```python
import torch

def _softmax(x, axis=-1):
    return torch.softmax(x, dim=axis)

def _gelu(x):
    return torch.nn.functional.gelu(x, approximate='tanh')

def _silu(x):
    return torch.nn.functional.silu(x)

def _sigmoid(x):
    return torch.sigmoid(x)

def _layernorm(x, axis=-1, eps=1e-05):
    m = x.mean(dim=axis, keepdim=True)
    v = x.var(dim=axis, keepdim=True, unbiased=False)
    return (x - m) / torch.sqrt(v + eps)

def _scatter_add(tgt, idx, src, axis=0):
    return tgt.clone().index_add_(axis, idx, src)

def _segment_sum(src, seg, n):
    out = torch.zeros((n,) + src.shape[1:], dtype=src.dtype)
    return out.index_add_(0, seg, src)

def _pad(x, pw):
    flat = tuple((v for pair in reversed(pw) for v in pair))
    return torch.nn.functional.pad(x, flat)
kernel_name = 'recurrent_scan__ssm_conv_h3__mixer_gmlp__prompt'

def setup_inputs():

    _w = lambda a: (lambda t: t.to(torch.bfloat16) if t.is_floating_point() else t)(torch.as_tensor(a))

    def _A_setup():
        B, S, D = (1, 2048, 576)
        ks = 4
        return {'q': _w((lambda *s: torch.randn(*s, dtype=torch.bfloat16) * 0.05)(B, S, D)), 'k': _w((lambda *s: torch.randn(*s, dtype=torch.bfloat16) * 0.2)(B, S, D)), 'v': _w((lambda *s: torch.randn(*s, dtype=torch.bfloat16) * 0.2)(B, S, D)), 'shift_k': _w((lambda *s: torch.randn(*s, dtype=torch.bfloat16) * 0.2)(D, ks) * 0.5), 'ssm_k': _w((lambda *s: torch.randn(*s, dtype=torch.bfloat16) * 0.2)(D, S) * (1.0 / S ** 0.5)), 'ssm_D': _w((lambda *s: torch.randn(*s, dtype=torch.bfloat16) * 0.2)(D))}
    _A_in = _A_setup()

    def _B_setup():
        B, S, D, F = (1, 2048, 576, 4608)
        Fh = F // 2
        return {'x': _w((lambda *s: torch.randn(*s, dtype=torch.bfloat16) * 0.05)(B, S, D)), 'w_in': _w((lambda *s: torch.randn(*s, dtype=torch.bfloat16) * 0.4)(D, 2 * Fh)), 'w_sp': _w(0.01 * (lambda *s: torch.randn(*s, dtype=torch.bfloat16) * 0.4)(S, S)), 'b_sp': _w(1.0 + 0.01 * (lambda *s: torch.randn(*s, dtype=torch.bfloat16) * 0.1)(S)), 'w_out': _w((lambda *s: torch.randn(*s, dtype=torch.bfloat16) * 0.1)(Fh, D))}
    _B_in = _B_setup()
    return {'A_q': _A_in['q'], 'A_k': _A_in['k'], 'A_v': _A_in['v'], 'A_shift_k': _A_in['shift_k'], 'A_ssm_k': _A_in['ssm_k'], 'A_ssm_D': _A_in['ssm_D'], 'B_x': _B_in['x'], 'B_w_in': _B_in['w_in'], 'B_w_sp': _B_in['w_sp'], 'B_b_sp': _B_in['b_sp'], 'B_w_out': _B_in['w_out']}

def reference(A_q, A_k, A_v, A_shift_k, A_ssm_k, A_ssm_D, B_x, B_w_in, B_w_sp, B_b_sp, B_w_out):

    def _A_ref(q, k, v, shift_k, ssm_k, ssm_D):
        B, S, D = q.shape
        ks = shift_k.shape[-1]
        k_pad = _pad(k, ((0, 0), (ks - 1, 0), (0, 0)))
        k_shift = torch.zeros_like(k)
        for t in range(ks):
            k_shift = k_shift + k_pad[:, t:t + S, :] * shift_k[:, ks - 1 - t][None, None, :]
        kv = k_shift * v
        L = 2 * S
        kv_pad = _pad(kv, ((0, 0), (0, S), (0, 0)))
        kf_pad = _pad(ssm_k, ((0, 0), (0, S)))
        kv_f = (lambda x, axes=(-2, -1): torch.fft.rfft2(x.float(), dim=axes))(kv_pad[:, None, :, :], axes=(1, 2))
        kf_f = (lambda x, axes=(-2, -1): torch.fft.rfft2(x.float(), dim=axes))(kf_pad[:, None, :], axes=(1, 2))
        kf_f = (lambda x, *d: x.permute(*d))(kf_f, 1, 2, 0)
        y_f = kv_f * kf_f[None, :, :, :]
        y = (lambda x, s, axes=(-2, -1): torch.fft.irfft2(x, s=s, dim=axes).to(torch.bfloat16))(y_f, (1, L), axes=(1, 2))[:, 0, :S, :]
        y = y + kv * ssm_D[None, None, :]
        return q * y

    def _B_ref(x, w_in, w_sp, b_sp, w_out):
        B, S, D = x.shape
        F = w_in.shape[-1]
        Fh = F // 2
        z = _gelu(torch.einsum('bsd,df->bsf', x, w_in))
        z1 = z[..., :Fh].clone()
        z2 = _layernorm(z[..., Fh:], axis=-1)
        g = torch.einsum('ts,bsf->btf', w_sp, z2) + b_sp[None, :, None]
        return torch.einsum('bsf,fd->bsd', z1 * g, w_out)
    x = A_q
    xn = _layernorm(x, axis=-1)
    s = _A_ref(xn, A_k, A_v, A_shift_k, A_ssm_k, A_ssm_D)
    g = _silu(_B_ref(xn, B_w_in, B_w_sp, B_b_sp, B_w_out))
    return x + s * g
```

```asm
; @launch grid=(256,1,1) block=(512,1,1) lds=160832
.amdgcn_target "amdgcn-amd-amdhsa--gfx950"
.text
.globl recurrent_scan__ssm_conv_h3__mixer_gmlp__prompt_kernel
.p2align 8
.type recurrent_scan__ssm_conv_h3__mixer_gmlp__prompt_kernel,@function
recurrent_scan__ssm_conv_h3__mixer_gmlp__prompt_kernel:
    s_cmp_ge_u32 s2, 256
    s_cbranch_scc1 recurrent_scan__ssm_conv_h3__mixer_gmlp__prompt_kernel_end1
    s_load_dwordx2 s[4:5], s[0:1], 0
    s_load_dwordx2 s[6:7], s[0:1], 56
    s_load_dwordx4 s[40:43], s[0:1], 96
    v_lshrrev_b32 v2, 6, v0
    v_and_b32 v1, 63, v0
    v_readfirstlane_b32 s28, v2
    s_getpc_b64 s[60:61]
recurrent_scan__ssm_conv_h3__mixer_gmlp__prompt_kernel_pc4:
    s_mov_b32 s62, recurrent_scan__ssm_conv_h3__mixer_gmlp__prompt_kernel_end1-recurrent_scan__ssm_conv_h3__mixer_gmlp__prompt_kernel_pc4
    s_mov_b32 s63, 0x20000
    v_lshlrev_b32 v3, 7, v0
    buffer_load_dword v253, v3, s[60:63], 0 offen
    v_and_b32 v5, 15, v1
    v_lshrrev_b32 v6, 4, v1
    v_lshlrev_b32 v7, 4, v1
    s_lshr_b32 s29, s28, 2
    s_and_b32 s30, s28, 3
    s_and_b32 s34, s2, 1
    s_lshl_b32 s34, s34, 3
    s_bfe_u32 s39, s2, 0x30003
    s_add_u32 s39, s39, s34
    s_lshl_b32 s31, s39, 7
    s_bfe_u32 s34, s2, 0x20001
    s_lshl_b32 s34, s34, 2
    s_lshr_b32 s32, s2, 6
    s_add_u32 s32, s32, s34
    s_sub_u32 s34, s39, 9
    s_cmp_lt_u32 s39, 9
    s_cselect_b32 s56, s39, s34
    s_mov_b32 s35, 0
    s_mov_b32 s36, 0
    s_mov_b32 s33, 0
    s_mov_b32 s53, 0x3f803f80
    v_lshrrev_b32 v2, 2, v5
    v_and_b32 v3, 1, v6
    v_lshl_add_u32 v2, v3, 2, v2
    v_lshrrev_b32 v3, 1, v6
    v_lshl_add_u32 v2, v3, 4, v2
    v_mul_u32_u24 v2, 288, v2
    v_and_b32 v3, 3, v5
    v_lshl_add_u32 v248, v3, 3, v2
    v_add_u32 v248, 4608, v248
    v_lshrrev_b32 v2, 2, v5
    v_and_b32 v3, 3, v5
    v_lshl_add_u32 v2, v2, 3, v3
    v_lshlrev_b32 v2, 7, v2
    v_xor_b32 v3, v6, v5
    v_and_b32 v3, 7, v3
    v_lshl_add_u32 v2, v3, 4, v2
    s_lshl_b32 s34, s30, 12
    s_add_u32 s34, s34, 87552
    v_add_u32 v249, s34, v2
    s_cmp_eq_u32 s29, 1
    s_cbranch_scc1 recurrent_scan__ssm_conv_h3__mixer_gmlp__prompt_kernel_B2
    v_mov_b32 v8, 0
    v_mov_b32 v9, 0
    v_mov_b32 v10, 0
    v_mov_b32 v11, 0
    v_mov_b32 v12, 0
    v_mov_b32 v13, 0
    v_mov_b32 v14, 0
    v_mov_b32 v15, 0
    v_mov_b32 v16, 0
    v_mov_b32 v17, 0
    v_mov_b32 v18, 0
    v_mov_b32 v19, 0
    v_mov_b32 v20, 0
    v_mov_b32 v21, 0
    v_mov_b32 v22, 0
    v_mov_b32 v23, 0
    v_mov_b32 v24, 0
    v_mov_b32 v25, 0
    v_mov_b32 v26, 0
    v_mov_b32 v27, 0
    v_mov_b32 v28, 0
    v_mov_b32 v29, 0
    v_mov_b32 v30, 0
    v_mov_b32 v31, 0
    v_mov_b32 v32, 0
    v_mov_b32 v33, 0
    v_mov_b32 v34, 0
    v_mov_b32 v35, 0
    v_mov_b32 v36, 0
    v_mov_b32 v37, 0
    v_mov_b32 v38, 0
    v_mov_b32 v39, 0
    v_mov_b32 v40, 0
    v_mov_b32 v41, 0
    v_mov_b32 v42, 0
    v_mov_b32 v43, 0
    v_mov_b32 v44, 0
    v_mov_b32 v45, 0
    v_mov_b32 v46, 0
    v_mov_b32 v47, 0
    v_mov_b32 v48, 0
    v_mov_b32 v49, 0
    v_mov_b32 v50, 0
    v_mov_b32 v51, 0
    v_mov_b32 v52, 0
    v_mov_b32 v53, 0
    v_mov_b32 v54, 0
    v_mov_b32 v55, 0
    v_mov_b32 v56, 0
    v_mov_b32 v57, 0
    v_mov_b32 v58, 0
    v_mov_b32 v59, 0
    v_mov_b32 v60, 0
    v_mov_b32 v61, 0
    v_mov_b32 v62, 0
    v_mov_b32 v63, 0
    v_mov_b32 v64, 0
    v_mov_b32 v65, 0
    v_mov_b32 v66, 0
    v_mov_b32 v67, 0
    v_mov_b32 v68, 0
    v_mov_b32 v69, 0
    v_mov_b32 v70, 0
    v_mov_b32 v71, 0
    v_mov_b32 v72, 0
    v_mov_b32 v73, 0
    v_mov_b32 v74, 0
    v_mov_b32 v75, 0
    v_mov_b32 v76, 0
    v_mov_b32 v77, 0
    v_mov_b32 v78, 0
    v_mov_b32 v79, 0
    s_mul_i32 s37, s32, 288
    s_mov_b32 s54, 3641
    v_add_u32 v2, 0, v1
    v_mul_lo_u32 v3, v2, s54
    v_lshrrev_b32 v3, 16, v3
    v_mul_u32_u24 v4, 18, v3
    v_sub_u32 v2, v2, v4
    v_and_b32 v4, 0x13, v3
    v_and_b32 v132, 4, v3
    v_lshl_or_b32 v4, v132, 1, v4
    v_and_b32 v132, 8, v3
    v_lshrrev_b32 v132, 1, v132
    v_or_b32 v4, v4, v132
    v_mul_u32_u24 v4, 9216, v4
    v_lshl_add_u32 v4, v2, 4, v4
    v_add_u32 v4, s37, v4
    v_add_u32 v132, 4096, v4
    v_add_u32 v2, 64, v1
    v_mul_lo_u32 v3, v2, s54
    v_lshrrev_b32 v3, 16, v3
    v_mul_u32_u24 v4, 18, v3
    v_sub_u32 v2, v2, v4
    v_and_b32 v4, 0x13, v3
    v_and_b32 v133, 4, v3
    v_lshl_or_b32 v4, v133, 1, v4
    v_and_b32 v133, 8, v3
    v_lshrrev_b32 v133, 1, v133
    v_or_b32 v4, v4, v133
    v_mul_u32_u24 v4, 9216, v4
    v_lshl_add_u32 v4, v2, 4, v4
    v_add_u32 v4, s37, v4
    v_add_u32 v133, 3072, v4
    v_add_u32 v2, 128, v1
    v_mul_lo_u32 v3, v2, s54
    v_lshrrev_b32 v3, 16, v3
    v_mul_u32_u24 v4, 18, v3
    v_sub_u32 v2, v2, v4
    v_and_b32 v4, 0x13, v3
    v_and_b32 v134, 4, v3
    v_lshl_or_b32 v4, v134, 1, v4
    v_and_b32 v134, 8, v3
    v_lshrrev_b32 v134, 1, v134
    v_or_b32 v4, v4, v134
    v_mul_u32_u24 v4, 9216, v4
    v_lshl_add_u32 v4, v2, 4, v4
    v_add_u32 v4, s37, v4
    v_add_u32 v134, 2048, v4
    v_add_u32 v2, 192, v1
    v_mul_lo_u32 v3, v2, s54
    v_lshrrev_b32 v3, 16, v3
    v_mul_u32_u24 v4, 18, v3
    v_sub_u32 v2, v2, v4
    v_and_b32 v4, 0x13, v3
    v_and_b32 v135, 4, v3
    v_lshl_or_b32 v4, v135, 1, v4
    v_and_b32 v135, 8, v3
    v_lshrrev_b32 v135, 1, v135
    v_or_b32 v4, v4, v135
    v_mul_u32_u24 v4, 9216, v4
    v_lshl_add_u32 v4, v2, 4, v4
    v_add_u32 v4, s37, v4
    v_add_u32 v135, 1024, v4
    v_add_u32 v2, 256, v1
    v_mul_lo_u32 v3, v2, s54
    v_lshrrev_b32 v3, 16, v3
    v_mul_u32_u24 v4, 18, v3
    v_sub_u32 v2, v2, v4
    v_and_b32 v4, 0x13, v3
    v_and_b32 v136, 4, v3
    v_lshl_or_b32 v4, v136, 1, v4
    v_and_b32 v136, 8, v3
    v_lshrrev_b32 v136, 1, v136
    v_or_b32 v4, v4, v136
    v_mul_u32_u24 v4, 9216, v4
    v_lshl_add_u32 v4, v2, 4, v4
    v_add_u32 v4, s37, v4
    v_add_u32 v136, 4096, v4
    v_add_u32 v2, 320, v1
    v_mul_lo_u32 v3, v2, s54
    v_lshrrev_b32 v3, 16, v3
    v_mul_u32_u24 v4, 18, v3
    v_sub_u32 v2, v2, v4
    v_and_b32 v4, 0x13, v3
    v_and_b32 v137, 4, v3
    v_lshl_or_b32 v4, v137, 1, v4
    v_and_b32 v137, 8, v3
    v_lshrrev_b32 v137, 1, v137
    v_or_b32 v4, v4, v137
    v_mul_u32_u24 v4, 9216, v4
    v_lshl_add_u32 v4, v2, 4, v4
    v_add_u32 v4, s37, v4
    v_add_u32 v137, 3072, v4
    v_add_u32 v2, 384, v1
    v_mul_lo_u32 v3, v2, s54
    v_lshrrev_b32 v3, 16, v3
    v_mul_u32_u24 v4, 18, v3
    v_sub_u32 v2, v2, v4
    v_and_b32 v4, 0x13, v3
    v_and_b32 v138, 4, v3
    v_lshl_or_b32 v4, v138, 1, v4
    v_and_b32 v138, 8, v3
    v_lshrrev_b32 v138, 1, v138
    v_or_b32 v4, v4, v138
    v_mul_u32_u24 v4, 9216, v4
    v_lshl_add_u32 v4, v2, 4, v4
    v_add_u32 v4, s37, v4
    v_add_u32 v138, 2048, v4
    v_add_u32 v2, 448, v1
    v_mul_lo_u32 v3, v2, s54
    v_lshrrev_b32 v3, 16, v3
    v_mul_u32_u24 v4, 18, v3
    v_sub_u32 v2, v2, v4
    v_and_b32 v4, 0x13, v3
    v_and_b32 v139, 4, v3
    v_lshl_or_b32 v4, v139, 1, v4
    v_and_b32 v139, 8, v3
    v_lshrrev_b32 v139, 1, v139
    v_or_b32 v4, v4, v139
    v_mul_u32_u24 v4, 9216, v4
    v_lshl_add_u32 v4, v2, 4, v4
    v_add_u32 v4, s37, v4
    v_add_u32 v139, 1024, v4
    v_add_u32 v2, 512, v1
    v_mul_lo_u32 v3, v2, s54
    v_lshrrev_b32 v3, 16, v3
    v_mul_u32_u24 v4, 18, v3
    v_sub_u32 v2, v2, v4
    v_and_b32 v4, 0x13, v3
    v_and_b32 v140, 4, v3
    v_lshl_or_b32 v4, v140, 1, v4
    v_and_b32 v140, 8, v3
    v_lshrrev_b32 v140, 1, v140
    v_or_b32 v4, v4, v140
    v_mul_u32_u24 v4, 9216, v4
    v_lshl_add_u32 v4, v2, 4, v4
    v_add_u32 v4, s37, v4
    v_add_u32 v140, 4096, v4
    s_waitcnt lgkmcnt(0)
    s_sub_u32 s12, s6, 4096
    s_subb_u32 s13, s7, 0
    s_mov_b32 s14, 5312512
    s_mov_b32 s15, 0x20000
    s_add_u32 s48, s42, 67108864
    s_addc_u32 s49, s43, 0
    s_mov_b32 s50, 2097152
    s_mov_b32 s51, 0x20000
    s_load_dwordx2 s[64:65], s[0:1], 64
    s_load_dwordx2 s[62:63], s[0:1], 80
    s_lshl_b32 s58, s2, 2
    s_add_u32 s58, s58, s30
    s_mul_i32 s57, s58, 2592
    s_lshl_b32 s58, s58, 13
    v_lshlrev_b32 v150, 7, v1
    s_waitcnt lgkmcnt(0)
    s_mov_b32 s24, s64
    s_mov_b32 s25, s65
    s_mov_b32 s26, 8388608
    s_mov_b32 s27, 0x20000
    s_mov_b32 s64, s62
    s_mov_b32 s65, s63
    s_mov_b32 s66, 2654208
    s_mov_b32 s67, 0x20000
    s_barrier
    v_add_u32 v251, s36, v249
    ds_read_b128 v[116:119], v251 offset:0
    v_xor_b32 v252, 64, v251
    ds_read_b128 v[120:123], v251 offset:512
    v_add_u32 v250, s35, v248
    ds_read_b64_tr_b16 v[80:81], v250 offset:0
    ds_read_b64_tr_b16 v[82:83], v250 offset:2304
    ds_read_b64_tr_b16 v[84:85], v250 offset:32
    s_add_u32 s35, s35, 9216
    ds_read_b64_tr_b16 v[86:87], v250 offset:2336
    ds_read_b64_tr_b16 v[88:89], v250 offset:64
    s_cmp_eq_u32 s35, 82944
    s_cselect_b32 s35, 0, s35
    ds_read_b64_tr_b16 v[90:91], v250 offset:2368
    ds_read_b64_tr_b16 v[92:93], v250 offset:96
    s_add_u32 s36, s36, 16384
    ds_read_b64_tr_b16 v[94:95], v250 offset:2400
recurrent_scan__ssm_conv_h3__mixer_gmlp__prompt_kernel_loop5:
    s_waitcnt lgkmcnt(4)
    v_mfma_f32_16x16x32_bf16 v[8:11], v[116:119], v[80:83], v[8:11]
    ds_read_b64_tr_b16 v[96:97], v250 offset:128
    s_and_b32 s36, s36, 65535
    ds_read_b64_tr_b16 v[98:99], v250 offset:2432
    v_mfma_f32_16x16x32_bf16 v[12:15], v[120:123], v[80:83], v[12:15]
    v_mfma_f32_16x16x32_bf16 v[16:19], v[116:119], v[84:87], v[16:19]
    ds_read_b64_tr_b16 v[100:101], v250 offset:160
    ds_read_b64_tr_b16 v[102:103], v250 offset:2464
    v_mfma_f32_16x16x32_bf16 v[20:23], v[120:123], v[84:87], v[20:23]
    s_waitcnt lgkmcnt(4)
    v_mfma_f32_16x16x32_bf16 v[24:27], v[116:119], v[88:91], v[24:27]
    ds_read_b64_tr_b16 v[104:105], v250 offset:192
    ds_read_b64_tr_b16 v[106:107], v250 offset:2496
    v_mfma_f32_16x16x32_bf16 v[28:31], v[120:123], v[88:91], v[28:31]
    v_mfma_f32_16x16x32_bf16 v[32:35], v[116:119], v[92:95], v[32:35]
    ds_read_b64_tr_b16 v[108:109], v250 offset:224
    ds_read_b64_tr_b16 v[110:111], v250 offset:2528
    v_mfma_f32_16x16x32_bf16 v[36:39], v[120:123], v[92:95], v[36:39]
    s_waitcnt lgkmcnt(4)
    v_mfma_f32_16x16x32_bf16 v[40:43], v[116:119], v[96:99], v[40:43]
    ds_read_b64_tr_b16 v[112:113], v250 offset:256
    ds_read_b64_tr_b16 v[114:115], v250 offset:2560
    v_mfma_f32_16x16x32_bf16 v[44:47], v[120:123], v[96:99], v[44:47]
    v_mfma_f32_16x16x32_bf16 v[48:51], v[116:119], v[100:103], v[48:51]
    ds_read_b128 v[124:127], v252 offset:0
    ds_read_b128 v[128:131], v252 offset:512
    v_mfma_f32_16x16x32_bf16 v[52:55], v[120:123], v[100:103], v[52:55]
    v_add_u32 v250, s35, v248
    ds_read_b64_tr_b16 v[80:81], v250 offset:0
    ds_read_b64_tr_b16 v[82:83], v250 offset:2304
    s_waitcnt lgkmcnt(6)
    v_mfma_f32_16x16x32_bf16 v[56:59], v[116:119], v[104:107], v[56:59]
    ds_read_b64_tr_b16 v[84:85], v250 offset:32
    s_add_u32 s35, s35, 9216
    ds_read_b64_tr_b16 v[86:87], v250 offset:2336
    v_mfma_f32_16x16x32_bf16 v[60:63], v[120:123], v[104:107], v[60:63]
    v_mfma_f32_16x16x32_bf16 v[64:67], v[116:119], v[108:111], v[64:67]
    ds_read_b64_tr_b16 v[88:89], v250 offset:64
    s_cmp_eq_u32 s35, 82944
    s_cselect_b32 s35, 0, s35
    ds_read_b64_tr_b16 v[90:91], v250 offset:2368
    v_mfma_f32_16x16x32_bf16 v[68:71], v[120:123], v[108:111], v[68:71]
    s_waitcnt lgkmcnt(8)
    v_mfma_f32_16x16x32_bf16 v[72:75], v[116:119], v[112:115], v[72:75]
    ds_read_b64_tr_b16 v[92:93], v250 offset:96
    ds_read_b64_tr_b16 v[94:95], v250 offset:2400
    v_mfma_f32_16x16x32_bf16 v[76:79], v[120:123], v[112:115], v[76:79]
    s_waitcnt lgkmcnt(4)
    v_mfma_f32_16x16x32_bf16 v[8:11], v[124:127], v[80:83], v[8:11]
    ds_read_b64_tr_b16 v[96:97], v250 offset:128
    ds_read_b64_tr_b16 v[98:99], v250 offset:2432
    v_mfma_f32_16x16x32_bf16 v[12:15], v[128:131], v[80:83], v[12:15]
    v_mfma_f32_16x16x32_bf16 v[16:19], v[124:127], v[84:87], v[16:19]
    ds_read_b64_tr_b16 v[100:101], v250 offset:160
    ds_read_b64_tr_b16 v[102:103], v250 offset:2464
    v_mfma_f32_16x16x32_bf16 v[20:23], v[128:131], v[84:87], v[20:23]
    s_waitcnt lgkmcnt(4)
    v_mfma_f32_16x16x32_bf16 v[24:27], v[124:127], v[88:91], v[24:27]
    ds_read_b64_tr_b16 v[104:105], v250 offset:192
    ds_read_b64_tr_b16 v[106:107], v250 offset:2496
    v_mfma_f32_16x16x32_bf16 v[28:31], v[128:131], v[88:91], v[28:31]
    v_mfma_f32_16x16x32_bf16 v[32:35], v[124:127], v[92:95], v[32:35]
    ds_read_b64_tr_b16 v[108:109], v250 offset:224
    ds_read_b64_tr_b16 v[110:111], v250 offset:2528
    v_mfma_f32_16x16x32_bf16 v[36:39], v[128:131], v[92:95], v[36:39]
    s_waitcnt lgkmcnt(4)
    v_mfma_f32_16x16x32_bf16 v[40:43], v[124:127], v[96:99], v[40:43]
    ds_read_b64_tr_b16 v[112:113], v250 offset:256
    ds_read_b64_tr_b16 v[114:115], v250 offset:2560
    v_mfma_f32_16x16x32_bf16 v[44:47], v[128:131], v[96:99], v[44:47]
    v_mfma_f32_16x16x32_bf16 v[48:51], v[124:127], v[100:103], v[48:51]
    s_barrier
    v_add_u32 v251, s36, v249
    ds_read_b128 v[116:119], v251 offset:0
    v_xor_b32 v252, 64, v251
    ds_read_b128 v[120:123], v251 offset:512
    v_mfma_f32_16x16x32_bf16 v[52:55], v[128:131], v[100:103], v[52:55]
    v_add_u32 v250, s35, v248
    ds_read_b64_tr_b16 v[80:81], v250 offset:0
    ds_read_b64_tr_b16 v[82:83], v250 offset:2304
    s_waitcnt lgkmcnt(6)
    v_mfma_f32_16x16x32_bf16 v[56:59], v[124:127], v[104:107], v[56:59]
    ds_read_b64_tr_b16 v[84:85], v250 offset:32
    s_add_u32 s35, s35, 9216
    ds_read_b64_tr_b16 v[86:87], v250 offset:2336
    v_mfma_f32_16x16x32_bf16 v[60:63], v[128:131], v[104:107], v[60:63]
    v_mfma_f32_16x16x32_bf16 v[64:67], v[124:127], v[108:111], v[64:67]
    ds_read_b64_tr_b16 v[88:89], v250 offset:64
    s_cmp_eq_u32 s35, 82944
    s_cselect_b32 s35, 0, s35
    ds_read_b64_tr_b16 v[90:91], v250 offset:2368
    v_mfma_f32_16x16x32_bf16 v[68:71], v[128:131], v[108:111], v[68:71]
    s_waitcnt lgkmcnt(8)
    v_mfma_f32_16x16x32_bf16 v[72:75], v[124:127], v[112:115], v[72:75]
    ds_read_b64_tr_b16 v[92:93], v250 offset:96
    s_add_u32 s36, s36, 16384
    ds_read_b64_tr_b16 v[94:95], v250 offset:2400
    v_mfma_f32_16x16x32_bf16 v[76:79], v[128:131], v[112:115], v[76:79]
    s_add_u32 s33, s33, 1
    s_cmp_lt_u32 s33, 9
    s_cbranch_scc1 recurrent_scan__ssm_conv_h3__mixer_gmlp__prompt_kernel_loop5
    s_waitcnt lgkmcnt(0)
    s_lshl_b32 s38, s56, 1
    s_add_u32 s38, s38, s30
    s_add_u32 s38, s38, 6
    s_cmp_ge_u32 s38, 18
    s_cselect_b32 s34, 18, 0
    s_sub_u32 s38, s38, s34
    s_mul_i32 s35, s38, 294912
    s_add_u32 s38, s38, 4
    s_mul_i32 s59, s30, 9216
    s_add_u32 s59, s59, 87552
    s_add_u32 m0, s59, 0
    s_nop 0
    buffer_load_dwordx4 v132, s[12:15], s35 offen offset:0 lds
    buffer_load_dwordx4 v133, s[12:15], s35 offen offset:1024 lds
    buffer_load_dwordx4 v134, s[12:15], s35 offen offset:2048 lds
    buffer_load_dwordx4 v135, s[12:15], s35 offen offset:3072 lds
    s_add_u32 m0, s59, 4096
    s_nop 0
    buffer_load_dwordx4 v136, s[12:15], s35 offen offset:0 lds
    buffer_load_dwordx4 v137, s[12:15], s35 offen offset:1024 lds
    buffer_load_dwordx4 v138, s[12:15], s35 offen offset:2048 lds
    buffer_load_dwordx4 v139, s[12:15], s35 offen offset:3072 lds
    s_add_u32 m0, s59, 8192
    s_nop 0
    buffer_load_dwordx4 v140, s[12:15], s35 offen offset:0 lds
    s_lshl_b32 s34, s30, 7
    v_lshlrev_b32 v230, 5, v6
    v_add_u32 v230, s34, v230
    ds_read_b128 v[152:155], v230 offset:1280
    ds_read_b128 v[160:163], v230 offset:1792
    ds_read_b128 v[156:159], v230 offset:1296
    ds_read_b128 v[164:167], v230 offset:1808
    v_lshlrev_b32 v231, 2, v5
    ds_read_b32 v216, v231 offset:0
    ds_read_b32 v218, v231 offset:64
    ds_read_b32 v220, v231 offset:128
    ds_read_b32 v222, v231 offset:192
    ds_read_b32 v224, v231 offset:256
    ds_read_b32 v226, v231 offset:320
    v_mov_b32 v184, 0
    v_mov_b32 v192, 0
    v_mov_b32 v185, 0
    v_mov_b32 v193, 0
    v_mov_b32 v186, 0
    v_mov_b32 v194, 0
    v_mov_b32 v187, 0
    v_mov_b32 v195, 0
    v_mov_b32 v188, 0
    v_mov_b32 v196, 0
    v_mov_b32 v189, 0
    v_mov_b32 v197, 0
    v_mov_b32 v190, 0
    v_mov_b32 v198, 0
    v_mov_b32 v191, 0
    v_mov_b32 v199, 0
    v_mov_b32 v228, 1.0
    v_mov_b32 v229, 1.0
    s_waitcnt lgkmcnt(0)
    v_mov_b32 v217, v216
    v_mov_b32 v219, v218
    v_mov_b32 v221, v220
    v_mov_b32 v223, v222
    v_mov_b32 v225, v224
    v_mov_b32 v227, v226
    v_mul_f32 v168, 0xc0135761, v160
    v_mul_f32 v176, v160, v160
    v_mul_f32 v169, 0xc0135761, v161
    v_mul_f32 v177, v161, v161
    v_mul_f32 v170, 0xc0135761, v162
    v_mul_f32 v178, v162, v162
    v_mul_f32 v171, 0xc0135761, v163
    v_mul_f32 v179, v163, v163
    v_mul_f32 v172, 0xc0135761, v164
    v_mul_f32 v180, v164, v164
    v_mul_f32 v173, 0xc0135761, v165
    v_mul_f32 v181, v165, v165
    v_mul_f32 v174, 0xc0135761, v166
    v_mul_f32 v182, v166, v166
    v_mul_f32 v175, 0xc0135761, v167
    v_mul_f32 v183, v167, v167
    v_mul_f32 v176, v176, v160
    v_mul_f32 v177, v177, v161
    v_mul_f32 v178, v178, v162
    v_mul_f32 v179, v179, v163
    v_mul_f32 v180, v180, v164
    v_mul_f32 v181, v181, v165
    v_mul_f32 v182, v182, v166
    v_mul_f32 v183, v183, v167
    v_mul_f32 v176, 0xbdd2d3e8, v176
    v_mul_f32 v177, 0xbdd2d3e8, v177
    v_mul_f32 v178, 0xbdd2d3e8, v178
    v_mul_f32 v179, 0xbdd2d3e8, v179
    v_mul_f32 v180, 0xbdd2d3e8, v180
    v_mul_f32 v181, 0xbdd2d3e8, v181
    v_mul_f32 v182, 0xbdd2d3e8, v182
    v_mul_f32 v183, 0xbdd2d3e8, v183
    s_lshl_b32 s60, s32, 8
    s_add_u32 s60, s60, 1847296
    s_cmp_ge_u32 s38, 18
    s_cselect_b32 s34, 18, 0
    s_sub_u32 s38, s38, s34
    s_mul_i32 s35, s38, 294912
    s_add_u32 s38, s38, 4
    s_mul_i32 s59, s30, 9216
    s_add_u32 s59, s59, 124416
    s_cmp_eq_u32 s30, 3
    s_cselect_b32 s59, 59904, s59
    s_add_u32 m0, s59, 0
    s_nop 0
    buffer_load_dwordx4 v132, s[12:15], s35 offen offset:0 lds
    buffer_load_dwordx4 v133, s[12:15], s35 offen offset:1024 lds
    buffer_load_dwordx4 v134, s[12:15], s35 offen offset:2048 lds
    buffer_load_dwordx4 v135, s[12:15], s35 offen offset:3072 lds
    s_add_u32 m0, s59, 4096
    s_nop 0
    buffer_load_dwordx4 v136, s[12:15], s35 offen offset:0 lds
    buffer_load_dwordx4 v137, s[12:15], s35 offen offset:1024 lds
    buffer_load_dwordx4 v138, s[12:15], s35 offen offset:2048 lds
    buffer_load_dwordx4 v139, s[12:15], s35 offen offset:3072 lds
    s_add_u32 m0, s59, 8192
    s_nop 0
    buffer_load_dwordx4 v140, s[12:15], s35 offen offset:0 lds
    s_waitcnt vmcnt(9)
    s_barrier
    s_cmp_ge_u32 s38, 18
    s_cselect_b32 s34, 18, 0
    s_sub_u32 s38, s38, s34
    s_mul_i32 s35, s38, 294912
    s_add_u32 s38, s38, 4
    s_mul_i32 s59, s30, 9216
    s_add_u32 s59, s59, 69120
    s_cmp_ge_u32 s30, 2
    s_cselect_b32 s34, 82944, 0
    s_sub_u32 s59, s59, s34
    s_add_u32 m0, s59, 0
    s_nop 0
    buffer_load_dwordx4 v132, s[12:15], s35 offen offset:0 lds
    buffer_load_dwordx4 v133, s[12:15], s35 offen offset:1024 lds
    buffer_load_dwordx4 v134, s[12:15], s35 offen offset:2048 lds
    buffer_load_dwordx4 v135, s[12:15], s35 offen offset:3072 lds
    s_add_u32 m0, s59, 4096
    s_nop 0
    buffer_load_dwordx4 v136, s[12:15], s35 offen offset:0 lds
    buffer_load_dwordx4 v137, s[12:15], s35 offen offset:1024 lds
    buffer_load_dwordx4 v138, s[12:15], s35 offen offset:2048 lds
    buffer_load_dwordx4 v139, s[12:15], s35 offen offset:3072 lds
    s_add_u32 m0, s59, 8192
    s_nop 0
    buffer_load_dwordx4 v140, s[12:15], s35 offen offset:0 lds
    s_mul_i32 s34, s30, 6144
    s_add_u32 s34, s34, 23040
    v_add_u32 v4, s34, v7
    s_lshr_b32 s34, s30, 1
    s_mul_i32 s34, s34, 9216
    s_and_b32 s59, s30, 1
    s_mul_i32 s59, s59, 160
    s_add_u32 s34, s34, s59
    s_add_u32 s34, s34, 82944
    v_add_u32 v2, s34, v248
    ds_read_b64_tr_b16 v[92:93], v2 offset:0
    ds_read_b64_tr_b16 v[94:95], v2 offset:2304
    ds_read_b64_tr_b16 v[96:97], v2 offset:32
    ds_read_b64_tr_b16 v[98:99], v2 offset:2336
    ds_read_b64_tr_b16 v[100:101], v2 offset:64
    ds_read_b64_tr_b16 v[102:103], v2 offset:2368
    ds_read_b64_tr_b16 v[104:105], v2 offset:96
    ds_read_b64_tr_b16 v[106:107], v2 offset:2400
    ds_read_b64_tr_b16 v[108:109], v2 offset:128
    ds_read_b64_tr_b16 v[110:111], v2 offset:2432
    v_mov_b32 v112, 0
    v_mov_b32 v113, 0
    v_mov_b32 v114, 0
    v_mov_b32 v115, 0
    v_mov_b32 v116, 0
    s_lshl_b32 s59, s59, 1
    s_lshr_b32 s34, s30, 1
    s_mul_i32 s34, s34, 640
    s_add_u32 s59, s59, s34
    v_lshlrev_b32 v3, 2, v5
    v_add_u32 v3, s59, v3
    s_waitcnt lgkmcnt(0)
    v_dot2_f32_bf16 v112, v92, s53, v112
    v_dot2_f32_bf16 v113, v96, s53, v113
    v_dot2_f32_bf16 v114, v100, s53, v114
    v_dot2_f32_bf16 v115, v104, s53, v115
    v_dot2_f32_bf16 v116, v108, s53, v116
    v_dot2_f32_bf16 v112, v93, s53, v112
    v_dot2_f32_bf16 v113, v97, s53, v113
    v_dot2_f32_bf16 v114, v101, s53, v114
    v_dot2_f32_bf16 v115, v105, s53, v115
    v_dot2_f32_bf16 v116, v109, s53, v116
    v_dot2_f32_bf16 v112, v94, s53, v112
    v_dot2_f32_bf16 v113, v98, s53, v113
    v_dot2_f32_bf16 v114, v102, s53, v114
    v_dot2_f32_bf16 v115, v106, s53, v115
    v_dot2_f32_bf16 v116, v110, s53, v116
    v_dot2_f32_bf16 v112, v95, s53, v112
    v_dot2_f32_bf16 v113, v99, s53, v113
    v_dot2_f32_bf16 v114, v103, s53, v114
    v_dot2_f32_bf16 v115, v107, s53, v115
    v_dot2_f32_bf16 v116, v111, s53, v116
    v_mov_b32 v92, v112
    v_mov_b32 v93, v113
    v_mov_b32 v94, v114
    v_mov_b32 v95, v115
    v_mov_b32 v96, v116
    v_permlane32_swap_b32 v112, v92
    v_permlane32_swap_b32 v113, v93
    v_permlane32_swap_b32 v114, v94
    v_permlane32_swap_b32 v115, v95
    v_permlane32_swap_b32 v116, v96
    v_add_f32 v112, v112, v92
    v_add_f32 v113, v113, v93
    v_add_f32 v114, v114, v94
    v_add_f32 v115, v115, v95
    v_add_f32 v116, v116, v96
    v_mov_b32 v92, v112
    v_mov_b32 v93, v113
    v_mov_b32 v94, v114
    v_mov_b32 v95, v115
    v_mov_b32 v96, v116
    v_permlane16_swap_b32 v112, v92
    v_permlane16_swap_b32 v113, v93
    v_permlane16_swap_b32 v114, v94
    v_permlane16_swap_b32 v115, v95
    v_permlane16_swap_b32 v116, v96
    v_add_f32 v112, v112, v92
    v_add_f32 v113, v113, v93
    v_add_f32 v114, v114, v94
    v_add_f32 v115, v115, v95
    v_add_f32 v116, v116, v96
    ds_write_b32 v3, v112 offset:3328
    ds_write_b32 v3, v113 offset:3392
    ds_write_b32 v3, v114 offset:3456
    ds_write_b32 v3, v115 offset:3520
    ds_write_b32 v3, v116 offset:3584
    v_pk_fma_f32 v[8:9], v[152:153], v[216:217], v[8:9] neg_lo:[1,0,0] neg_hi:[1,0,0]
    v_pk_fma_f32 v[10:11], v[154:155], v[216:217], v[10:11] neg_lo:[1,0,0] neg_hi:[1,0,0]
    v_pk_fma_f32 v[12:13], v[156:157], v[216:217], v[12:13] neg_lo:[1,0,0] neg_hi:[1,0,0]
    v_pk_fma_f32 v[14:15], v[158:159], v[216:217], v[14:15] neg_lo:[1,0,0] neg_hi:[1,0,0]
    v_pk_mul_f32 v[208:209], v[8:9], v[8:9]
    v_pk_mul_f32 v[210:211], v[10:11], v[10:11]
    v_pk_mul_f32 v[212:213], v[12:13], v[12:13]
    v_pk_mul_f32 v[214:215], v[14:15], v[14:15]
    v_pk_fma_f32 v[208:209], v[208:209], v[176:177], v[168:169]
    v_pk_fma_f32 v[210:211], v[210:211], v[178:179], v[170:171]
    v_pk_fma_f32 v[212:213], v[212:213], v[180:181], v[172:173]
    v_pk_fma_f32 v[214:215], v[214:215], v[182:183], v[174:175]
    v_pk_mul_f32 v[208:209], v[208:209], v[8:9]
    v_pk_mul_f32 v[210:211], v[210:211], v[10:11]
    v_pk_mul_f32 v[212:213], v[212:213], v[12:13]
    v_pk_mul_f32 v[214:215], v[214:215], v[14:15]
    v_exp_f32 v208, v208
    v_exp_f32 v209, v209
    v_exp_f32 v210, v210
    v_exp_f32 v211, v211
    v_exp_f32 v212, v212
    v_exp_f32 v213, v213
    v_exp_f32 v214, v214
    v_exp_f32 v215, v215
    v_pk_add_f32 v[208:209], v[208:209], v[228:229]
    v_pk_add_f32 v[210:211], v[210:211], v[228:229]
    v_pk_add_f32 v[212:213], v[212:213], v[228:229]
    v_pk_add_f32 v[214:215], v[214:215], v[228:229]
    v_rcp_f32 v208, v208
    v_rcp_f32 v209, v209
    v_rcp_f32 v210, v210
    v_rcp_f32 v211, v211
    v_rcp_f32 v212, v212
    v_rcp_f32 v213, v213
    v_rcp_f32 v214, v214
    v_rcp_f32 v215, v215
    v_pk_mul_f32 v[8:9], v[8:9], v[208:209]
    v_pk_mul_f32 v[10:11], v[10:11], v[210:211]
    v_pk_mul_f32 v[12:13], v[12:13], v[212:213]
    v_pk_mul_f32 v[14:15], v[14:15], v[214:215]
    v_pk_add_f32 v[184:185], v[184:185], v[8:9]
    v_pk_add_f32 v[186:187], v[186:187], v[10:11]
    v_pk_add_f32 v[188:189], v[188:189], v[12:13]
    v_pk_add_f32 v[190:191], v[190:191], v[14:15]
    v_pk_fma_f32 v[192:193], v[8:9], v[8:9], v[192:193]
    v_pk_fma_f32 v[194:195], v[10:11], v[10:11], v[194:195]
    v_pk_fma_f32 v[196:197], v[12:13], v[12:13], v[196:197]
    v_pk_fma_f32 v[198:199], v[14:15], v[14:15], v[198:199]
    s_waitcnt vmcnt(9) lgkmcnt(0)
    s_barrier
    ds_read_b128 v[120:123], v7 offset:3328
    ds_read_b128 v[124:127], v7 offset:3968
    s_lshl_b32 s34, s32, 1
    s_add_u32 s34, s34, 1
    s_mul_i32 s34, s34, 9
    s_add_u32 s34, s34, s56
    s_mul_i32 s34, s34, 576
    s_add_u32 s34, s34, 1310720
    s_cmp_lt_u32 s39, 9
    s_cselect_b32 s34, s34, 2146435072
    s_cmp_eq_u32 s30, 0
    s_cselect_b32 s34, s34, 2146435072
    v_mov_b32 v234, 2146435072
    v_cmp_gt_u32 vcc, 36, v1
    s_nop 1
    v_cndmask_b32 v233, v234, v7, vcc
    s_waitcnt lgkmcnt(0)
    v_add_f32 v120, v120, v124
    v_add_f32 v121, v121, v125
    v_add_f32 v122, v122, v126
    v_add_f32 v123, v123, v127
    buffer_store_dwordx4 v[120:123], v233, s[48:51], s34 offen sc1
    s_load_dwordx2 s[64:65], s[0:1], 24
    s_and_b32 s34, s2, 7
    s_mul_i32 s34, s34, 576
    s_mov_b32 m0, 2304
    s_waitcnt lgkmcnt(0)
    s_mov_b32 s24, s64
    s_mov_b32 s25, s65
    s_mov_b32 s26, 4608
    s_mov_b32 s27, 0x20000
    buffer_load_dwordx4 v7, s[24:27], s34 offen lds
    v_pk_fma_f32 v[16:17], v[152:153], v[218:219], v[16:17] neg_lo:[1,0,0] neg_hi:[1,0,0]
    v_pk_fma_f32 v[18:19], v[154:155], v[218:219], v[18:19] neg_lo:[1,0,0] neg_hi:[1,0,0]
    v_pk_fma_f32 v[20:21], v[156:157], v[218:219], v[20:21] neg_lo:[1,0,0] neg_hi:[1,0,0]
    v_pk_fma_f32 v[22:23], v[158:159], v[218:219], v[22:23] neg_lo:[1,0,0] neg_hi:[1,0,0]
    v_pk_mul_f32 v[208:209], v[16:17], v[16:17]
    v_pk_mul_f32 v[210:211], v[18:19], v[18:19]
    v_pk_mul_f32 v[212:213], v[20:21], v[20:21]
    v_pk_mul_f32 v[214:215], v[22:23], v[22:23]
    v_pk_fma_f32 v[208:209], v[208:209], v[176:177], v[168:169]
    v_pk_fma_f32 v[210:211], v[210:211], v[178:179], v[170:171]
    v_pk_fma_f32 v[212:213], v[212:213], v[180:181], v[172:173]
    v_pk_fma_f32 v[214:215], v[214:215], v[182:183], v[174:175]
    v_pk_mul_f32 v[208:209], v[208:209], v[16:17]
    v_pk_mul_f32 v[210:211], v[210:211], v[18:19]
    v_pk_mul_f32 v[212:213], v[212:213], v[20:21]
    v_pk_mul_f32 v[214:215], v[214:215], v[22:23]
    v_exp_f32 v208, v208
    v_exp_f32 v209, v209
    v_exp_f32 v210, v210
    v_exp_f32 v211, v211
    v_exp_f32 v212, v212
    v_exp_f32 v213, v213
    v_exp_f32 v214, v214
    v_exp_f32 v215, v215
    v_pk_add_f32 v[208:209], v[208:209], v[228:229]
    v_pk_add_f32 v[210:211], v[210:211], v[228:229]
    v_pk_add_f32 v[212:213], v[212:213], v[228:229]
    v_pk_add_f32 v[214:215], v[214:215], v[228:229]
    v_rcp_f32 v208, v208
    v_rcp_f32 v209, v209
    v_rcp_f32 v210, v210
    v_rcp_f32 v211, v211
    v_rcp_f32 v212, v212
    v_rcp_f32 v213, v213
    v_rcp_f32 v214, v214
    v_rcp_f32 v215, v215
    v_pk_mul_f32 v[16:17], v[16:17], v[208:209]
    v_pk_mul_f32 v[18:19], v[18:19], v[210:211]
    v_pk_mul_f32 v[20:21], v[20:21], v[212:213]
    v_pk_mul_f32 v[22:23], v[22:23], v[214:215]
    v_pk_add_f32 v[184:185], v[184:185], v[16:17]
    v_pk_add_f32 v[186:187], v[186:187], v[18:19]
    v_pk_add_f32 v[188:189], v[188:189], v[20:21]
    v_pk_add_f32 v[190:191], v[190:191], v[22:23]
    v_pk_fma_f32 v[192:193], v[16:17], v[16:17], v[192:193]
    v_pk_fma_f32 v[194:195], v[18:19], v[18:19], v[194:195]
    v_pk_fma_f32 v[196:197], v[20:21], v[20:21], v[196:197]
    v_pk_fma_f32 v[198:199], v[22:23], v[22:23], v[198:199]
    s_waitcnt vmcnt(0)
    s_barrier
    s_cmp_lt_u32 s39, 9
    s_cselect_b32 s34, s60, 2146435072
    s_cmp_eq_u32 s30, 0
    s_cselect_b32 s34, s34, 2146435072
    v_mov_b32 v233, s34
    v_mov_b32 v234, 1
    s_mov_b64 exec, 1
    buffer_atomic_add v234, v233, s[48:51], 0 offen sc1
    s_mov_b64 exec, -1
    s_load_dwordx2 s[64:65], s[0:1], 64
    s_lshl_b32 s34, s2, 2
    s_add_u32 s34, s34, s30
    s_lshl_b32 s34, s34, 13
    v_lshlrev_b32 v233, 7, v1
    s_waitcnt lgkmcnt(0)
    s_mov_b32 s24, s64
    s_mov_b32 s25, s65
    s_mov_b32 s26, 8388608
    s_mov_b32 s27, 0x20000
    buffer_load_dword v120, v233, s[24:27], s34 offen
    v_pk_fma_f32 v[24:25], v[152:153], v[220:221], v[24:25] neg_lo:[1,0,0] neg_hi:[1,0,0]
    v_pk_fma_f32 v[26:27], v[154:155], v[220:221], v[26:27] neg_lo:[1,0,0] neg_hi:[1,0,0]
    v_pk_fma_f32 v[28:29], v[156:157], v[220:221], v[28:29] neg_lo:[1,0,0] neg_hi:[1,0,0]
    v_pk_fma_f32 v[30:31], v[158:159], v[220:221], v[30:31] neg_lo:[1,0,0] neg_hi:[1,0,0]
    v_pk_mul_f32 v[208:209], v[24:25], v[24:25]
    v_pk_mul_f32 v[210:211], v[26:27], v[26:27]
    v_pk_mul_f32 v[212:213], v[28:29], v[28:29]
    v_pk_mul_f32 v[214:215], v[30:31], v[30:31]
    v_pk_fma_f32 v[208:209], v[208:209], v[176:177], v[168:169]
    v_pk_fma_f32 v[210:211], v[210:211], v[178:179], v[170:171]
    v_pk_fma_f32 v[212:213], v[212:213], v[180:181], v[172:173]
    v_pk_fma_f32 v[214:215], v[214:215], v[182:183], v[174:175]
    v_pk_mul_f32 v[208:209], v[208:209], v[24:25]
    v_pk_mul_f32 v[210:211], v[210:211], v[26:27]
    v_pk_mul_f32 v[212:213], v[212:213], v[28:29]
    v_pk_mul_f32 v[214:215], v[214:215], v[30:31]
    v_exp_f32 v208, v208
    v_exp_f32 v209, v209
    v_exp_f32 v210, v210
    v_exp_f32 v211, v211
    v_exp_f32 v212, v212
    v_exp_f32 v213, v213
    v_exp_f32 v214, v214
    v_exp_f32 v215, v215
    v_pk_add_f32 v[208:209], v[208:209], v[228:229]
    v_pk_add_f32 v[210:211], v[210:211], v[228:229]
    v_pk_add_f32 v[212:213], v[212:213], v[228:229]
    v_pk_add_f32 v[214:215], v[214:215], v[228:229]
    v_rcp_f32 v208, v208
    v_rcp_f32 v209, v209
    v_rcp_f32 v210, v210
    v_rcp_f32 v211, v211
    v_rcp_f32 v212, v212
    v_rcp_f32 v213, v213
    v_rcp_f32 v214, v214
    v_rcp_f32 v215, v215
    v_pk_mul_f32 v[24:25], v[24:25], v[208:209]
    v_pk_mul_f32 v[26:27], v[26:27], v[210:211]
    v_pk_mul_f32 v[28:29], v[28:29], v[212:213]
    v_pk_mul_f32 v[30:31], v[30:31], v[214:215]
    v_pk_add_f32 v[184:185], v[184:185], v[24:25]
    v_pk_add_f32 v[186:187], v[186:187], v[26:27]
    v_pk_add_f32 v[188:189], v[188:189], v[28:29]
    v_pk_add_f32 v[190:191], v[190:191], v[30:31]
    v_pk_fma_f32 v[192:193], v[24:25], v[24:25], v[192:193]
    v_pk_fma_f32 v[194:195], v[26:27], v[26:27], v[194:195]
    v_pk_fma_f32 v[196:197], v[28:29], v[28:29], v[196:197]
    v_pk_fma_f32 v[198:199], v[30:31], v[30:31], v[198:199]
    v_pk_fma_f32 v[32:33], v[152:153], v[222:223], v[32:33] neg_lo:[1,0,0] neg_hi:[1,0,0]
    v_pk_fma_f32 v[34:35], v[154:155], v[222:223], v[34:35] neg_lo:[1,0,0] neg_hi:[1,0,0]
    v_pk_fma_f32 v[36:37], v[156:157], v[222:223], v[36:37] neg_lo:[1,0,0] neg_hi:[1,0,0]
    v_pk_fma_f32 v[38:39], v[158:159], v[222:223], v[38:39] neg_lo:[1,0,0] neg_hi:[1,0,0]
    v_pk_mul_f32 v[208:209], v[32:33], v[32:33]
    v_pk_mul_f32 v[210:211], v[34:35], v[34:35]
    v_pk_mul_f32 v[212:213], v[36:37], v[36:37]
    v_pk_mul_f32 v[214:215], v[38:39], v[38:39]
    v_pk_fma_f32 v[208:209], v[208:209], v[176:177], v[168:169]
    v_pk_fma_f32 v[210:211], v[210:211], v[178:179], v[170:171]
    v_pk_fma_f32 v[212:213], v[212:213], v[180:181], v[172:173]
    v_pk_fma_f32 v[214:215], v[214:215], v[182:183], v[174:175]
    v_pk_mul_f32 v[208:209], v[208:209], v[32:33]
    v_pk_mul_f32 v[210:211], v[210:211], v[34:35]
    v_pk_mul_f32 v[212:213], v[212:213], v[36:37]
    v_pk_mul_f32 v[214:215], v[214:215], v[38:39]
    v_exp_f32 v208, v208
    v_exp_f32 v209, v209
    v_exp_f32 v210, v210
    v_exp_f32 v211, v211
    v_exp_f32 v212, v212
    v_exp_f32 v213, v213
    v_exp_f32 v214, v214
    v_exp_f32 v215, v215
    v_pk_add_f32 v[208:209], v[208:209], v[228:229]
    v_pk_add_f32 v[210:211], v[210:211], v[228:229]
    v_pk_add_f32 v[212:213], v[212:213], v[228:229]
    v_pk_add_f32 v[214:215], v[214:215], v[228:229]
    v_rcp_f32 v208, v208
    v_rcp_f32 v209, v209
    v_rcp_f32 v210, v210
    v_rcp_f32 v211, v211
    v_rcp_f32 v212, v212
    v_rcp_f32 v213, v213
    v_rcp_f32 v214, v214
    v_rcp_f32 v215, v215
    v_pk_mul_f32 v[32:33], v[32:33], v[208:209]
    v_pk_mul_f32 v[34:35], v[34:35], v[210:211]
    v_pk_mul_f32 v[36:37], v[36:37], v[212:213]
    v_pk_mul_f32 v[38:39], v[38:39], v[214:215]
    v_pk_add_f32 v[184:185], v[184:185], v[32:33]
    v_pk_add_f32 v[186:187], v[186:187], v[34:35]
    v_pk_add_f32 v[188:189], v[188:189], v[36:37]
    v_pk_add_f32 v[190:191], v[190:191], v[38:39]
    v_pk_fma_f32 v[192:193], v[32:33], v[32:33], v[192:193]
    v_pk_fma_f32 v[194:195], v[34:35], v[34:35], v[194:195]
    v_pk_fma_f32 v[196:197], v[36:37], v[36:37], v[196:197]
    v_pk_fma_f32 v[198:199], v[38:39], v[38:39], v[198:199]
    v_pk_fma_f32 v[40:41], v[152:153], v[224:225], v[40:41] neg_lo:[1,0,0] neg_hi:[1,0,0]
    v_pk_fma_f32 v[42:43], v[154:155], v[224:225], v[42:43] neg_lo:[1,0,0] neg_hi:[1,0,0]
    v_pk_fma_f32 v[44:45], v[156:157], v[224:225], v[44:45] neg_lo:[1,0,0] neg_hi:[1,0,0]
    v_pk_fma_f32 v[46:47], v[158:159], v[224:225], v[46:47] neg_lo:[1,0,0] neg_hi:[1,0,0]
    v_pk_mul_f32 v[208:209], v[40:41], v[40:41]
    v_pk_mul_f32 v[210:211], v[42:43], v[42:43]
    v_pk_mul_f32 v[212:213], v[44:45], v[44:45]
    v_pk_mul_f32 v[214:215], v[46:47], v[46:47]
    v_pk_fma_f32 v[208:209], v[208:209], v[176:177], v[168:169]
    v_pk_fma_f32 v[210:211], v[210:211], v[178:179], v[170:171]
    v_pk_fma_f32 v[212:213], v[212:213], v[180:181], v[172:173]
    v_pk_fma_f32 v[214:215], v[214:215], v[182:183], v[174:175]
    v_pk_mul_f32 v[208:209], v[208:209], v[40:41]
    v_pk_mul_f32 v[210:211], v[210:211], v[42:43]
    v_pk_mul_f32 v[212:213], v[212:213], v[44:45]
    v_pk_mul_f32 v[214:215], v[214:215], v[46:47]
    v_exp_f32 v208, v208
    v_exp_f32 v209, v209
    v_exp_f32 v210, v210
    v_exp_f32 v211, v211
    v_exp_f32 v212, v212
    v_exp_f32 v213, v213
    v_exp_f32 v214, v214
    v_exp_f32 v215, v215
    v_pk_add_f32 v[208:209], v[208:209], v[228:229]
    v_pk_add_f32 v[210:211], v[210:211], v[228:229]
    v_pk_add_f32 v[212:213], v[212:213], v[228:229]
    v_pk_add_f32 v[214:215], v[214:215], v[228:229]
    v_rcp_f32 v208, v208
    v_rcp_f32 v209, v209
    v_rcp_f32 v210, v210
    v_rcp_f32 v211, v211
    v_rcp_f32 v212, v212
    v_rcp_f32 v213, v213
    v_rcp_f32 v214, v214
    v_rcp_f32 v215, v215
    v_pk_mul_f32 v[40:41], v[40:41], v[208:209]
    v_pk_mul_f32 v[42:43], v[42:43], v[210:211]
    v_pk_mul_f32 v[44:45], v[44:45], v[212:213]
    v_pk_mul_f32 v[46:47], v[46:47], v[214:215]
    v_pk_add_f32 v[184:185], v[184:185], v[40:41]
    v_pk_add_f32 v[186:187], v[186:187], v[42:43]
    v_pk_add_f32 v[188:189], v[188:189], v[44:45]
    v_pk_add_f32 v[190:191], v[190:191], v[46:47]
    v_pk_fma_f32 v[192:193], v[40:41], v[40:41], v[192:193]
    v_pk_fma_f32 v[194:195], v[42:43], v[42:43], v[194:195]
    v_pk_fma_f32 v[196:197], v[44:45], v[44:45], v[196:197]
    v_pk_fma_f32 v[198:199], v[46:47], v[46:47], v[198:199]
    v_mov_b32 v234, s60
recurrent_scan__ssm_conv_h3__mixer_gmlp__prompt_kernel_pc17:
    buffer_load_dword v233, v234, s[48:51], 0 offen sc1
    s_waitcnt vmcnt(0)
    v_readfirstlane_b32 s34, v233
    s_cmp_lt_u32 s34, 9
    s_cbranch_scc1 recurrent_scan__ssm_conv_h3__mixer_gmlp__prompt_kernel_pc17
    s_lshl_b32 s34, s32, 1
    s_add_u32 s34, s34, 1
    s_mul_i32 s34, s34, 5184
    s_add_u32 s34, s34, 1310720
    s_add_u32 s61, s34, 4032
    v_mov_b32 v234, 2146435072
    v_cmp_gt_u32 vcc, 36, v1
    s_nop 1
    v_cndmask_b32 v233, v234, v7, vcc
    buffer_load_dwordx4 v[80:83], v233, s[48:51], s34 offen offset:0 sc1
    buffer_load_dwordx4 v[84:87], v233, s[48:51], s34 offen offset:576 sc1
    buffer_load_dwordx4 v[88:91], v233, s[48:51], s34 offen offset:1152 sc1
    buffer_load_dwordx4 v[92:95], v233, s[48:51], s34 offen offset:1728 sc1
    buffer_load_dwordx4 v[96:99], v233, s[48:51], s34 offen offset:2304 sc1
    buffer_load_dwordx4 v[100:103], v233, s[48:51], s34 offen offset:2880 sc1
    buffer_load_dwordx4 v[104:107], v233, s[48:51], s34 offen offset:3456 sc1
    buffer_load_dwordx4 v[108:111], v233, s[48:51], s61 offen offset:0 sc1
    buffer_load_dwordx4 v[112:115], v233, s[48:51], s61 offen offset:576 sc1
    v_pk_fma_f32 v[48:49], v[152:153], v[226:227], v[48:49] neg_lo:[1,0,0] neg_hi:[1,0,0]
    v_pk_fma_f32 v[50:51], v[154:155], v[226:227], v[50:51] neg_lo:[1,0,0] neg_hi:[1,0,0]
    v_pk_fma_f32 v[52:53], v[156:157], v[226:227], v[52:53] neg_lo:[1,0,0] neg_hi:[1,0,0]
    v_pk_fma_f32 v[54:55], v[158:159], v[226:227], v[54:55] neg_lo:[1,0,0] neg_hi:[1,0,0]
    v_pk_mul_f32 v[208:209], v[48:49], v[48:49]
    v_pk_mul_f32 v[210:211], v[50:51], v[50:51]
    v_pk_mul_f32 v[212:213], v[52:53], v[52:53]
    v_pk_mul_f32 v[214:215], v[54:55], v[54:55]
    v_pk_fma_f32 v[208:209], v[208:209], v[176:177], v[168:169]
    v_pk_fma_f32 v[210:211], v[210:211], v[178:179], v[170:171]
    v_pk_fma_f32 v[212:213], v[212:213], v[180:181], v[172:173]
    v_pk_fma_f32 v[214:215], v[214:215], v[182:183], v[174:175]
    v_pk_mul_f32 v[208:209], v[208:209], v[48:49]
    v_pk_mul_f32 v[210:211], v[210:211], v[50:51]
    v_pk_mul_f32 v[212:213], v[212:213], v[52:53]
    v_pk_mul_f32 v[214:215], v[214:215], v[54:55]
    v_exp_f32 v208, v208
    v_exp_f32 v209, v209
    v_exp_f32 v210, v210
    v_exp_f32 v211, v211
    v_exp_f32 v212, v212
    v_exp_f32 v213, v213
    v_exp_f32 v214, v214
    v_exp_f32 v215, v215
    v_pk_add_f32 v[208:209], v[208:209], v[228:229]
    v_pk_add_f32 v[210:211], v[210:211], v[228:229]
    v_pk_add_f32 v[212:213], v[212:213], v[228:229]
    v_pk_add_f32 v[214:215], v[214:215], v[228:229]
    v_rcp_f32 v208, v208
    v_rcp_f32 v209, v209
    v_rcp_f32 v210, v210
    v_rcp_f32 v211, v211
    v_rcp_f32 v212, v212
    v_rcp_f32 v213, v213
    v_rcp_f32 v214, v214
    v_rcp_f32 v215, v215
    v_pk_mul_f32 v[48:49], v[48:49], v[208:209]
    v_pk_mul_f32 v[50:51], v[50:51], v[210:211]
    v_pk_mul_f32 v[52:53], v[52:53], v[212:213]
    v_pk_mul_f32 v[54:55], v[54:55], v[214:215]
    v_pk_add_f32 v[184:185], v[184:185], v[48:49]
    v_pk_add_f32 v[186:187], v[186:187], v[50:51]
    v_pk_add_f32 v[188:189], v[188:189], v[52:53]
    v_pk_add_f32 v[190:191], v[190:191], v[54:55]
    v_pk_fma_f32 v[192:193], v[48:49], v[48:49], v[192:193]
    v_pk_fma_f32 v[194:195], v[50:51], v[50:51], v[194:195]
    v_pk_fma_f32 v[196:197], v[52:53], v[52:53], v[196:197]
    v_pk_fma_f32 v[198:199], v[54:55], v[54:55], v[198:199]
    v_lshlrev_b32 v231, 2, v5
    ds_read_b32 v216, v231 offset:384
    ds_read_b32 v218, v231 offset:448
    ds_read_b32 v220, v231 offset:512
    s_waitcnt vmcnt(0)
    v_add_f32 v80, v80, v84
    v_add_f32 v81, v81, v85
    v_add_f32 v82, v82, v86
    v_add_f32 v83, v83, v87
    v_add_f32 v80, v80, v88
    v_add_f32 v81, v81, v89
    v_add_f32 v82, v82, v90
    v_add_f32 v83, v83, v91
    v_add_f32 v80, v80, v92
    v_add_f32 v81, v81, v93
    v_add_f32 v82, v82, v94
    v_add_f32 v83, v83, v95
    v_add_f32 v80, v80, v96
    v_add_f32 v81, v81, v97
    v_add_f32 v82, v82, v98
    v_add_f32 v83, v83, v99
    v_add_f32 v80, v80, v100
    v_add_f32 v81, v81, v101
    v_add_f32 v82, v82, v102
    v_add_f32 v83, v83, v103
    v_add_f32 v80, v80, v104
    v_add_f32 v81, v81, v105
    v_add_f32 v82, v82, v106
    v_add_f32 v83, v83, v107
    v_add_f32 v80, v80, v108
    v_add_f32 v81, v81, v109
    v_add_f32 v82, v82, v110
    v_add_f32 v83, v83, v111
    v_add_f32 v80, v80, v112
    v_add_f32 v81, v81, v113
    v_add_f32 v82, v82, v114
    v_add_f32 v83, v83, v115
    v_cmp_gt_u32 vcc, 36, v1
    s_and_saveexec_b64 s[62:63], vcc
    ds_write_b128 v7, v[80:83] offset:576
    s_mov_b64 exec, -1
    s_waitcnt lgkmcnt(0)
    v_mov_b32 v217, v216
    v_mov_b32 v219, v218
    v_mov_b32 v221, v220
    v_pk_fma_f32 v[56:57], v[152:153], v[216:217], v[56:57] neg_lo:[1,0,0] neg_hi:[1,0,0]
    v_pk_fma_f32 v[58:59], v[154:155], v[216:217], v[58:59] neg_lo:[1,0,0] neg_hi:[1,0,0]
    v_pk_fma_f32 v[60:61], v[156:157], v[216:217], v[60:61] neg_lo:[1,0,0] neg_hi:[1,0,0]
    v_pk_fma_f32 v[62:63], v[158:159], v[216:217], v[62:63] neg_lo:[1,0,0] neg_hi:[1,0,0]
    v_pk_mul_f32 v[208:209], v[56:57], v[56:57]
    v_pk_mul_f32 v[210:211], v[58:59], v[58:59]
    v_pk_mul_f32 v[212:213], v[60:61], v[60:61]
    v_pk_mul_f32 v[214:215], v[62:63], v[62:63]
    v_pk_fma_f32 v[208:209], v[208:209], v[176:177], v[168:169]
    v_pk_fma_f32 v[210:211], v[210:211], v[178:179], v[170:171]
    v_pk_fma_f32 v[212:213], v[212:213], v[180:181], v[172:173]
    v_pk_fma_f32 v[214:215], v[214:215], v[182:183], v[174:175]
    v_pk_mul_f32 v[208:209], v[208:209], v[56:57]
    v_pk_mul_f32 v[210:211], v[210:211], v[58:59]
    v_pk_mul_f32 v[212:213], v[212:213], v[60:61]
    v_pk_mul_f32 v[214:215], v[214:215], v[62:63]
    v_exp_f32 v208, v208
    v_exp_f32 v209, v209
    v_exp_f32 v210, v210
    v_exp_f32 v211, v211
    v_exp_f32 v212, v212
    v_exp_f32 v213, v213
    v_exp_f32 v214, v214
    v_exp_f32 v215, v215
    v_pk_add_f32 v[208:209], v[208:209], v[228:229]
    v_pk_add_f32 v[210:211], v[210:211], v[228:229]
    v_pk_add_f32 v[212:213], v[212:213], v[228:229]
    v_pk_add_f32 v[214:215], v[214:215], v[228:229]
    v_rcp_f32 v208, v208
    v_rcp_f32 v209, v209
    v_rcp_f32 v210, v210
    v_rcp_f32 v211, v211
    v_rcp_f32 v212, v212
    v_rcp_f32 v213, v213
    v_rcp_f32 v214, v214
    v_rcp_f32 v215, v215
    v_pk_mul_f32 v[56:57], v[56:57], v[208:209]
    v_pk_mul_f32 v[58:59], v[58:59], v[210:211]
    v_pk_mul_f32 v[60:61], v[60:61], v[212:213]
    v_pk_mul_f32 v[62:63], v[62:63], v[214:215]
    v_pk_add_f32 v[184:185], v[184:185], v[56:57]
    v_pk_add_f32 v[186:187], v[186:187], v[58:59]
    v_pk_add_f32 v[188:189], v[188:189], v[60:61]
    v_pk_add_f32 v[190:191], v[190:191], v[62:63]
    v_pk_fma_f32 v[192:193], v[56:57], v[56:57], v[192:193]
    v_pk_fma_f32 v[194:195], v[58:59], v[58:59], v[194:195]
    v_pk_fma_f32 v[196:197], v[60:61], v[60:61], v[196:197]
    v_pk_fma_f32 v[198:199], v[62:63], v[62:63], v[198:199]
    v_pk_fma_f32 v[64:65], v[152:153], v[218:219], v[64:65] neg_lo:[1,0,0] neg_hi:[1,0,0]
    v_pk_fma_f32 v[66:67], v[154:155], v[218:219], v[66:67] neg_lo:[1,0,0] neg_hi:[1,0,0]
    v_pk_fma_f32 v[68:69], v[156:157], v[218:219], v[68:69] neg_lo:[1,0,0] neg_hi:[1,0,0]
    v_pk_fma_f32 v[70:71], v[158:159], v[218:219], v[70:71] neg_lo:[1,0,0] neg_hi:[1,0,0]
    v_pk_mul_f32 v[208:209], v[64:65], v[64:65]
    v_pk_mul_f32 v[210:211], v[66:67], v[66:67]
    v_pk_mul_f32 v[212:213], v[68:69], v[68:69]
    v_pk_mul_f32 v[214:215], v[70:71], v[70:71]
    v_pk_fma_f32 v[208:209], v[208:209], v[176:177], v[168:169]
    v_pk_fma_f32 v[210:211], v[210:211], v[178:179], v[170:171]
    v_pk_fma_f32 v[212:213], v[212:213], v[180:181], v[172:173]
    v_pk_fma_f32 v[214:215], v[214:215], v[182:183], v[174:175]
    v_pk_mul_f32 v[208:209], v[208:209], v[64:65]
    v_pk_mul_f32 v[210:211], v[210:211], v[66:67]
    v_pk_mul_f32 v[212:213], v[212:213], v[68:69]
    v_pk_mul_f32 v[214:215], v[214:215], v[70:71]
    v_exp_f32 v208, v208
    v_exp_f32 v209, v209
    v_exp_f32 v210, v210
    v_exp_f32 v211, v211
    v_exp_f32 v212, v212
    v_exp_f32 v213, v213
    v_exp_f32 v214, v214
    v_exp_f32 v215, v215
    v_pk_add_f32 v[208:209], v[208:209], v[228:229]
    v_pk_add_f32 v[210:211], v[210:211], v[228:229]
    v_pk_add_f32 v[212:213], v[212:213], v[228:229]
    v_pk_add_f32 v[214:215], v[214:215], v[228:229]
    v_rcp_f32 v208, v208
    v_rcp_f32 v209, v209
    v_rcp_f32 v210, v210
    v_rcp_f32 v211, v211
    v_rcp_f32 v212, v212
    v_rcp_f32 v213, v213
    v_rcp_f32 v214, v214
    v_rcp_f32 v215, v215
    v_pk_mul_f32 v[64:65], v[64:65], v[208:209]
    v_pk_mul_f32 v[66:67], v[66:67], v[210:211]
    v_pk_mul_f32 v[68:69], v[68:69], v[212:213]
    v_pk_mul_f32 v[70:71], v[70:71], v[214:215]
    v_pk_add_f32 v[184:185], v[184:185], v[64:65]
    v_pk_add_f32 v[186:187], v[186:187], v[66:67]
    v_pk_add_f32 v[188:189], v[188:189], v[68:69]
    v_pk_add_f32 v[190:191], v[190:191], v[70:71]
    v_pk_fma_f32 v[192:193], v[64:65], v[64:65], v[192:193]
    v_pk_fma_f32 v[194:195], v[66:67], v[66:67], v[194:195]
    v_pk_fma_f32 v[196:197], v[68:69], v[68:69], v[196:197]
    v_pk_fma_f32 v[198:199], v[70:71], v[70:71], v[198:199]
    v_pk_fma_f32 v[72:73], v[152:153], v[220:221], v[72:73] neg_lo:[1,0,0] neg_hi:[1,0,0]
    v_pk_fma_f32 v[74:75], v[154:155], v[220:221], v[74:75] neg_lo:[1,0,0] neg_hi:[1,0,0]
    v_pk_fma_f32 v[76:77], v[156:157], v[220:221], v[76:77] neg_lo:[1,0,0] neg_hi:[1,0,0]
    v_pk_fma_f32 v[78:79], v[158:159], v[220:221], v[78:79] neg_lo:[1,0,0] neg_hi:[1,0,0]
    v_pk_mul_f32 v[208:209], v[72:73], v[72:73]
    v_pk_mul_f32 v[210:211], v[74:75], v[74:75]
    v_pk_mul_f32 v[212:213], v[76:77], v[76:77]
    v_pk_mul_f32 v[214:215], v[78:79], v[78:79]
    v_pk_fma_f32 v[208:209], v[208:209], v[176:177], v[168:169]
    v_pk_fma_f32 v[210:211], v[210:211], v[178:179], v[170:171]
    v_pk_fma_f32 v[212:213], v[212:213], v[180:181], v[172:173]
    v_pk_fma_f32 v[214:215], v[214:215], v[182:183], v[174:175]
    v_pk_mul_f32 v[208:209], v[208:209], v[72:73]
    v_pk_mul_f32 v[210:211], v[210:211], v[74:75]
    v_pk_mul_f32 v[212:213], v[212:213], v[76:77]
    v_pk_mul_f32 v[214:215], v[214:215], v[78:79]
    v_exp_f32 v208, v208
    v_exp_f32 v209, v209
    v_exp_f32 v210, v210
    v_exp_f32 v211, v211
    v_exp_f32 v212, v212
    v_exp_f32 v213, v213
    v_exp_f32 v214, v214
    v_exp_f32 v215, v215
    v_pk_add_f32 v[208:209], v[208:209], v[228:229]
    v_pk_add_f32 v[210:211], v[210:211], v[228:229]
    v_pk_add_f32 v[212:213], v[212:213], v[228:229]
    v_pk_add_f32 v[214:215], v[214:215], v[228:229]
    v_rcp_f32 v208, v208
    v_rcp_f32 v209, v209
    v_rcp_f32 v210, v210
    v_rcp_f32 v211, v211
    v_rcp_f32 v212, v212
    v_rcp_f32 v213, v213
    v_rcp_f32 v214, v214
    v_rcp_f32 v215, v215
    v_pk_mul_f32 v[72:73], v[72:73], v[208:209]
    v_pk_mul_f32 v[74:75], v[74:75], v[210:211]
    v_pk_mul_f32 v[76:77], v[76:77], v[212:213]
    v_pk_mul_f32 v[78:79], v[78:79], v[214:215]
    v_pk_add_f32 v[184:185], v[184:185], v[72:73]
    v_pk_add_f32 v[186:187], v[186:187], v[74:75]
    v_pk_add_f32 v[188:189], v[188:189], v[76:77]
    v_pk_add_f32 v[190:191], v[190:191], v[78:79]
    v_pk_fma_f32 v[192:193], v[72:73], v[72:73], v[192:193]
    v_pk_fma_f32 v[194:195], v[74:75], v[74:75], v[194:195]
    v_pk_fma_f32 v[196:197], v[76:77], v[76:77], v[196:197]
    v_pk_fma_f32 v[198:199], v[78:79], v[78:79], v[198:199]
    v_add_f32_dpp v184, v184, v184 row_ror:8 row_mask:0xf bank_mask:0xf
    v_add_f32_dpp v192, v192, v192 row_ror:8 row_mask:0xf bank_mask:0xf
    v_add_f32_dpp v185, v185, v185 row_ror:8 row_mask:0xf bank_mask:0xf
    v_add_f32_dpp v193, v193, v193 row_ror:8 row_mask:0xf bank_mask:0xf
    v_add_f32_dpp v186, v186, v186 row_ror:8 row_mask:0xf bank_mask:0xf
    v_add_f32_dpp v194, v194, v194 row_ror:8 row_mask:0xf bank_mask:0xf
    v_add_f32_dpp v187, v187, v187 row_ror:8 row_mask:0xf bank_mask:0xf
    v_add_f32_dpp v195, v195, v195 row_ror:8 row_mask:0xf bank_mask:0xf
    v_add_f32_dpp v188, v188, v188 row_ror:8 row_mask:0xf bank_mask:0xf
    v_add_f32_dpp v196, v196, v196 row_ror:8 row_mask:0xf bank_mask:0xf
    v_add_f32_dpp v189, v189, v189 row_ror:8 row_mask:0xf bank_mask:0xf
    v_add_f32_dpp v197, v197, v197 row_ror:8 row_mask:0xf bank_mask:0xf
    v_add_f32_dpp v190, v190, v190 row_ror:8 row_mask:0xf bank_mask:0xf
    v_add_f32_dpp v198, v198, v198 row_ror:8 row_mask:0xf bank_mask:0xf
    v_add_f32_dpp v191, v191, v191 row_ror:8 row_mask:0xf bank_mask:0xf
    v_add_f32_dpp v199, v199, v199 row_ror:8 row_mask:0xf bank_mask:0xf
    v_add_f32_dpp v184, v184, v184 row_ror:4 row_mask:0xf bank_mask:0xf
    v_add_f32_dpp v192, v192, v192 row_ror:4 row_mask:0xf bank_mask:0xf
    v_add_f32_dpp v185, v185, v185 row_ror:4 row_mask:0xf bank_mask:0xf
    v_add_f32_dpp v193, v193, v193 row_ror:4 row_mask:0xf bank_mask:0xf
    v_add_f32_dpp v186, v186, v186 row_ror:4 row_mask:0xf bank_mask:0xf
    v_add_f32_dpp v194, v194, v194 row_ror:4 row_mask:0xf bank_mask:0xf
    v_add_f32_dpp v187, v187, v187 row_ror:4 row_mask:0xf bank_mask:0xf
    v_add_f32_dpp v195, v195, v195 row_ror:4 row_mask:0xf bank_mask:0xf
    v_add_f32_dpp v188, v188, v188 row_ror:4 row_mask:0xf bank_mask:0xf
    v_add_f32_dpp v196, v196, v196 row_ror:4 row_mask:0xf bank_mask:0xf
    v_add_f32_dpp v189, v189, v189 row_ror:4 row_mask:0xf bank_mask:0xf
    v_add_f32_dpp v197, v197, v197 row_ror:4 row_mask:0xf bank_mask:0xf
    v_add_f32_dpp v190, v190, v190 row_ror:4 row_mask:0xf bank_mask:0xf
    v_add_f32_dpp v198, v198, v198 row_ror:4 row_mask:0xf bank_mask:0xf
    v_add_f32_dpp v191, v191, v191 row_ror:4 row_mask:0xf bank_mask:0xf
    v_add_f32_dpp v199, v199, v199 row_ror:4 row_mask:0xf bank_mask:0xf
    v_add_f32_dpp v184, v184, v184 row_ror:2 row_mask:0xf bank_mask:0xf
    v_add_f32_dpp v192, v192, v192 row_ror:2 row_mask:0xf bank_mask:0xf
    v_add_f32_dpp v185, v185, v185 row_ror:2 row_mask:0xf bank_mask:0xf
    v_add_f32_dpp v193, v193, v193 row_ror:2 row_mask:0xf bank_mask:0xf
    v_add_f32_dpp v186, v186, v186 row_ror:2 row_mask:0xf bank_mask:0xf
    v_add_f32_dpp v194, v194, v194 row_ror:2 row_mask:0xf bank_mask:0xf
    v_add_f32_dpp v187, v187, v187 row_ror:2 row_mask:0xf bank_mask:0xf
    v_add_f32_dpp v195, v195, v195 row_ror:2 row_mask:0xf bank_mask:0xf
    v_add_f32_dpp v188, v188, v188 row_ror:2 row_mask:0xf bank_mask:0xf
    v_add_f32_dpp v196, v196, v196 row_ror:2 row_mask:0xf bank_mask:0xf
    v_add_f32_dpp v189, v189, v189 row_ror:2 row_mask:0xf bank_mask:0xf
    v_add_f32_dpp v197, v197, v197 row_ror:2 row_mask:0xf bank_mask:0xf
    v_add_f32_dpp v190, v190, v190 row_ror:2 row_mask:0xf bank_mask:0xf
    v_add_f32_dpp v198, v198, v198 row_ror:2 row_mask:0xf bank_mask:0xf
    v_add_f32_dpp v191, v191, v191 row_ror:2 row_mask:0xf bank_mask:0xf
    v_add_f32_dpp v199, v199, v199 row_ror:2 row_mask:0xf bank_mask:0xf
    v_add_f32_dpp v184, v184, v184 row_ror:1 row_mask:0xf bank_mask:0xf
    v_add_f32_dpp v192, v192, v192 row_ror:1 row_mask:0xf bank_mask:0xf
    v_add_f32_dpp v185, v185, v185 row_ror:1 row_mask:0xf bank_mask:0xf
    v_add_f32_dpp v193, v193, v193 row_ror:1 row_mask:0xf bank_mask:0xf
    v_add_f32_dpp v186, v186, v186 row_ror:1 row_mask:0xf bank_mask:0xf
    v_add_f32_dpp v194, v194, v194 row_ror:1 row_mask:0xf bank_mask:0xf
    v_add_f32_dpp v187, v187, v187 row_ror:1 row_mask:0xf bank_mask:0xf
    v_add_f32_dpp v195, v195, v195 row_ror:1 row_mask:0xf bank_mask:0xf
    v_add_f32_dpp v188, v188, v188 row_ror:1 row_mask:0xf bank_mask:0xf
    v_add_f32_dpp v196, v196, v196 row_ror:1 row_mask:0xf bank_mask:0xf
    v_add_f32_dpp v189, v189, v189 row_ror:1 row_mask:0xf bank_mask:0xf
    v_add_f32_dpp v197, v197, v197 row_ror:1 row_mask:0xf bank_mask:0xf
    v_add_f32_dpp v190, v190, v190 row_ror:1 row_mask:0xf bank_mask:0xf
    v_add_f32_dpp v198, v198, v198 row_ror:1 row_mask:0xf bank_mask:0xf
    v_add_f32_dpp v191, v191, v191 row_ror:1 row_mask:0xf bank_mask:0xf
    v_add_f32_dpp v199, v199, v199 row_ror:1 row_mask:0xf bank_mask:0xf
    v_mul_f32 v200, v160, v160
    v_mul_f32 v168, v184, v160
    v_mul_f32 v201, v161, v161
    v_mul_f32 v170, v185, v161
    v_mul_f32 v202, v162, v162
    v_mul_f32 v172, v186, v162
    v_mul_f32 v203, v163, v163
    v_mul_f32 v174, v187, v163
    v_mul_f32 v204, v164, v164
    v_mul_f32 v176, v188, v164
    v_mul_f32 v205, v165, v165
    v_mul_f32 v178, v189, v165
    v_mul_f32 v206, v166, v166
    v_mul_f32 v180, v190, v166
    v_mul_f32 v207, v167, v167
    v_mul_f32 v182, v191, v167
    v_mul_f32 v169, v192, v200
    v_mul_f32 v171, v193, v201
    v_mul_f32 v173, v194, v202
    v_mul_f32 v175, v195, v203
    v_mul_f32 v177, v196, v204
    v_mul_f32 v179, v197, v205
    v_mul_f32 v181, v198, v206
    v_mul_f32 v183, v199, v207
    s_lshl_b32 s34, s39, 4
    s_add_u32 s34, s34, s32
    s_lshl_b32 s34, s34, 10
    v_lshl_add_u32 v233, v230, 1, s34
    v_mov_b32 v234, 2146435072
    v_cmp_eq_u32 vcc, 0, v5
    s_nop 1
    v_cndmask_b32 v233, v234, v233, vcc
    buffer_store_dwordx4 v[168:171], v233, s[48:51], 0 offen offset:0 sc1
    buffer_store_dwordx4 v[172:175], v233, s[48:51], 0 offen offset:16 sc1
    buffer_store_dwordx4 v[176:179], v233, s[48:51], 0 offen offset:32 sc1
    buffer_store_dwordx4 v[180:183], v233, s[48:51], 0 offen offset:48 sc1
    s_waitcnt vmcnt(0)
    v_mov_b32 v233, 1152
    v_mov_b32 v234, 1
    s_mov_b64 exec, 1
    ds_add_rtn_u32 v233, v233, v234
    s_waitcnt lgkmcnt(0)
    v_readfirstlane_b32 s34, v233
    s_lshl_b32 s59, s39, 8
    s_add_u32 s59, s59, 1839104
    s_cmp_eq_u32 s34, 3
    s_cselect_b32 s34, s59, 2146435072
    v_mov_b32 v233, s34
    buffer_atomic_add v234, v233, s[48:51], 0 offen sc1
    s_mov_b64 exec, -1
    v_mov_b32 v234, s59
    buffer_load_dword v233, v234, s[48:51], 0 offen sc1
    s_barrier
    s_branch recurrent_scan__ssm_conv_h3__mixer_gmlp__prompt_kernel_dz6
    s_waitcnt lgkmcnt(0)
    s_mul_i32 s34, s30, 10240
    s_add_u32 s34, s34, 87552
    v_add_u32 v2, s34, v7
    s_barrier
    ds_read_b128 v[112:115], v2 offset:0
    ds_read_b128 v[116:119], v2 offset:1024
    ds_read_b128 v[120:123], v2 offset:2048
    ds_read_b128 v[124:127], v2 offset:3072
    ds_read_b128 v[128:131], v2 offset:4096
    ds_read_b128 v[132:135], v2 offset:5120
    ds_read_b128 v[136:139], v2 offset:6144
    ds_read_b128 v[140:143], v2 offset:7168
    ds_read_b128 v[144:147], v2 offset:8192
    ds_read_b128 v[148:151], v2 offset:9216
recurrent_scan__ssm_conv_h3__mixer_gmlp__prompt_kernel_B2:
    v_xor_b32 v252, 64, v249
    v_mov_b32 v92, 0
    v_mov_b32 v93, 0
    v_mov_b32 v94, 0
    v_mov_b32 v95, 0
    v_mov_b32 v2, 1152
    ds_write_b32 v2, v92
    v_mov_b32 v2, 160768
    ds_write_b64 v2, v[92:93]
    s_waitcnt lgkmcnt(0)
    s_sub_u32 s8, s4, 4096
    s_subb_u32 s9, s5, 0
    s_mov_b32 s10, 2363392
    s_mov_b32 s11, 0x20000
    s_add_u32 s48, s42, 67108864
    s_addc_u32 s49, s43, 0
    s_mov_b32 s50, 2097152
    s_mov_b32 s51, 0x20000
    s_mov_b32 s44, s40
    s_mov_b32 s45, s41
    s_mov_b32 s46, 256
    s_mov_b32 s47, 0x20000
    s_cmp_ge_u32 s30, 2
    s_cbranch_scc1 recurrent_scan__ssm_conv_h3__mixer_gmlp__prompt_kernel_xload8
    s_sub_u32 s12, s6, 4096
    s_subb_u32 s13, s7, 0
    s_mov_b32 s14, 5312512
    s_mov_b32 s15, 0x20000
    s_mul_i32 s37, s32, 288
    s_add_u32 s37, s37, 4608
    s_mov_b32 s54, 3641
    v_add_u32 v2, 0, v1
    v_mul_lo_u32 v3, v2, s54
    v_lshrrev_b32 v3, 16, v3
    v_mul_u32_u24 v4, 18, v3
    v_sub_u32 v2, v2, v4
    v_and_b32 v4, 0x13, v3
    v_and_b32 v80, 4, v3
    v_lshl_or_b32 v4, v80, 1, v4
    v_and_b32 v80, 8, v3
    v_lshrrev_b32 v80, 1, v80
    v_or_b32 v4, v4, v80
    v_mul_u32_u24 v4, 9216, v4
    v_lshl_add_u32 v4, v2, 4, v4
    v_add_u32 v4, s37, v4
    v_add_u32 v80, 4096, v4
    v_add_u32 v2, 64, v1
    v_mul_lo_u32 v3, v2, s54
    v_lshrrev_b32 v3, 16, v3
    v_mul_u32_u24 v4, 18, v3
    v_sub_u32 v2, v2, v4
    v_and_b32 v4, 0x13, v3
    v_and_b32 v81, 4, v3
    v_lshl_or_b32 v4, v81, 1, v4
    v_and_b32 v81, 8, v3
    v_lshrrev_b32 v81, 1, v81
    v_or_b32 v4, v4, v81
    v_mul_u32_u24 v4, 9216, v4
    v_lshl_add_u32 v4, v2, 4, v4
    v_add_u32 v4, s37, v4
    v_add_u32 v81, 3072, v4
    v_add_u32 v2, 128, v1
    v_mul_lo_u32 v3, v2, s54
    v_lshrrev_b32 v3, 16, v3
    v_mul_u32_u24 v4, 18, v3
    v_sub_u32 v2, v2, v4
    v_and_b32 v4, 0x13, v3
    v_and_b32 v82, 4, v3
    v_lshl_or_b32 v4, v82, 1, v4
    v_and_b32 v82, 8, v3
    v_lshrrev_b32 v82, 1, v82
    v_or_b32 v4, v4, v82
    v_mul_u32_u24 v4, 9216, v4
    v_lshl_add_u32 v4, v2, 4, v4
    v_add_u32 v4, s37, v4
    v_add_u32 v82, 2048, v4
    v_add_u32 v2, 192, v1
    v_mul_lo_u32 v3, v2, s54
    v_lshrrev_b32 v3, 16, v3
    v_mul_u32_u24 v4, 18, v3
    v_sub_u32 v2, v2, v4
    v_and_b32 v4, 0x13, v3
    v_and_b32 v83, 4, v3
    v_lshl_or_b32 v4, v83, 1, v4
    v_and_b32 v83, 8, v3
    v_lshrrev_b32 v83, 1, v83
    v_or_b32 v4, v4, v83
    v_mul_u32_u24 v4, 9216, v4
    v_lshl_add_u32 v4, v2, 4, v4
    v_add_u32 v4, s37, v4
    v_add_u32 v83, 1024, v4
    v_add_u32 v2, 256, v1
    v_mul_lo_u32 v3, v2, s54
    v_lshrrev_b32 v3, 16, v3
    v_mul_u32_u24 v4, 18, v3
    v_sub_u32 v2, v2, v4
    v_and_b32 v4, 0x13, v3
    v_and_b32 v84, 4, v3
    v_lshl_or_b32 v4, v84, 1, v4
    v_and_b32 v84, 8, v3
    v_lshrrev_b32 v84, 1, v84
    v_or_b32 v4, v4, v84
    v_mul_u32_u24 v4, 9216, v4
    v_lshl_add_u32 v4, v2, 4, v4
    v_add_u32 v4, s37, v4
    v_add_u32 v84, 4096, v4
    v_add_u32 v2, 320, v1
    v_mul_lo_u32 v3, v2, s54
    v_lshrrev_b32 v3, 16, v3
    v_mul_u32_u24 v4, 18, v3
    v_sub_u32 v2, v2, v4
    v_and_b32 v4, 0x13, v3
    v_and_b32 v85, 4, v3
    v_lshl_or_b32 v4, v85, 1, v4
    v_and_b32 v85, 8, v3
    v_lshrrev_b32 v85, 1, v85
    v_or_b32 v4, v4, v85
    v_mul_u32_u24 v4, 9216, v4
    v_lshl_add_u32 v4, v2, 4, v4
    v_add_u32 v4, s37, v4
    v_add_u32 v85, 3072, v4
    v_add_u32 v2, 384, v1
    v_mul_lo_u32 v3, v2, s54
    v_lshrrev_b32 v3, 16, v3
    v_mul_u32_u24 v4, 18, v3
    v_sub_u32 v2, v2, v4
    v_and_b32 v4, 0x13, v3
    v_and_b32 v86, 4, v3
    v_lshl_or_b32 v4, v86, 1, v4
    v_and_b32 v86, 8, v3
    v_lshrrev_b32 v86, 1, v86
    v_or_b32 v4, v4, v86
    v_mul_u32_u24 v4, 9216, v4
    v_lshl_add_u32 v4, v2, 4, v4
    v_add_u32 v4, s37, v4
    v_add_u32 v86, 2048, v4
    v_add_u32 v2, 448, v1
    v_mul_lo_u32 v3, v2, s54
    v_lshrrev_b32 v3, 16, v3
    v_mul_u32_u24 v4, 18, v3
    v_sub_u32 v2, v2, v4
    v_and_b32 v4, 0x13, v3
    v_and_b32 v87, 4, v3
    v_lshl_or_b32 v4, v87, 1, v4
    v_and_b32 v87, 8, v3
    v_lshrrev_b32 v87, 1, v87
    v_or_b32 v4, v4, v87
    v_mul_u32_u24 v4, 9216, v4
    v_lshl_add_u32 v4, v2, 4, v4
    v_add_u32 v4, s37, v4
    v_add_u32 v87, 1024, v4
    v_add_u32 v2, 512, v1
    v_mul_lo_u32 v3, v2, s54
    v_lshrrev_b32 v3, 16, v3
    v_mul_u32_u24 v4, 18, v3
    v_sub_u32 v2, v2, v4
    v_and_b32 v4, 0x13, v3
    v_and_b32 v88, 4, v3
    v_lshl_or_b32 v4, v88, 1, v4
    v_and_b32 v88, 8, v3
    v_lshrrev_b32 v88, 1, v88
    v_or_b32 v4, v4, v88
    v_mul_u32_u24 v4, 9216, v4
    v_lshl_add_u32 v4, v2, 4, v4
    v_add_u32 v4, s37, v4
    v_add_u32 v88, 4096, v4
    s_lshl_b32 s38, s56, 1
    s_add_u32 s38, s38, s30
    s_mul_i32 s38, s38, 294912
    s_mul_i32 s52, s30, 9216
    s_add_u32 s59, s52, 4608
    s_add_u32 m0, s59, 0
    s_nop 0
    buffer_load_dwordx4 v80, s[12:15], s38 offen offset:0 lds
    buffer_load_dwordx4 v81, s[12:15], s38 offen offset:1024 lds
    buffer_load_dwordx4 v82, s[12:15], s38 offen offset:2048 lds
    buffer_load_dwordx4 v83, s[12:15], s38 offen offset:3072 lds
    s_add_u32 m0, s59, 4096
    s_nop 0
    buffer_load_dwordx4 v84, s[12:15], s38 offen offset:0 lds
    buffer_load_dwordx4 v85, s[12:15], s38 offen offset:1024 lds
    buffer_load_dwordx4 v86, s[12:15], s38 offen offset:2048 lds
    buffer_load_dwordx4 v87, s[12:15], s38 offen offset:3072 lds
    s_add_u32 m0, s59, 8192
    s_nop 0
    buffer_load_dwordx4 v88, s[12:15], s38 offen offset:0 lds
    s_add_u32 s38, s38, 589824
    s_cmp_ge_u32 s38, 5308416
    s_cselect_b32 s34, 5308416, 0
    s_sub_u32 s38, s38, s34
    s_lshl_b32 s34, s32, 3
    s_add_u32 s34, s34, s31
    s_lshl_b32 s59, s30, 1
    s_add_u32 s34, s34, s59
    v_lshrrev_b32 v2, 5, v1
    v_add_u32 v136, s34, v2
    v_mul_u32_u24 v2, 1152, v136
    v_and_b32 v3, 31, v1
    v_lshl_add_u32 v2, v3, 4, v2
    v_add_u32 v2, 4096, v2
    v_cmp_gt_u32 vcc, 8, v3
    v_mov_b32 v3, 2146435072
    s_nop 0
    v_cndmask_b32 v4, v3, v2, vcc
    buffer_load_dwordx4 v[200:203], v2, s[8:11], 0 offen offset:0
    buffer_load_dwordx4 v[204:207], v2, s[8:11], 0 offen offset:512
    buffer_load_dwordx4 v[208:211], v4, s[8:11], 0 offen offset:1024
    s_lshl_b32 s34, s39, 8
    s_lshl_b32 s59, s32, 8
    v_mov_b32 v137, s34
    v_mov_b32 v2, s59
    v_cmp_lt_u32 vcc, 1, v1
    s_nop 1
    v_cndmask_b32 v137, v137, v2, vcc
    v_lshl_add_u32 v137, v1, 12, v137
    v_add_u32 v137, 1835008, v137
    v_cmp_gt_u32 vcc, 4, v1
    s_nop 1
    v_cndmask_b32 v138, v3, 0, vcc
    v_cndmask_b32 v137, v3, v137, vcc
    s_lshl_b32 s34, s30, 8
    s_add_u32 s34, s34, s2
    s_cmp_eq_u32 s34, 512
    s_mov_b32 s60, 2146435072
    s_cselect_b32 s60, 1835008, s60
    s_mov_b32 s61, 2146435072
    s_cselect_b32 s61, 0, s61
    v_add_u32 v140, s61, v138
    v_lshlrev_b32 v4, 8, v1
    v_mov_b32 v139, 0
    buffer_store_dword v139, v4, s[48:51], s60 offen sc1
    v_add_u32 v4, 16384, v4
    buffer_store_dword v139, v4, s[48:51], s60 offen sc1
    v_add_u32 v4, 16384, v4
    buffer_store_dword v139, v4, s[48:51], s60 offen sc1
    v_lshrrev_b32 v4, 2, v1
    v_lshlrev_b32 v4, 8, v4
    v_and_b32 v2, 3, v1
    v_lshl_add_u32 v4, v2, 4, v4
    v_add_u32 v4, 0x8000, v4
    v_mov_b32 v124, 0
    v_mov_b32 v125, 0
    v_mov_b32 v126, 0
    v_mov_b32 v127, 0
    buffer_store_dwordx4 v[124:127], v4, s[48:51], s60 offen sc1
    v_add_u32 v4, 0x1000, v4
    buffer_store_dwordx4 v[124:127], v4, s[48:51], s60 offen sc1
    s_add_u32 s59, s52, 23040
    s_add_u32 m0, s59, 0
    s_nop 0
    buffer_load_dwordx4 v80, s[12:15], s38 offen offset:0 lds
    buffer_load_dwordx4 v81, s[12:15], s38 offen offset:1024 lds
    buffer_load_dwordx4 v82, s[12:15], s38 offen offset:2048 lds
    buffer_load_dwordx4 v83, s[12:15], s38 offen offset:3072 lds
    s_add_u32 m0, s59, 4096
    s_nop 0
    buffer_load_dwordx4 v84, s[12:15], s38 offen offset:0 lds
    buffer_load_dwordx4 v85, s[12:15], s38 offen offset:1024 lds
    buffer_load_dwordx4 v86, s[12:15], s38 offen offset:2048 lds
    buffer_load_dwordx4 v87, s[12:15], s38 offen offset:3072 lds
    s_add_u32 m0, s59, 8192
    s_nop 0
    buffer_load_dwordx4 v88, s[12:15], s38 offen offset:0 lds
    s_add_u32 s38, s38, 589824
    s_cmp_ge_u32 s38, 5308416
    s_cselect_b32 s34, 5308416, 0
    s_sub_u32 s38, s38, s34
    s_waitcnt vmcnt(17)
    s_waitcnt lgkmcnt(0)
    s_barrier
    s_add_u32 s59, s52, 41472
    s_add_u32 m0, s59, 0
    s_nop 0
    buffer_load_dwordx4 v80, s[12:15], s38 offen offset:0 lds
    buffer_load_dwordx4 v81, s[12:15], s38 offen offset:1024 lds
    buffer_load_dwordx4 v82, s[12:15], s38 offen offset:2048 lds
    buffer_load_dwordx4 v83, s[12:15], s38 offen offset:3072 lds
    s_add_u32 m0, s59, 4096
    s_nop 0
    buffer_load_dwordx4 v84, s[12:15], s38 offen offset:0 lds
    buffer_load_dwordx4 v85, s[12:15], s38 offen offset:1024 lds
    buffer_load_dwordx4 v86, s[12:15], s38 offen offset:2048 lds
    buffer_load_dwordx4 v87, s[12:15], s38 offen offset:3072 lds
    s_add_u32 m0, s59, 8192
    s_nop 0
    buffer_load_dwordx4 v88, s[12:15], s38 offen offset:0 lds
    s_add_u32 s38, s38, 589824
    s_cmp_ge_u32 s38, 5308416
    s_cselect_b32 s34, 5308416, 0
    s_sub_u32 s38, s38, s34
    ds_read_b128 v[8:11], v249 offset:0
    ds_read_b128 v[12:15], v249 offset:512
    ds_read_b128 v[16:19], v252 offset:0
    ds_read_b128 v[20:23], v252 offset:512
    s_lshr_b32 s34, s30, 1
    s_mul_i32 s34, s34, 9216
    s_and_b32 s59, s30, 1
    s_mul_i32 s59, s59, 160
    s_add_u32 s34, s34, s59
    v_add_u32 v2, s34, v248
    ds_read_b64_tr_b16 v[92:93], v2 offset:0
    ds_read_b64_tr_b16 v[94:95], v2 offset:2304
    ds_read_b64_tr_b16 v[96:97], v2 offset:32
    ds_read_b64_tr_b16 v[98:99], v2 offset:2336
    ds_read_b64_tr_b16 v[100:101], v2 offset:64
    ds_read_b64_tr_b16 v[102:103], v2 offset:2368
    ds_read_b64_tr_b16 v[104:105], v2 offset:96
    ds_read_b64_tr_b16 v[106:107], v2 offset:2400
    ds_read_b64_tr_b16 v[108:109], v2 offset:128
    ds_read_b64_tr_b16 v[110:111], v2 offset:2432
    v_mov_b32 v128, 0
    v_mov_b32 v129, 0
    v_mov_b32 v130, 0
    v_mov_b32 v131, 0
    v_mov_b32 v132, 0
    s_lshl_b32 s59, s59, 1
    s_lshr_b32 s34, s30, 1
    s_mul_i32 s34, s34, 640
    s_add_u32 s59, s59, s34
    v_lshlrev_b32 v3, 2, v5
    v_add_u32 v3, s59, v3
    s_waitcnt lgkmcnt(0)
    v_dot2_f32_bf16 v128, v92, s53, v128
    v_dot2_f32_bf16 v129, v96, s53, v129
    v_dot2_f32_bf16 v130, v100, s53, v130
    v_dot2_f32_bf16 v131, v104, s53, v131
    v_dot2_f32_bf16 v132, v108, s53, v132
    v_dot2_f32_bf16 v128, v93, s53, v128
    v_dot2_f32_bf16 v129, v97, s53, v129
    v_dot2_f32_bf16 v130, v101, s53, v130
    v_dot2_f32_bf16 v131, v105, s53, v131
    v_dot2_f32_bf16 v132, v109, s53, v132
    v_dot2_f32_bf16 v128, v94, s53, v128
    v_dot2_f32_bf16 v129, v98, s53, v129
    v_dot2_f32_bf16 v130, v102, s53, v130
    v_dot2_f32_bf16 v131, v106, s53, v131
    v_dot2_f32_bf16 v132, v110, s53, v132
    v_dot2_f32_bf16 v128, v95, s53, v128
    v_dot2_f32_bf16 v129, v99, s53, v129
    v_dot2_f32_bf16 v130, v103, s53, v130
    v_dot2_f32_bf16 v131, v107, s53, v131
    v_dot2_f32_bf16 v132, v111, s53, v132
    v_mov_b32 v92, v128
    v_mov_b32 v93, v129
    v_mov_b32 v94, v130
    v_mov_b32 v95, v131
    v_mov_b32 v96, v132
    v_permlane32_swap_b32 v128, v92
    v_permlane32_swap_b32 v129, v93
    v_permlane32_swap_b32 v130, v94
    v_permlane32_swap_b32 v131, v95
    v_permlane32_swap_b32 v132, v96
    v_add_f32 v128, v128, v92
    v_add_f32 v129, v129, v93
    v_add_f32 v130, v130, v94
    v_add_f32 v131, v131, v95
    v_add_f32 v132, v132, v96
    v_mov_b32 v92, v128
    v_mov_b32 v93, v129
    v_mov_b32 v94, v130
    v_mov_b32 v95, v131
    v_mov_b32 v96, v132
    v_permlane16_swap_b32 v128, v92
    v_permlane16_swap_b32 v129, v93
    v_permlane16_swap_b32 v130, v94
    v_permlane16_swap_b32 v131, v95
    v_permlane16_swap_b32 v132, v96
    v_add_f32 v128, v128, v92
    v_add_f32 v129, v129, v93
    v_add_f32 v130, v130, v94
    v_add_f32 v131, v131, v95
    v_add_f32 v132, v132, v96
    ds_write_b32 v3, v128 offset:3328
    ds_write_b32 v3, v129 offset:3392
    ds_write_b32 v3, v130 offset:3456
    ds_write_b32 v3, v131 offset:3520
    ds_write_b32 v3, v132 offset:3584
    s_waitcnt vmcnt(9)
    s_waitcnt lgkmcnt(0)
    s_barrier
    s_add_u32 s59, s52, 59904
    s_add_u32 m0, s59, 0
    s_nop 0
    buffer_load_dwordx4 v80, s[12:15], s38 offen offset:0 lds
    buffer_load_dwordx4 v81, s[12:15], s38 offen offset:1024 lds
    buffer_load_dwordx4 v82, s[12:15], s38 offen offset:2048 lds
    buffer_load_dwordx4 v83, s[12:15], s38 offen offset:3072 lds
    s_add_u32 m0, s59, 4096
    s_nop 0
    buffer_load_dwordx4 v84, s[12:15], s38 offen offset:0 lds
    buffer_load_dwordx4 v85, s[12:15], s38 offen offset:1024 lds
    buffer_load_dwordx4 v86, s[12:15], s38 offen offset:2048 lds
    buffer_load_dwordx4 v87, s[12:15], s38 offen offset:3072 lds
    s_add_u32 m0, s59, 8192
    s_nop 0
    buffer_load_dwordx4 v88, s[12:15], s38 offen offset:0 lds
    s_add_u32 s38, s38, 589824
    s_cmp_ge_u32 s38, 5308416
    s_cselect_b32 s34, 5308416, 0
    s_sub_u32 s38, s38, s34
    s_cmp_eq_u32 s30, 0
    s_cselect_b32 s59, 73728, 0
    s_add_u32 s59, s59, 4608
    s_add_u32 m0, s59, 0
    s_nop 0
    buffer_load_dwordx4 v80, s[12:15], s38 offen offset:0 lds
    buffer_load_dwordx4 v81, s[12:15], s38 offen offset:1024 lds
    buffer_load_dwordx4 v82, s[12:15], s38 offen offset:2048 lds
    buffer_load_dwordx4 v83, s[12:15], s38 offen offset:3072 lds
    s_add_u32 m0, s59, 4096
    s_nop 0
    buffer_load_dwordx4 v84, s[12:15], s38 offen offset:0 lds
    buffer_load_dwordx4 v85, s[12:15], s38 offen offset:1024 lds
    buffer_load_dwordx4 v86, s[12:15], s38 offen offset:2048 lds
    buffer_load_dwordx4 v87, s[12:15], s38 offen offset:3072 lds
    s_add_u32 m0, s59, 8192
    s_nop 0
    buffer_load_dwordx4 v88, s[12:15], s38 offen offset:0 lds
    s_add_u32 s38, s38, 589824
    s_cmp_ge_u32 s38, 5308416
    s_cselect_b32 s34, 5308416, 0
    s_sub_u32 s38, s38, s34
    ds_read_b128 v[24:27], v249 offset:16384
    ds_read_b128 v[28:31], v249 offset:16896
    ds_read_b128 v[32:35], v252 offset:16384
    ds_read_b128 v[36:39], v252 offset:16896
    v_mov_b32 v139, 1
    buffer_store_dword v139, v140, s[44:47], 0 offen sc1
    ds_read_b128 v[92:95], v7 offset:3328
    ds_read_b128 v[96:99], v7 offset:3968
    s_lshl_b32 s34, s32, 1
    s_add_u32 s34, s34, 0
    s_mul_i32 s34, s34, 9
    s_add_u32 s34, s34, s56
    s_mul_i32 s34, s34, 576
    s_add_u32 s34, s34, 1310720
    s_cmp_lt_u32 s39, 9
    s_cselect_b32 s34, s34, 2146435072
    s_cmp_eq_u32 s30, 0
    s_cselect_b32 s34, s34, 2146435072
    v_mov_b32 v3, 2146435072
    v_cmp_gt_u32 vcc, 36, v1
    s_nop 1
    v_cndmask_b32 v2, v3, v7, vcc
    s_waitcnt lgkmcnt(0)
    v_add_f32 v92, v92, v96
    v_add_f32 v93, v93, v97
    v_add_f32 v94, v94, v98
    v_add_f32 v95, v95, v99
    buffer_store_dwordx4 v[92:95], v2, s[48:51], s34 offen sc1
    v_mov_b32 v100, 0
    v_mov_b32 v101, 0
    v_mov_b32 v102, 0
    v_mov_b32 v103, 0
    v_dot2_f32_bf16 v100, v200, s53, v100
    v_dot2_f32_bf16 v102, v200, v200, v102
    v_dot2_f32_bf16 v101, v201, s53, v101
    v_dot2_f32_bf16 v103, v201, v201, v103
    v_dot2_f32_bf16 v100, v202, s53, v100
    v_dot2_f32_bf16 v102, v202, v202, v102
    v_dot2_f32_bf16 v101, v203, s53, v101
    v_dot2_f32_bf16 v103, v203, v203, v103
    v_dot2_f32_bf16 v100, v204, s53, v100
    v_dot2_f32_bf16 v102, v204, v204, v102
    v_dot2_f32_bf16 v101, v205, s53, v101
    v_dot2_f32_bf16 v103, v205, v205, v103
    v_dot2_f32_bf16 v100, v206, s53, v100
    v_dot2_f32_bf16 v102, v206, v206, v102
    v_dot2_f32_bf16 v101, v207, s53, v101
    v_dot2_f32_bf16 v103, v207, v207, v103
    v_dot2_f32_bf16 v100, v208, s53, v100
    v_dot2_f32_bf16 v102, v208, v208, v102
    v_dot2_f32_bf16 v101, v209, s53, v101
    v_dot2_f32_bf16 v103, v209, v209, v103
    v_dot2_f32_bf16 v100, v210, s53, v100
    v_dot2_f32_bf16 v102, v210, v210, v102
    v_dot2_f32_bf16 v101, v211, s53, v101
    v_dot2_f32_bf16 v103, v211, v211, v103
    s_nop 1
    v_add_f32 v134, v100, v101
    v_add_f32 v135, v102, v103
    s_waitcnt vmcnt(20)
    s_waitcnt lgkmcnt(0)
    s_barrier
    s_add_u32 s59, s52, 13824
    s_add_u32 m0, s59, 0
    s_nop 0
    buffer_load_dwordx4 v80, s[12:15], s38 offen offset:0 lds
    buffer_load_dwordx4 v81, s[12:15], s38 offen offset:1024 lds
    buffer_load_dwordx4 v82, s[12:15], s38 offen offset:2048 lds
    buffer_load_dwordx4 v83, s[12:15], s38 offen offset:3072 lds
    s_add_u32 m0, s59, 4096
    s_nop 0
    buffer_load_dwordx4 v84, s[12:15], s38 offen offset:0 lds
    buffer_load_dwordx4 v85, s[12:15], s38 offen offset:1024 lds
    buffer_load_dwordx4 v86, s[12:15], s38 offen offset:2048 lds
    buffer_load_dwordx4 v87, s[12:15], s38 offen offset:3072 lds
    s_add_u32 m0, s59, 8192
    s_nop 0
    buffer_load_dwordx4 v88, s[12:15], s38 offen offset:0 lds
    s_add_u32 s38, s38, 589824
    s_cmp_ge_u32 s38, 5308416
    s_cselect_b32 s34, 5308416, 0
    s_sub_u32 s38, s38, s34
    ds_read_b128 v[40:43], v249 offset:32768
    ds_read_b128 v[44:47], v249 offset:33280
    ds_read_b128 v[48:51], v252 offset:32768
    ds_read_b128 v[52:55], v252 offset:33280
    v_add_f32_dpp v134, v134, v134 row_ror:8 row_mask:0xf bank_mask:0xf
    v_add_f32_dpp v135, v135, v135 row_ror:8 row_mask:0xf bank_mask:0xf
    s_nop 0
    v_add_f32_dpp v134, v134, v134 row_ror:4 row_mask:0xf bank_mask:0xf
    v_add_f32_dpp v135, v135, v135 row_ror:4 row_mask:0xf bank_mask:0xf
    s_nop 0
    v_add_f32_dpp v134, v134, v134 row_ror:2 row_mask:0xf bank_mask:0xf
    v_add_f32_dpp v135, v135, v135 row_ror:2 row_mask:0xf bank_mask:0xf
    s_nop 0
    v_add_f32_dpp v134, v134, v134 row_ror:1 row_mask:0xf bank_mask:0xf
    v_add_f32_dpp v135, v135, v135 row_ror:1 row_mask:0xf bank_mask:0xf
    v_mov_b32 v96, v134
    v_mov_b32 v97, v135
    s_nop 0
    v_permlane16_swap_b32 v134, v96
    v_permlane16_swap_b32 v135, v97
    v_add_f32 v134, v134, v96
    v_add_f32 v135, v135, v97
    v_mul_f32 v134, 0x3ae38e39, v134
    v_mul_f32 v135, 0x3ae38e39, v135
    v_fma_f32 v135, -v134, v134, v135
    v_max_f32 v135, 0, v135
    v_cvt_pk_bf16_f32 v2, v134, v135
    v_lshlrev_b32 v134, 16, v2
    v_and_b32 v135, 0xffff0000, v2
    v_add_f32 v135, 0x3727c5ac, v135
    v_cvt_pk_bf16_f32 v2, v135, v135
    v_lshlrev_b32 v135, 16, v2
    v_sqrt_f32 v135, v135
    s_nop 0
    v_cvt_pk_bf16_f32 v2, v135, v135
    v_lshlrev_b32 v135, 16, v2
    v_rcp_f32 v135, v135
    v_lshlrev_b32 v2, 3, v136
    v_add_u32 v2, 1048576, v2
    v_and_b32 v3, 31, v1
    v_cmp_eq_u32 vcc, 0, v3
    v_mov_b32 v3, 2146435072
    s_nop 0
    v_cndmask_b32 v2, v3, v2, vcc
    buffer_store_dwordx2 v[134:135], v2, s[48:51], 0 offen sc1
    buffer_load_dword v4, v138, s[44:47], 0 offen sc1
    s_waitcnt vmcnt(22)
    s_waitcnt lgkmcnt(0)
    s_barrier
    s_add_u32 s59, s52, 32256
    s_add_u32 m0, s59, 0
    s_nop 0
    buffer_load_dwordx4 v80, s[12:15], s38 offen offset:0 lds
    buffer_load_dwordx4 v81, s[12:15], s38 offen offset:1024 lds
    buffer_load_dwordx4 v82, s[12:15], s38 offen offset:2048 lds
    buffer_load_dwordx4 v83, s[12:15], s38 offen offset:3072 lds
    s_add_u32 m0, s59, 4096
    s_nop 0
    buffer_load_dwordx4 v84, s[12:15], s38 offen offset:0 lds
    buffer_load_dwordx4 v85, s[12:15], s38 offen offset:1024 lds
    buffer_load_dwordx4 v86, s[12:15], s38 offen offset:2048 lds
    buffer_load_dwordx4 v87, s[12:15], s38 offen offset:3072 lds
    s_add_u32 m0, s59, 8192
    s_nop 0
    buffer_load_dwordx4 v88, s[12:15], s38 offen offset:0 lds
    s_add_u32 s38, s38, 589824
    s_cmp_ge_u32 s38, 5308416
    s_cselect_b32 s34, 5308416, 0
    s_sub_u32 s38, s38, s34
    ds_read_b128 v[56:59], v249 offset:49152
    ds_read_b128 v[60:63], v249 offset:49664
    ds_read_b128 v[64:67], v252 offset:49152
    ds_read_b128 v[68:71], v252 offset:49664
    v_mov_b32 v3, 1
    s_waitcnt vmcnt(9)
recurrent_scan__ssm_conv_h3__mixer_gmlp__prompt_kernel_re10:
    v_cmp_lt_u32 vcc, v4, v3
    s_and_b32 s34, vcc_lo, 15
    s_cmp_eq_u32 s34, 0
    s_cbranch_scc1 recurrent_scan__ssm_conv_h3__mixer_gmlp__prompt_kernel_ok11
    s_sleep 2
    buffer_load_dword v4, v138, s[44:47], 0 offen sc1
    s_waitcnt vmcnt(0)
    s_branch recurrent_scan__ssm_conv_h3__mixer_gmlp__prompt_kernel_re10
recurrent_scan__ssm_conv_h3__mixer_gmlp__prompt_kernel_ok11:
    s_cmp_lt_u32 s39, 9
    s_cselect_b32 s60, 4, 0
    s_cmp_eq_u32 s30, 0
    s_cselect_b32 s60, s60, 0
    s_or_b32 s60, s60, 1
    s_mov_b32 s61, 0
    v_mov_b32 v3, 2146435072
    v_cndmask_b32 v2, v3, v137, s[60:61]
    buffer_atomic_add v139, v2, s[48:51], 0 offen sc1
    s_waitcnt lgkmcnt(0)
    s_barrier
    s_add_u32 s59, s52, 50688
    s_add_u32 m0, s59, 0
    s_nop 0
    buffer_load_dwordx4 v80, s[12:15], s38 offen offset:0 lds
    buffer_load_dwordx4 v81, s[12:15], s38 offen offset:1024 lds
    buffer_load_dwordx4 v82, s[12:15], s38 offen offset:2048 lds
    buffer_load_dwordx4 v83, s[12:15], s38 offen offset:3072 lds
    s_add_u32 m0, s59, 4096
    s_nop 0
    buffer_load_dwordx4 v84, s[12:15], s38 offen offset:0 lds
    buffer_load_dwordx4 v85, s[12:15], s38 offen offset:1024 lds
    buffer_load_dwordx4 v86, s[12:15], s38 offen offset:2048 lds
    buffer_load_dwordx4 v87, s[12:15], s38 offen offset:3072 lds
    s_add_u32 m0, s59, 8192
    s_nop 0
    buffer_load_dwordx4 v88, s[12:15], s38 offen offset:0 lds
    s_add_u32 s38, s38, 589824
    s_cmp_ge_u32 s38, 5308416
    s_cselect_b32 s34, 5308416, 0
    s_sub_u32 s38, s38, s34
    ds_read_b128 v[72:75], v249 offset:0
    ds_read_b128 v[76:79], v249 offset:512
    ds_read_b128 v[152:155], v252 offset:0
    ds_read_b128 v[156:159], v252 offset:512
    s_and_b32 s34, s30, 2
    s_lshl_b32 s34, s34, 2
    s_add_u32 s62, s0, s34
    s_addc_u32 s63, s1, 0
    s_load_dwordx2 s[64:65], s[62:63], 8
    s_lshr_b32 s34, s2, 3
    s_mul_i32 s34, s34, 73728
    s_and_b32 s59, s2, 7
    s_mul_i32 s59, s59, 144
    s_add_u32 s34, s34, s59
    s_and_b32 s59, s30, 1
    s_mul_i32 s59, s59, 140
    s_add_u32 s34, s34, s59
    v_mul_u32_u24 v2, 1152, v1
    s_waitcnt lgkmcnt(0)
    s_mov_b32 s24, s64
    s_mov_b32 s25, s65
    s_mov_b32 s26, 2359296
    s_mov_b32 s27, 0x20000
    buffer_load_dword v125, v2, s[24:27], s34 offen
    s_waitcnt lgkmcnt(0)
    s_barrier
    s_add_u32 s59, s52, 69120
    s_add_u32 m0, s59, 0
    s_nop 0
    buffer_load_dwordx4 v80, s[12:15], s38 offen offset:0 lds
    buffer_load_dwordx4 v81, s[12:15], s38 offen offset:1024 lds
    buffer_load_dwordx4 v82, s[12:15], s38 offen offset:2048 lds
    buffer_load_dwordx4 v83, s[12:15], s38 offen offset:3072 lds
    s_add_u32 m0, s59, 4096
    s_nop 0
    buffer_load_dwordx4 v84, s[12:15], s38 offen offset:0 lds
    buffer_load_dwordx4 v85, s[12:15], s38 offen offset:1024 lds
    buffer_load_dwordx4 v86, s[12:15], s38 offen offset:2048 lds
    buffer_load_dwordx4 v87, s[12:15], s38 offen offset:3072 lds
    s_add_u32 m0, s59, 8192
    s_nop 0
    buffer_load_dwordx4 v88, s[12:15], s38 offen offset:0 lds
    s_add_u32 s38, s38, 589824
    s_cmp_ge_u32 s38, 5308416
    s_cselect_b32 s34, 5308416, 0
    s_sub_u32 s38, s38, s34
    ds_read_b128 v[160:163], v249 offset:16384
    ds_read_b128 v[164:167], v249 offset:16896
    ds_read_b128 v[168:171], v252 offset:16384
    ds_read_b128 v[172:175], v252 offset:16896
    s_waitcnt vmcnt(20)
    s_waitcnt lgkmcnt(0)
    s_barrier
    v_subrev_u32 v80, 4608, v80
    v_subrev_u32 v81, 4608, v81
    v_subrev_u32 v82, 4608, v82
    v_subrev_u32 v83, 4608, v83
    v_subrev_u32 v84, 4608, v84
    v_subrev_u32 v85, 4608, v85
    v_subrev_u32 v86, 4608, v86
    v_subrev_u32 v87, 4608, v87
    v_subrev_u32 v88, 4608, v88
    s_add_u32 s59, s52, 4608
    s_add_u32 m0, s59, 0
    s_nop 0
    buffer_load_dwordx4 v80, s[12:15], s38 offen offset:0 lds
    buffer_load_dwordx4 v81, s[12:15], s38 offen offset:1024 lds
    buffer_load_dwordx4 v82, s[12:15], s38 offen offset:2048 lds
    buffer_load_dwordx4 v83, s[12:15], s38 offen offset:3072 lds
    s_add_u32 m0, s59, 4096
    s_nop 0
    buffer_load_dwordx4 v84, s[12:15], s38 offen offset:0 lds
    buffer_load_dwordx4 v85, s[12:15], s38 offen offset:1024 lds
    buffer_load_dwordx4 v86, s[12:15], s38 offen offset:2048 lds
    buffer_load_dwordx4 v87, s[12:15], s38 offen offset:3072 lds
    s_add_u32 m0, s59, 8192
    s_nop 0
    buffer_load_dwordx4 v88, s[12:15], s38 offen offset:0 lds
    s_add_u32 s38, s38, 589824
    s_cmp_ge_u32 s38, 5308416
    s_cselect_b32 s34, 5308416, 0
    s_sub_u32 s38, s38, s34
    ds_read_b128 v[176:179], v249 offset:32768
    ds_read_b128 v[180:183], v249 offset:33280
    ds_read_b128 v[184:187], v252 offset:32768
    ds_read_b128 v[188:191], v252 offset:33280
    s_waitcnt vmcnt(19)
    s_waitcnt lgkmcnt(0)
    s_barrier
    s_add_u32 s59, s52, 23040
    s_add_u32 m0, s59, 0
    s_nop 0
    buffer_load_dwordx4 v80, s[12:15], s38 offen offset:0 lds
    buffer_load_dwordx4 v81, s[12:15], s38 offen offset:1024 lds
    buffer_load_dwordx4 v82, s[12:15], s38 offen offset:2048 lds
    buffer_load_dwordx4 v83, s[12:15], s38 offen offset:3072 lds
    s_add_u32 m0, s59, 4096
    s_nop 0
    buffer_load_dwordx4 v84, s[12:15], s38 offen offset:0 lds
    buffer_load_dwordx4 v85, s[12:15], s38 offen offset:1024 lds
    buffer_load_dwordx4 v86, s[12:15], s38 offen offset:2048 lds
    buffer_load_dwordx4 v87, s[12:15], s38 offen offset:3072 lds
    s_add_u32 m0, s59, 8192
    s_nop 0
    buffer_load_dwordx4 v88, s[12:15], s38 offen offset:0 lds
    s_add_u32 s38, s38, 589824
    s_cmp_ge_u32 s38, 5308416
    s_cselect_b32 s34, 5308416, 0
    s_sub_u32 s38, s38, s34
    ds_read_b128 v[192:195], v249 offset:49152
    ds_read_b128 v[196:199], v249 offset:49664
    ds_read_b128 v[200:203], v252 offset:49152
    ds_read_b128 v[204:207], v252 offset:49664
    s_waitcnt vmcnt(18)
    s_waitcnt lgkmcnt(0)
    s_barrier
    s_add_u32 s59, s52, 41472
    s_add_u32 m0, s59, 0
    s_nop 0
    buffer_load_dwordx4 v80, s[12:15], s38 offen offset:0 lds
    buffer_load_dwordx4 v81, s[12:15], s38 offen offset:1024 lds
    buffer_load_dwordx4 v82, s[12:15], s38 offen offset:2048 lds
    buffer_load_dwordx4 v83, s[12:15], s38 offen offset:3072 lds
    s_add_u32 m0, s59, 4096
    s_nop 0
    buffer_load_dwordx4 v84, s[12:15], s38 offen offset:0 lds
    buffer_load_dwordx4 v85, s[12:15], s38 offen offset:1024 lds
    buffer_load_dwordx4 v86, s[12:15], s38 offen offset:2048 lds
    buffer_load_dwordx4 v87, s[12:15], s38 offen offset:3072 lds
    s_add_u32 m0, s59, 8192
    s_nop 0
    buffer_load_dwordx4 v88, s[12:15], s38 offen offset:0 lds
    s_add_u32 s38, s38, 589824
    s_cmp_ge_u32 s38, 5308416
    s_cselect_b32 s34, 5308416, 0
    s_sub_u32 s38, s38, s34
    ds_read_b128 v[208:211], v249 offset:0
    ds_read_b128 v[212:215], v249 offset:512
    ds_read_b128 v[216:219], v252 offset:0
    ds_read_b128 v[220:223], v252 offset:512
    s_waitcnt vmcnt(0)
    s_branch recurrent_scan__ssm_conv_h3__mixer_gmlp__prompt_kernel_bjoin9
recurrent_scan__ssm_conv_h3__mixer_gmlp__prompt_kernel_xload8:
    s_sub_u32 s34, s30, 2
    s_lshl_b32 s37, s34, 13
    s_add_u32 s37, s37, 87552
    s_lshl_b32 s34, s34, 6
    s_add_u32 s34, s34, s31
    s_lshl_b32 s38, s56, 7
    v_lshrrev_b32 v2, 3, v1
    v_and_b32 v3, 3, v2
    v_xor_b32 v3, v3, v1
    v_and_b32 v3, 7, v3
    v_add_u32 v2, s34, v2
    v_mul_u32_u24 v2, 1152, v2
    v_xor_b32 v4, 0, v3
    v_lshl_add_u32 v4, v4, 4, v2
    v_add_u32 v80, 4096, v4
    v_xor_b32 v4, 4, v3
    v_lshl_add_u32 v4, v4, 4, v2
    v_add_u32 v81, 12288, v4
    v_xor_b32 v4, 0, v3
    v_lshl_add_u32 v4, v4, 4, v2
    v_add_u32 v82, 20480, v4
    v_xor_b32 v4, 4, v3
    v_lshl_add_u32 v4, v4, 4, v2
    v_add_u32 v83, 28672, v4
    v_xor_b32 v4, 0, v3
    v_lshl_add_u32 v4, v4, 4, v2
    v_add_u32 v84, 40960, v4
    v_xor_b32 v4, 4, v3
    v_lshl_add_u32 v4, v4, 4, v2
    v_add_u32 v85, 49152, v4
    v_xor_b32 v4, 0, v3
    v_lshl_add_u32 v4, v4, 4, v2
    v_add_u32 v86, 57344, v4
    v_xor_b32 v4, 4, v3
    v_lshl_add_u32 v4, v4, 4, v2
    v_add_u32 v87, 65536, v4
    s_add_u32 m0, s37, 0
    s_nop 0
    buffer_load_dwordx4 v80, s[8:11], s38 offen offset:0 lds
    buffer_load_dwordx4 v81, s[8:11], s38 offen offset:1024 lds
    buffer_load_dwordx4 v82, s[8:11], s38 offen offset:2048 lds
    buffer_load_dwordx4 v83, s[8:11], s38 offen offset:3072 lds
    s_add_u32 m0, s37, 4096
    s_nop 0
    buffer_load_dwordx4 v84, s[8:11], s38 offen offset:0 lds
    buffer_load_dwordx4 v85, s[8:11], s38 offen offset:1024 lds
    buffer_load_dwordx4 v86, s[8:11], s38 offen offset:2048 lds
    buffer_load_dwordx4 v87, s[8:11], s38 offen offset:3072 lds
    s_add_u32 s38, s38, 128
    s_cmp_eq_u32 s38, 1152
    s_cselect_b32 s38, 0, s38
    s_lshl_b32 s34, s32, 3
    s_add_u32 s34, s34, s31
    s_lshl_b32 s59, s30, 1
    s_add_u32 s34, s34, s59
    v_lshrrev_b32 v2, 5, v1
    v_add_u32 v136, s34, v2
    v_mul_u32_u24 v2, 1152, v136
    v_and_b32 v3, 31, v1
    v_lshl_add_u32 v2, v3, 4, v2
    v_add_u32 v2, 4096, v2
    v_cmp_gt_u32 vcc, 8, v3
    v_mov_b32 v3, 2146435072
    s_nop 0
    v_cndmask_b32 v4, v3, v2, vcc
    buffer_load_dwordx4 v[200:203], v2, s[8:11], 0 offen offset:0
    buffer_load_dwordx4 v[204:207], v2, s[8:11], 0 offen offset:512
    buffer_load_dwordx4 v[208:211], v4, s[8:11], 0 offen offset:1024
    s_lshl_b32 s34, s39, 8
    s_lshl_b32 s59, s32, 8
    v_mov_b32 v137, s34
    v_mov_b32 v2, s59
    v_cmp_lt_u32 vcc, 1, v1
    s_nop 1
    v_cndmask_b32 v137, v137, v2, vcc
    v_lshl_add_u32 v137, v1, 12, v137
    v_add_u32 v137, 1835008, v137
    v_cmp_gt_u32 vcc, 4, v1
    s_nop 1
    v_cndmask_b32 v138, v3, 0, vcc
    v_cndmask_b32 v137, v3, v137, vcc
    s_lshl_b32 s34, s30, 8
    s_add_u32 s34, s34, s2
    s_cmp_eq_u32 s34, 512
    s_mov_b32 s60, 2146435072
    s_cselect_b32 s60, 1835008, s60
    s_mov_b32 s61, 2146435072
    s_cselect_b32 s61, 0, s61
    v_add_u32 v140, s61, v138
    v_lshlrev_b32 v4, 8, v1
    v_mov_b32 v139, 0
    buffer_store_dword v139, v4, s[48:51], s60 offen sc1
    v_add_u32 v4, 16384, v4
    buffer_store_dword v139, v4, s[48:51], s60 offen sc1
    v_add_u32 v4, 16384, v4
    buffer_store_dword v139, v4, s[48:51], s60 offen sc1
    v_lshrrev_b32 v4, 2, v1
    v_lshlrev_b32 v4, 8, v4
    v_and_b32 v2, 3, v1
    v_lshl_add_u32 v4, v2, 4, v4
    v_add_u32 v4, 0x8000, v4
    v_mov_b32 v124, 0
    v_mov_b32 v125, 0
    v_mov_b32 v126, 0
    v_mov_b32 v127, 0
    buffer_store_dwordx4 v[124:127], v4, s[48:51], s60 offen sc1
    v_add_u32 v4, 0x1000, v4
    buffer_store_dwordx4 v[124:127], v4, s[48:51], s60 offen sc1
    s_add_u32 m0, s37, 16384
    s_nop 0
    buffer_load_dwordx4 v80, s[8:11], s38 offen offset:0 lds
    buffer_load_dwordx4 v81, s[8:11], s38 offen offset:1024 lds
    buffer_load_dwordx4 v82, s[8:11], s38 offen offset:2048 lds
    buffer_load_dwordx4 v83, s[8:11], s38 offen offset:3072 lds
    s_add_u32 m0, s37, 20480
    s_nop 0
    buffer_load_dwordx4 v84, s[8:11], s38 offen offset:0 lds
    buffer_load_dwordx4 v85, s[8:11], s38 offen offset:1024 lds
    buffer_load_dwordx4 v86, s[8:11], s38 offen offset:2048 lds
    buffer_load_dwordx4 v87, s[8:11], s38 offen offset:3072 lds
    s_add_u32 s38, s38, 128
    s_cmp_eq_u32 s38, 1152
    s_cselect_b32 s38, 0, s38
    s_waitcnt vmcnt(16)
    s_waitcnt lgkmcnt(0)
    s_barrier
    s_add_u32 m0, s37, 32768
    s_nop 0
    buffer_load_dwordx4 v80, s[8:11], s38 offen offset:0 lds
    buffer_load_dwordx4 v81, s[8:11], s38 offen offset:1024 lds
    buffer_load_dwordx4 v82, s[8:11], s38 offen offset:2048 lds
    buffer_load_dwordx4 v83, s[8:11], s38 offen offset:3072 lds
    s_add_u32 m0, s37, 36864
    s_nop 0
    buffer_load_dwordx4 v84, s[8:11], s38 offen offset:0 lds
    buffer_load_dwordx4 v85, s[8:11], s38 offen offset:1024 lds
    buffer_load_dwordx4 v86, s[8:11], s38 offen offset:2048 lds
    buffer_load_dwordx4 v87, s[8:11], s38 offen offset:3072 lds
    s_add_u32 s38, s38, 128
    s_cmp_eq_u32 s38, 1152
    s_cselect_b32 s38, 0, s38
    ds_read_b128 v[8:11], v249 offset:0
    ds_read_b128 v[12:15], v249 offset:512
    ds_read_b128 v[16:19], v252 offset:0
    ds_read_b128 v[20:23], v252 offset:512
    s_lshr_b32 s34, s30, 1
    s_mul_i32 s34, s34, 9216
    s_and_b32 s59, s30, 1
    s_mul_i32 s59, s59, 160
    s_add_u32 s34, s34, s59
    v_add_u32 v2, s34, v248
    ds_read_b64_tr_b16 v[92:93], v2 offset:0
    ds_read_b64_tr_b16 v[94:95], v2 offset:2304
    ds_read_b64_tr_b16 v[96:97], v2 offset:32
    ds_read_b64_tr_b16 v[98:99], v2 offset:2336
    ds_read_b64_tr_b16 v[100:101], v2 offset:64
    ds_read_b64_tr_b16 v[102:103], v2 offset:2368
    ds_read_b64_tr_b16 v[104:105], v2 offset:96
    ds_read_b64_tr_b16 v[106:107], v2 offset:2400
    ds_read_b64_tr_b16 v[108:109], v2 offset:128
    ds_read_b64_tr_b16 v[110:111], v2 offset:2432
    v_mov_b32 v128, 0
    v_mov_b32 v129, 0
    v_mov_b32 v130, 0
    v_mov_b32 v131, 0
    v_mov_b32 v132, 0
    s_lshl_b32 s59, s59, 1
    s_lshr_b32 s34, s30, 1
    s_mul_i32 s34, s34, 640
    s_add_u32 s59, s59, s34
    v_lshlrev_b32 v3, 2, v5
    v_add_u32 v3, s59, v3
    s_waitcnt lgkmcnt(0)
    v_dot2_f32_bf16 v128, v92, s53, v128
    v_dot2_f32_bf16 v129, v96, s53, v129
    v_dot2_f32_bf16 v130, v100, s53, v130
    v_dot2_f32_bf16 v131, v104, s53, v131
    v_dot2_f32_bf16 v132, v108, s53, v132
    v_dot2_f32_bf16 v128, v93, s53, v128
    v_dot2_f32_bf16 v129, v97, s53, v129
    v_dot2_f32_bf16 v130, v101, s53, v130
    v_dot2_f32_bf16 v131, v105, s53, v131
    v_dot2_f32_bf16 v132, v109, s53, v132
    v_dot2_f32_bf16 v128, v94, s53, v128
    v_dot2_f32_bf16 v129, v98, s53, v129
    v_dot2_f32_bf16 v130, v102, s53, v130
    v_dot2_f32_bf16 v131, v106, s53, v131
    v_dot2_f32_bf16 v132, v110, s53, v132
    v_dot2_f32_bf16 v128, v95, s53, v128
    v_dot2_f32_bf16 v129, v99, s53, v129
    v_dot2_f32_bf16 v130, v103, s53, v130
    v_dot2_f32_bf16 v131, v107, s53, v131
    v_dot2_f32_bf16 v132, v111, s53, v132
    v_mov_b32 v92, v128
    v_mov_b32 v93, v129
    v_mov_b32 v94, v130
    v_mov_b32 v95, v131
    v_mov_b32 v96, v132
    v_permlane32_swap_b32 v128, v92
    v_permlane32_swap_b32 v129, v93
    v_permlane32_swap_b32 v130, v94
    v_permlane32_swap_b32 v131, v95
    v_permlane32_swap_b32 v132, v96
    v_add_f32 v128, v128, v92
    v_add_f32 v129, v129, v93
    v_add_f32 v130, v130, v94
    v_add_f32 v131, v131, v95
    v_add_f32 v132, v132, v96
    v_mov_b32 v92, v128
    v_mov_b32 v93, v129
    v_mov_b32 v94, v130
    v_mov_b32 v95, v131
    v_mov_b32 v96, v132
    v_permlane16_swap_b32 v128, v92
    v_permlane16_swap_b32 v129, v93
    v_permlane16_swap_b32 v130, v94
    v_permlane16_swap_b32 v131, v95
    v_permlane16_swap_b32 v132, v96
    v_add_f32 v128, v128, v92
    v_add_f32 v129, v129, v93
    v_add_f32 v130, v130, v94
    v_add_f32 v131, v131, v95
    v_add_f32 v132, v132, v96
    ds_write_b32 v3, v128 offset:3328
    ds_write_b32 v3, v129 offset:3392
    ds_write_b32 v3, v130 offset:3456
    ds_write_b32 v3, v131 offset:3520
    ds_write_b32 v3, v132 offset:3584
    s_waitcnt vmcnt(8)
    s_waitcnt lgkmcnt(0)
    s_barrier
    s_add_u32 m0, s37, 49152
    s_nop 0
    buffer_load_dwordx4 v80, s[8:11], s38 offen offset:0 lds
    buffer_load_dwordx4 v81, s[8:11], s38 offen offset:1024 lds
    buffer_load_dwordx4 v82, s[8:11], s38 offen offset:2048 lds
    buffer_load_dwordx4 v83, s[8:11], s38 offen offset:3072 lds
    s_add_u32 m0, s37, 53248
    s_nop 0
    buffer_load_dwordx4 v84, s[8:11], s38 offen offset:0 lds
    buffer_load_dwordx4 v85, s[8:11], s38 offen offset:1024 lds
    buffer_load_dwordx4 v86, s[8:11], s38 offen offset:2048 lds
    buffer_load_dwordx4 v87, s[8:11], s38 offen offset:3072 lds
    s_add_u32 s38, s38, 128
    s_cmp_eq_u32 s38, 1152
    s_cselect_b32 s38, 0, s38
    s_add_u32 m0, s37, 0
    s_nop 0
    buffer_load_dwordx4 v80, s[8:11], s38 offen offset:0 lds
    buffer_load_dwordx4 v81, s[8:11], s38 offen offset:1024 lds
    buffer_load_dwordx4 v82, s[8:11], s38 offen offset:2048 lds
    buffer_load_dwordx4 v83, s[8:11], s38 offen offset:3072 lds
    s_add_u32 m0, s37, 4096
    s_nop 0
    buffer_load_dwordx4 v84, s[8:11], s38 offen offset:0 lds
    buffer_load_dwordx4 v85, s[8:11], s38 offen offset:1024 lds
    buffer_load_dwordx4 v86, s[8:11], s38 offen offset:2048 lds
    buffer_load_dwordx4 v87, s[8:11], s38 offen offset:3072 lds
    s_add_u32 s38, s38, 128
    s_cmp_eq_u32 s38, 1152
    s_cselect_b32 s38, 0, s38
    ds_read_b128 v[24:27], v249 offset:16384
    ds_read_b128 v[28:31], v249 offset:16896
    ds_read_b128 v[32:35], v252 offset:16384
    ds_read_b128 v[36:39], v252 offset:16896
    v_mov_b32 v139, 1
    buffer_store_dword v139, v140, s[44:47], 0 offen sc1
    ds_read_b128 v[92:95], v7 offset:3328
    ds_read_b128 v[96:99], v7 offset:3968
    s_lshl_b32 s34, s32, 1
    s_add_u32 s34, s34, 0
    s_mul_i32 s34, s34, 9
    s_add_u32 s34, s34, s56
    s_mul_i32 s34, s34, 576
    s_add_u32 s34, s34, 1310720
    s_cmp_lt_u32 s39, 9
    s_cselect_b32 s34, s34, 2146435072
    s_cmp_eq_u32 s30, 0
    s_cselect_b32 s34, s34, 2146435072
    v_mov_b32 v3, 2146435072
    v_cmp_gt_u32 vcc, 36, v1
    s_nop 1
    v_cndmask_b32 v2, v3, v7, vcc
    s_waitcnt lgkmcnt(0)
    v_add_f32 v92, v92, v96
    v_add_f32 v93, v93, v97
    v_add_f32 v94, v94, v98
    v_add_f32 v95, v95, v99
    buffer_store_dwordx4 v[92:95], v2, s[48:51], s34 offen sc1
    v_mov_b32 v100, 0
    v_mov_b32 v101, 0
    v_mov_b32 v102, 0
    v_mov_b32 v103, 0
    v_dot2_f32_bf16 v100, v200, s53, v100
    v_dot2_f32_bf16 v102, v200, v200, v102
    v_dot2_f32_bf16 v101, v201, s53, v101
    v_dot2_f32_bf16 v103, v201, v201, v103
    v_dot2_f32_bf16 v100, v202, s53, v100
    v_dot2_f32_bf16 v102, v202, v202, v102
    v_dot2_f32_bf16 v101, v203, s53, v101
    v_dot2_f32_bf16 v103, v203, v203, v103
    v_dot2_f32_bf16 v100, v204, s53, v100
    v_dot2_f32_bf16 v102, v204, v204, v102
    v_dot2_f32_bf16 v101, v205, s53, v101
    v_dot2_f32_bf16 v103, v205, v205, v103
    v_dot2_f32_bf16 v100, v206, s53, v100
    v_dot2_f32_bf16 v102, v206, v206, v102
    v_dot2_f32_bf16 v101, v207, s53, v101
    v_dot2_f32_bf16 v103, v207, v207, v103
    v_dot2_f32_bf16 v100, v208, s53, v100
    v_dot2_f32_bf16 v102, v208, v208, v102
    v_dot2_f32_bf16 v101, v209, s53, v101
    v_dot2_f32_bf16 v103, v209, v209, v103
    v_dot2_f32_bf16 v100, v210, s53, v100
    v_dot2_f32_bf16 v102, v210, v210, v102
    v_dot2_f32_bf16 v101, v211, s53, v101
    v_dot2_f32_bf16 v103, v211, v211, v103
    s_nop 1
    v_add_f32 v134, v100, v101
    v_add_f32 v135, v102, v103
    s_waitcnt vmcnt(18)
    s_waitcnt lgkmcnt(0)
    s_barrier
    s_add_u32 m0, s37, 16384
    s_nop 0
    buffer_load_dwordx4 v80, s[8:11], s38 offen offset:0 lds
    buffer_load_dwordx4 v81, s[8:11], s38 offen offset:1024 lds
    buffer_load_dwordx4 v82, s[8:11], s38 offen offset:2048 lds
    buffer_load_dwordx4 v83, s[8:11], s38 offen offset:3072 lds
    s_add_u32 m0, s37, 20480
    s_nop 0
    buffer_load_dwordx4 v84, s[8:11], s38 offen offset:0 lds
    buffer_load_dwordx4 v85, s[8:11], s38 offen offset:1024 lds
    buffer_load_dwordx4 v86, s[8:11], s38 offen offset:2048 lds
    buffer_load_dwordx4 v87, s[8:11], s38 offen offset:3072 lds
    s_add_u32 s38, s38, 128
    s_cmp_eq_u32 s38, 1152
    s_cselect_b32 s38, 0, s38
    ds_read_b128 v[40:43], v249 offset:32768
    ds_read_b128 v[44:47], v249 offset:33280
    ds_read_b128 v[48:51], v252 offset:32768
    ds_read_b128 v[52:55], v252 offset:33280
    v_add_f32_dpp v134, v134, v134 row_ror:8 row_mask:0xf bank_mask:0xf
    v_add_f32_dpp v135, v135, v135 row_ror:8 row_mask:0xf bank_mask:0xf
    s_nop 0
    v_add_f32_dpp v134, v134, v134 row_ror:4 row_mask:0xf bank_mask:0xf
    v_add_f32_dpp v135, v135, v135 row_ror:4 row_mask:0xf bank_mask:0xf
    s_nop 0
    v_add_f32_dpp v134, v134, v134 row_ror:2 row_mask:0xf bank_mask:0xf
    v_add_f32_dpp v135, v135, v135 row_ror:2 row_mask:0xf bank_mask:0xf
    s_nop 0
    v_add_f32_dpp v134, v134, v134 row_ror:1 row_mask:0xf bank_mask:0xf
    v_add_f32_dpp v135, v135, v135 row_ror:1 row_mask:0xf bank_mask:0xf
    v_mov_b32 v96, v134
    v_mov_b32 v97, v135
    s_nop 0
    v_permlane16_swap_b32 v134, v96
    v_permlane16_swap_b32 v135, v97
    v_add_f32 v134, v134, v96
    v_add_f32 v135, v135, v97
    v_mul_f32 v134, 0x3ae38e39, v134
    v_mul_f32 v135, 0x3ae38e39, v135
    v_fma_f32 v135, -v134, v134, v135
    v_max_f32 v135, 0, v135
    v_cvt_pk_bf16_f32 v2, v134, v135
    v_lshlrev_b32 v134, 16, v2
    v_and_b32 v135, 0xffff0000, v2
    v_add_f32 v135, 0x3727c5ac, v135
    v_cvt_pk_bf16_f32 v2, v135, v135
    v_lshlrev_b32 v135, 16, v2
    v_sqrt_f32 v135, v135
    s_nop 0
    v_cvt_pk_bf16_f32 v2, v135, v135
    v_lshlrev_b32 v135, 16, v2
    v_rcp_f32 v135, v135
    v_lshlrev_b32 v2, 3, v136
    v_add_u32 v2, 1048576, v2
    v_and_b32 v3, 31, v1
    v_cmp_eq_u32 vcc, 0, v3
    v_mov_b32 v3, 2146435072
    s_nop 0
    v_cndmask_b32 v2, v3, v2, vcc
    buffer_store_dwordx2 v[134:135], v2, s[48:51], 0 offen sc1
    buffer_load_dword v4, v138, s[44:47], 0 offen sc1
    s_waitcnt vmcnt(20)
    s_waitcnt lgkmcnt(0)
    s_barrier
    s_add_u32 m0, s37, 32768
    s_nop 0
    buffer_load_dwordx4 v80, s[8:11], s38 offen offset:0 lds
    buffer_load_dwordx4 v81, s[8:11], s38 offen offset:1024 lds
    buffer_load_dwordx4 v82, s[8:11], s38 offen offset:2048 lds
    buffer_load_dwordx4 v83, s[8:11], s38 offen offset:3072 lds
    s_add_u32 m0, s37, 36864
    s_nop 0
    buffer_load_dwordx4 v84, s[8:11], s38 offen offset:0 lds
    buffer_load_dwordx4 v85, s[8:11], s38 offen offset:1024 lds
    buffer_load_dwordx4 v86, s[8:11], s38 offen offset:2048 lds
    buffer_load_dwordx4 v87, s[8:11], s38 offen offset:3072 lds
    s_add_u32 s38, s38, 128
    s_cmp_eq_u32 s38, 1152
    s_cselect_b32 s38, 0, s38
    ds_read_b128 v[56:59], v249 offset:49152
    ds_read_b128 v[60:63], v249 offset:49664
    ds_read_b128 v[64:67], v252 offset:49152
    ds_read_b128 v[68:71], v252 offset:49664
    v_mov_b32 v3, 1
    s_waitcnt vmcnt(8)
recurrent_scan__ssm_conv_h3__mixer_gmlp__prompt_kernel_re12:
    v_cmp_lt_u32 vcc, v4, v3
    s_and_b32 s34, vcc_lo, 15
    s_cmp_eq_u32 s34, 0
    s_cbranch_scc1 recurrent_scan__ssm_conv_h3__mixer_gmlp__prompt_kernel_ok13
    s_sleep 2
    buffer_load_dword v4, v138, s[44:47], 0 offen sc1
    s_waitcnt vmcnt(0)
    s_branch recurrent_scan__ssm_conv_h3__mixer_gmlp__prompt_kernel_re12
recurrent_scan__ssm_conv_h3__mixer_gmlp__prompt_kernel_ok13:
    s_cmp_lt_u32 s39, 9
    s_cselect_b32 s60, 4, 0
    s_cmp_eq_u32 s30, 0
    s_cselect_b32 s60, s60, 0
    s_or_b32 s60, s60, 1
    s_mov_b32 s61, 0
    v_mov_b32 v3, 2146435072
    v_cndmask_b32 v2, v3, v137, s[60:61]
    buffer_atomic_add v139, v2, s[48:51], 0 offen sc1
    s_waitcnt lgkmcnt(0)
    s_barrier
    s_add_u32 m0, s37, 49152
    s_nop 0
    buffer_load_dwordx4 v80, s[8:11], s38 offen offset:0 lds
    buffer_load_dwordx4 v81, s[8:11], s38 offen offset:1024 lds
    buffer_load_dwordx4 v82, s[8:11], s38 offen offset:2048 lds
    buffer_load_dwordx4 v83, s[8:11], s38 offen offset:3072 lds
    s_add_u32 m0, s37, 53248
    s_nop 0
    buffer_load_dwordx4 v84, s[8:11], s38 offen offset:0 lds
    buffer_load_dwordx4 v85, s[8:11], s38 offen offset:1024 lds
    buffer_load_dwordx4 v86, s[8:11], s38 offen offset:2048 lds
    buffer_load_dwordx4 v87, s[8:11], s38 offen offset:3072 lds
    s_add_u32 s38, s38, 128
    s_cmp_eq_u32 s38, 1152
    s_cselect_b32 s38, 0, s38
    ds_read_b128 v[72:75], v249 offset:0
    ds_read_b128 v[76:79], v249 offset:512
    ds_read_b128 v[152:155], v252 offset:0
    ds_read_b128 v[156:159], v252 offset:512
    s_and_b32 s34, s30, 2
    s_lshl_b32 s34, s34, 2
    s_add_u32 s62, s0, s34
    s_addc_u32 s63, s1, 0
    s_load_dwordx2 s[64:65], s[62:63], 8
    s_lshr_b32 s34, s2, 3
    s_mul_i32 s34, s34, 73728
    s_and_b32 s59, s2, 7
    s_mul_i32 s59, s59, 144
    s_add_u32 s34, s34, s59
    s_and_b32 s59, s30, 1
    s_mul_i32 s59, s59, 140
    s_add_u32 s34, s34, s59
    v_mul_u32_u24 v2, 1152, v1
    s_waitcnt lgkmcnt(0)
    s_mov_b32 s24, s64
    s_mov_b32 s25, s65
    s_mov_b32 s26, 2359296
    s_mov_b32 s27, 0x20000
    buffer_load_dword v125, v2, s[24:27], s34 offen
    s_waitcnt lgkmcnt(0)
    s_barrier
    s_add_u32 m0, s37, 0
    s_nop 0
    buffer_load_dwordx4 v80, s[8:11], s38 offen offset:0 lds
    buffer_load_dwordx4 v81, s[8:11], s38 offen offset:1024 lds
    buffer_load_dwordx4 v82, s[8:11], s38 offen offset:2048 lds
    buffer_load_dwordx4 v83, s[8:11], s38 offen offset:3072 lds
    s_add_u32 m0, s37, 4096
    s_nop 0
    buffer_load_dwordx4 v84, s[8:11], s38 offen offset:0 lds
    buffer_load_dwordx4 v85, s[8:11], s38 offen offset:1024 lds
    buffer_load_dwordx4 v86, s[8:11], s38 offen offset:2048 lds
    buffer_load_dwordx4 v87, s[8:11], s38 offen offset:3072 lds
    s_add_u32 s38, s38, 128
    s_cmp_eq_u32 s38, 1152
    s_cselect_b32 s38, 0, s38
    ds_read_b128 v[160:163], v249 offset:16384
    ds_read_b128 v[164:167], v249 offset:16896
    ds_read_b128 v[168:171], v252 offset:16384
    ds_read_b128 v[172:175], v252 offset:16896
    buffer_load_dword v4, v137, s[48:51], 0 offen sc1
    s_waitcnt vmcnt(19)
    s_waitcnt lgkmcnt(0)
    s_barrier
    ds_read_b128 v[176:179], v249 offset:32768
    ds_read_b128 v[180:183], v249 offset:33280
    ds_read_b128 v[184:187], v252 offset:32768
    ds_read_b128 v[188:191], v252 offset:33280
    v_mov_b32 v3, 0
    v_cmp_eq_u32 vcc, 0, v1
    s_nop 1
    v_cndmask_b32 v3, v3, 64, vcc
    v_cmp_eq_u32 vcc, 2, v1
    s_nop 1
    v_cndmask_b32 v3, v3, 9, vcc
    s_waitcnt vmcnt(0)
recurrent_scan__ssm_conv_h3__mixer_gmlp__prompt_kernel_re14:
    v_cmp_lt_u32 vcc, v4, v3
    s_and_b32 s34, vcc_lo, 15
    s_cmp_eq_u32 s34, 0
    s_cbranch_scc1 recurrent_scan__ssm_conv_h3__mixer_gmlp__prompt_kernel_ok15
    s_sleep 2
    buffer_load_dword v4, v137, s[48:51], 0 offen sc1
    s_waitcnt vmcnt(0)
    s_branch recurrent_scan__ssm_conv_h3__mixer_gmlp__prompt_kernel_re14
recurrent_scan__ssm_conv_h3__mixer_gmlp__prompt_kernel_ok15:
    s_sub_u32 s34, s30, 2
    s_lshl_b32 s34, s34, 6
    s_add_u32 s34, s34, s31
    s_lshl_b32 s34, s34, 3
    s_add_u32 s34, s34, 1048576
    v_lshlrev_b32 v2, 3, v1
    buffer_load_dwordx2 v[134:135], v2, s[48:51], s34 offen sc1
    s_lshl_b32 s34, s32, 1
    s_add_u32 s34, s34, 0
    s_mul_i32 s34, s34, 5184
    s_add_u32 s34, s34, 1310720
    s_add_u32 s61, s34, 4032
    v_mov_b32 v3, 2146435072
    v_cmp_gt_u32 vcc, 36, v1
    s_nop 1
    v_cndmask_b32 v2, v3, v7, vcc
    buffer_load_dwordx4 v[92:95], v2, s[48:51], s34 offen offset:0 sc1
    buffer_load_dwordx4 v[96:99], v2, s[48:51], s34 offen offset:576 sc1
    buffer_load_dwordx4 v[100:103], v2, s[48:51], s34 offen offset:1152 sc1
    buffer_load_dwordx4 v[104:107], v2, s[48:51], s34 offen offset:1728 sc1
    buffer_load_dwordx4 v[108:111], v2, s[48:51], s34 offen offset:2304 sc1
    buffer_load_dwordx4 v[112:115], v2, s[48:51], s34 offen offset:2880 sc1
    buffer_load_dwordx4 v[116:119], v2, s[48:51], s34 offen offset:3456 sc1
    buffer_load_dwordx4 v[120:123], v2, s[48:51], s61 offen offset:0 sc1
    buffer_load_dwordx4 v[124:127], v2, s[48:51], s61 offen offset:576 sc1
    s_waitcnt lgkmcnt(0)
    s_barrier
    ds_read_b128 v[192:195], v249 offset:49152
    ds_read_b128 v[196:199], v249 offset:49664
    ds_read_b128 v[200:203], v252 offset:49152
    ds_read_b128 v[204:207], v252 offset:49664
    s_waitcnt lgkmcnt(0)
    s_barrier
    ds_read_b128 v[208:211], v249 offset:0
    ds_read_b128 v[212:215], v249 offset:512
    ds_read_b128 v[216:219], v252 offset:0
    ds_read_b128 v[220:223], v252 offset:512
    s_waitcnt vmcnt(0)
    v_add_f32 v92, v92, v96
    v_add_f32 v93, v93, v97
    v_add_f32 v94, v94, v98
    v_add_f32 v95, v95, v99
    v_add_f32 v92, v92, v100
    v_add_f32 v93, v93, v101
    v_add_f32 v94, v94, v102
    v_add_f32 v95, v95, v103
    v_add_f32 v92, v92, v104
    v_add_f32 v93, v93, v105
    v_add_f32 v94, v94, v106
    v_add_f32 v95, v95, v107
    v_add_f32 v92, v92, v108
    v_add_f32 v93, v93, v109
    v_add_f32 v94, v94, v110
    v_add_f32 v95, v95, v111
    v_add_f32 v92, v92, v112
    v_add_f32 v93, v93, v113
    v_add_f32 v94, v94, v114
    v_add_f32 v95, v95, v115
    v_add_f32 v92, v92, v116
    v_add_f32 v93, v93, v117
    v_add_f32 v94, v94, v118
    v_add_f32 v95, v95, v119
    v_add_f32 v92, v92, v120
    v_add_f32 v93, v93, v121
    v_add_f32 v94, v94, v122
    v_add_f32 v95, v95, v123
    v_add_f32 v92, v92, v124
    v_add_f32 v93, v93, v125
    v_add_f32 v94, v94, v126
    v_add_f32 v95, v95, v127
    v_cmp_gt_u32 vcc, 36, v1
    s_and_saveexec_b64 s[62:63], vcc
    ds_write_b128 v7, v[92:95] offset:0
    s_mov_b64 exec, -1
    s_sub_u32 s34, s30, 2
    s_lshl_b32 s34, s34, 8
    v_lshlrev_b32 v2, 2, v1
    v_add_u32 v2, s34, v2
    ds_write_b32 v2, v134 offset:1280
    ds_write_b32 v2, v135 offset:1792
    s_waitcnt vmcnt(0)
recurrent_scan__ssm_conv_h3__mixer_gmlp__prompt_kernel_bjoin9:
    v_mov_b32 v80, 0
    v_mov_b32 v81, 0
    v_mov_b32 v82, 0
    v_mov_b32 v83, 0
    v_mov_b32 v84, 0
    v_mov_b32 v85, 0
    v_mov_b32 v86, 0
    v_mov_b32 v87, 0
    v_mov_b32 v88, 0
    v_mov_b32 v89, 0
    v_mov_b32 v90, 0
    v_mov_b32 v91, 0
    v_mov_b32 v92, 0
    v_mov_b32 v93, 0
    v_mov_b32 v94, 0
    v_mov_b32 v95, 0
    v_mov_b32 v96, 0
    v_mov_b32 v97, 0
    v_mov_b32 v98, 0
    v_mov_b32 v99, 0
    v_mov_b32 v100, 0
    v_mov_b32 v101, 0
    v_mov_b32 v102, 0
    v_mov_b32 v103, 0
    v_mov_b32 v104, 0
    v_mov_b32 v105, 0
    v_mov_b32 v106, 0
    v_mov_b32 v107, 0
    v_mov_b32 v108, 0
    v_mov_b32 v109, 0
    v_mov_b32 v110, 0
    v_mov_b32 v111, 0
    v_mov_b32 v112, 0
    v_mov_b32 v113, 0
    v_mov_b32 v114, 0
    v_mov_b32 v115, 0
    v_mov_b32 v116, 0
    v_mov_b32 v117, 0
    v_mov_b32 v118, 0
    v_mov_b32 v119, 0
    v_mov_b32 v120, 0
    v_mov_b32 v121, 0
    v_mov_b32 v122, 0
    v_mov_b32 v123, 0
    v_mov_b32 v124, 0
    v_mov_b32 v125, 0
    v_mov_b32 v126, 0
    v_mov_b32 v127, 0
    v_mov_b32 v128, 0
    v_mov_b32 v129, 0
    v_mov_b32 v130, 0
    v_mov_b32 v131, 0
    v_mov_b32 v132, 0
    v_mov_b32 v133, 0
    v_mov_b32 v134, 0
    v_mov_b32 v135, 0
    v_mov_b32 v136, 0
    v_mov_b32 v137, 0
    v_mov_b32 v138, 0
    v_mov_b32 v139, 0
    v_mov_b32 v140, 0
    v_mov_b32 v141, 0
    v_mov_b32 v142, 0
    v_mov_b32 v143, 0
    v_mov_b32 v144, 0
    v_mov_b32 v145, 0
    v_mov_b32 v146, 0
    v_mov_b32 v147, 0
    v_mov_b32 v148, 0
    v_mov_b32 v149, 0
    v_mov_b32 v150, 0
    v_mov_b32 v151, 0
    s_waitcnt lgkmcnt(0)
    s_barrier
    v_add_u32 v250, 0, v248
    ds_read_b64_tr_b16 v[224:225], v250 offset:0
    ds_read_b64_tr_b16 v[226:227], v250 offset:2304
    ds_read_b64_tr_b16 v[228:229], v250 offset:32
    ds_read_b64_tr_b16 v[230:231], v250 offset:2336
    ds_read_b64_tr_b16 v[232:233], v250 offset:64
    ds_read_b64_tr_b16 v[234:235], v250 offset:2368
    s_waitcnt lgkmcnt(4)
    v_mfma_f32_16x16x32_bf16 v[80:83], v[224:227], v[8:11], v[80:83]
    ds_read_b64_tr_b16 v[236:237], v250 offset:96
    ds_read_b64_tr_b16 v[238:239], v250 offset:2400
    v_mfma_f32_16x16x32_bf16 v[84:87], v[224:227], v[12:15], v[84:87]
    s_waitcnt lgkmcnt(4)
    v_mfma_f32_16x16x32_bf16 v[88:91], v[228:231], v[8:11], v[88:91]
    ds_read_b64_tr_b16 v[240:241], v250 offset:128
    ds_read_b64_tr_b16 v[242:243], v250 offset:2432
    v_mfma_f32_16x16x32_bf16 v[92:95], v[228:231], v[12:15], v[92:95]
    s_waitcnt lgkmcnt(4)
    v_mfma_f32_16x16x32_bf16 v[96:99], v[232:235], v[8:11], v[96:99]
    ds_read_b64_tr_b16 v[244:245], v250 offset:160
    ds_read_b64_tr_b16 v[246:247], v250 offset:2464
    v_mfma_f32_16x16x32_bf16 v[100:103], v[232:235], v[12:15], v[100:103]
    s_waitcnt lgkmcnt(4)
    v_mfma_f32_16x16x32_bf16 v[104:107], v[236:239], v[8:11], v[104:107]
    ds_read_b64_tr_b16 v[224:225], v250 offset:192
    ds_read_b64_tr_b16 v[226:227], v250 offset:2496
    v_mfma_f32_16x16x32_bf16 v[108:111], v[236:239], v[12:15], v[108:111]
    s_waitcnt lgkmcnt(4)
    v_mfma_f32_16x16x32_bf16 v[112:115], v[240:243], v[8:11], v[112:115]
    ds_read_b64_tr_b16 v[228:229], v250 offset:224
    ds_read_b64_tr_b16 v[230:231], v250 offset:2528
    v_mfma_f32_16x16x32_bf16 v[116:119], v[240:243], v[12:15], v[116:119]
    s_waitcnt lgkmcnt(4)
    v_mfma_f32_16x16x32_bf16 v[120:123], v[244:247], v[8:11], v[120:123]
    ds_read_b64_tr_b16 v[232:233], v250 offset:256
    ds_read_b64_tr_b16 v[234:235], v250 offset:2560
    v_mfma_f32_16x16x32_bf16 v[124:127], v[244:247], v[12:15], v[124:127]
    s_waitcnt lgkmcnt(4)
    v_mfma_f32_16x16x32_bf16 v[128:131], v[224:227], v[8:11], v[128:131]
    v_add_u32 v250, 9216, v248
    ds_read_b64_tr_b16 v[236:237], v250 offset:0
    ds_read_b64_tr_b16 v[238:239], v250 offset:2304
    v_mfma_f32_16x16x32_bf16 v[132:135], v[224:227], v[12:15], v[132:135]
    s_waitcnt lgkmcnt(4)
    v_mfma_f32_16x16x32_bf16 v[136:139], v[228:231], v[8:11], v[136:139]
    ds_read_b64_tr_b16 v[240:241], v250 offset:32
    ds_read_b64_tr_b16 v[242:243], v250 offset:2336
    v_mfma_f32_16x16x32_bf16 v[140:143], v[228:231], v[12:15], v[140:143]
    s_waitcnt lgkmcnt(4)
    v_mfma_f32_16x16x32_bf16 v[144:147], v[232:235], v[8:11], v[144:147]
    ds_read_b64_tr_b16 v[244:245], v250 offset:64
    ds_read_b64_tr_b16 v[246:247], v250 offset:2368
    v_mfma_f32_16x16x32_bf16 v[148:151], v[232:235], v[12:15], v[148:151]
    s_waitcnt lgkmcnt(4)
    v_mfma_f32_16x16x32_bf16 v[80:83], v[236:239], v[16:19], v[80:83]
    ds_read_b64_tr_b16 v[224:225], v250 offset:96
    ds_read_b64_tr_b16 v[226:227], v250 offset:2400
    v_mfma_f32_16x16x32_bf16 v[84:87], v[236:239], v[20:23], v[84:87]
    s_waitcnt lgkmcnt(4)
    v_mfma_f32_16x16x32_bf16 v[88:91], v[240:243], v[16:19], v[88:91]
    ds_read_b64_tr_b16 v[228:229], v250 offset:128
    ds_read_b64_tr_b16 v[230:231], v250 offset:2432
    v_mfma_f32_16x16x32_bf16 v[92:95], v[240:243], v[20:23], v[92:95]
    s_waitcnt lgkmcnt(4)
    v_mfma_f32_16x16x32_bf16 v[96:99], v[244:247], v[16:19], v[96:99]
    ds_read_b64_tr_b16 v[232:233], v250 offset:160
    ds_read_b64_tr_b16 v[234:235], v250 offset:2464
    v_mfma_f32_16x16x32_bf16 v[100:103], v[244:247], v[20:23], v[100:103]
    s_waitcnt lgkmcnt(4)
    v_mfma_f32_16x16x32_bf16 v[104:107], v[224:227], v[16:19], v[104:107]
    ds_read_b64_tr_b16 v[236:237], v250 offset:192
    ds_read_b64_tr_b16 v[238:239], v250 offset:2496
    v_mfma_f32_16x16x32_bf16 v[108:111], v[224:227], v[20:23], v[108:111]
    s_waitcnt lgkmcnt(4)
    v_mfma_f32_16x16x32_bf16 v[112:115], v[228:231], v[16:19], v[112:115]
    ds_read_b64_tr_b16 v[240:241], v250 offset:224
    ds_read_b64_tr_b16 v[242:243], v250 offset:2528
    v_mfma_f32_16x16x32_bf16 v[116:119], v[228:231], v[20:23], v[116:119]
    s_waitcnt lgkmcnt(4)
    v_mfma_f32_16x16x32_bf16 v[120:123], v[232:235], v[16:19], v[120:123]
    ds_read_b64_tr_b16 v[244:245], v250 offset:256
    ds_read_b64_tr_b16 v[246:247], v250 offset:2560
    v_mfma_f32_16x16x32_bf16 v[124:127], v[232:235], v[20:23], v[124:127]
    s_waitcnt lgkmcnt(4)
    v_mfma_f32_16x16x32_bf16 v[128:131], v[236:239], v[16:19], v[128:131]
    v_add_u32 v250, 18432, v248
    ds_read_b64_tr_b16 v[224:225], v250 offset:0
    ds_read_b64_tr_b16 v[226:227], v250 offset:2304
    v_mfma_f32_16x16x32_bf16 v[132:135], v[236:239], v[20:23], v[132:135]
    s_waitcnt lgkmcnt(4)
    v_mfma_f32_16x16x32_bf16 v[136:139], v[240:243], v[16:19], v[136:139]
    ds_read_b64_tr_b16 v[228:229], v250 offset:32
    ds_read_b64_tr_b16 v[230:231], v250 offset:2336
    v_mfma_f32_16x16x32_bf16 v[140:143], v[240:243], v[20:23], v[140:143]
    s_waitcnt lgkmcnt(4)
    v_mfma_f32_16x16x32_bf16 v[144:147], v[244:247], v[16:19], v[144:147]
    ds_read_b64_tr_b16 v[232:233], v250 offset:64
    ds_read_b64_tr_b16 v[234:235], v250 offset:2368
    v_mfma_f32_16x16x32_bf16 v[148:151], v[244:247], v[20:23], v[148:151]
    s_waitcnt lgkmcnt(4)
    v_mfma_f32_16x16x32_bf16 v[80:83], v[224:227], v[24:27], v[80:83]
    ds_read_b64_tr_b16 v[236:237], v250 offset:96
    ds_read_b64_tr_b16 v[238:239], v250 offset:2400
    v_mfma_f32_16x16x32_bf16 v[84:87], v[224:227], v[28:31], v[84:87]
    s_waitcnt lgkmcnt(4)
    v_mfma_f32_16x16x32_bf16 v[88:91], v[228:231], v[24:27], v[88:91]
    ds_read_b64_tr_b16 v[240:241], v250 offset:128
    ds_read_b64_tr_b16 v[242:243], v250 offset:2432
    v_mfma_f32_16x16x32_bf16 v[92:95], v[228:231], v[28:31], v[92:95]
    s_waitcnt lgkmcnt(4)
    v_mfma_f32_16x16x32_bf16 v[96:99], v[232:235], v[24:27], v[96:99]
    ds_read_b64_tr_b16 v[244:245], v250 offset:160
    ds_read_b64_tr_b16 v[246:247], v250 offset:2464
    v_mfma_f32_16x16x32_bf16 v[100:103], v[232:235], v[28:31], v[100:103]
    s_waitcnt lgkmcnt(4)
    v_mfma_f32_16x16x32_bf16 v[104:107], v[236:239], v[24:27], v[104:107]
    ds_read_b64_tr_b16 v[224:225], v250 offset:192
    ds_read_b64_tr_b16 v[226:227], v250 offset:2496
    v_mfma_f32_16x16x32_bf16 v[108:111], v[236:239], v[28:31], v[108:111]
    s_waitcnt lgkmcnt(4)
    v_mfma_f32_16x16x32_bf16 v[112:115], v[240:243], v[24:27], v[112:115]
    ds_read_b64_tr_b16 v[228:229], v250 offset:224
    ds_read_b64_tr_b16 v[230:231], v250 offset:2528
    v_mfma_f32_16x16x32_bf16 v[116:119], v[240:243], v[28:31], v[116:119]
    s_waitcnt lgkmcnt(4)
    v_mfma_f32_16x16x32_bf16 v[120:123], v[244:247], v[24:27], v[120:123]
    ds_read_b64_tr_b16 v[232:233], v250 offset:256
    ds_read_b64_tr_b16 v[234:235], v250 offset:2560
    v_mfma_f32_16x16x32_bf16 v[124:127], v[244:247], v[28:31], v[124:127]
    s_waitcnt lgkmcnt(4)
    v_mfma_f32_16x16x32_bf16 v[128:131], v[224:227], v[24:27], v[128:131]
    v_add_u32 v250, 27648, v248
    ds_read_b64_tr_b16 v[236:237], v250 offset:0
    ds_read_b64_tr_b16 v[238:239], v250 offset:2304
    v_mfma_f32_16x16x32_bf16 v[132:135], v[224:227], v[28:31], v[132:135]
    s_waitcnt lgkmcnt(4)
    v_mfma_f32_16x16x32_bf16 v[136:139], v[228:231], v[24:27], v[136:139]
    ds_read_b64_tr_b16 v[240:241], v250 offset:32
    ds_read_b64_tr_b16 v[242:243], v250 offset:2336
    v_mfma_f32_16x16x32_bf16 v[140:143], v[228:231], v[28:31], v[140:143]
    s_waitcnt lgkmcnt(4)
    v_mfma_f32_16x16x32_bf16 v[144:147], v[232:235], v[24:27], v[144:147]
    ds_read_b64_tr_b16 v[244:245], v250 offset:64
    ds_read_b64_tr_b16 v[246:247], v250 offset:2368
    v_mfma_f32_16x16x32_bf16 v[148:151], v[232:235], v[28:31], v[148:151]
    s_waitcnt lgkmcnt(4)
    v_mfma_f32_16x16x32_bf16 v[80:83], v[236:239], v[32:35], v[80:83]
    ds_read_b64_tr_b16 v[224:225], v250 offset:96
    ds_read_b64_tr_b16 v[226:227], v250 offset:2400
    v_mfma_f32_16x16x32_bf16 v[84:87], v[236:239], v[36:39], v[84:87]
    s_waitcnt lgkmcnt(4)
    v_mfma_f32_16x16x32_bf16 v[88:91], v[240:243], v[32:35], v[88:91]
    ds_read_b64_tr_b16 v[228:229], v250 offset:128
    ds_read_b64_tr_b16 v[230:231], v250 offset:2432
    v_mfma_f32_16x16x32_bf16 v[92:95], v[240:243], v[36:39], v[92:95]
    s_waitcnt lgkmcnt(4)
    v_mfma_f32_16x16x32_bf16 v[96:99], v[244:247], v[32:35], v[96:99]
    ds_read_b64_tr_b16 v[232:233], v250 offset:160
    ds_read_b64_tr_b16 v[234:235], v250 offset:2464
    v_mfma_f32_16x16x32_bf16 v[100:103], v[244:247], v[36:39], v[100:103]
    s_waitcnt lgkmcnt(4)
    v_mfma_f32_16x16x32_bf16 v[104:107], v[224:227], v[32:35], v[104:107]
    ds_read_b64_tr_b16 v[236:237], v250 offset:192
    ds_read_b64_tr_b16 v[238:239], v250 offset:2496
    v_mfma_f32_16x16x32_bf16 v[108:111], v[224:227], v[36:39], v[108:111]
    s_waitcnt lgkmcnt(4)
    v_mfma_f32_16x16x32_bf16 v[112:115], v[228:231], v[32:35], v[112:115]
    ds_read_b64_tr_b16 v[240:241], v250 offset:224
    ds_read_b64_tr_b16 v[242:243], v250 offset:2528
    v_mfma_f32_16x16x32_bf16 v[116:119], v[228:231], v[36:39], v[116:119]
    s_waitcnt lgkmcnt(4)
    v_mfma_f32_16x16x32_bf16 v[120:123], v[232:235], v[32:35], v[120:123]
    ds_read_b64_tr_b16 v[244:245], v250 offset:256
    ds_read_b64_tr_b16 v[246:247], v250 offset:2560
    v_mfma_f32_16x16x32_bf16 v[124:127], v[232:235], v[36:39], v[124:127]
    s_waitcnt lgkmcnt(4)
    v_mfma_f32_16x16x32_bf16 v[128:131], v[236:239], v[32:35], v[128:131]
    v_add_u32 v250, 36864, v248
    ds_read_b64_tr_b16 v[224:225], v250 offset:0
    ds_read_b64_tr_b16 v[226:227], v250 offset:2304
    v_mfma_f32_16x16x32_bf16 v[132:135], v[236:239], v[36:39], v[132:135]
    s_waitcnt lgkmcnt(4)
    v_mfma_f32_16x16x32_bf16 v[136:139], v[240:243], v[32:35], v[136:139]
    ds_read_b64_tr_b16 v[228:229], v250 offset:32
    ds_read_b64_tr_b16 v[230:231], v250 offset:2336
    v_mfma_f32_16x16x32_bf16 v[140:143], v[240:243], v[36:39], v[140:143]
    s_waitcnt lgkmcnt(4)
    v_mfma_f32_16x16x32_bf16 v[144:147], v[244:247], v[32:35], v[144:147]
    ds_read_b64_tr_b16 v[232:233], v250 offset:64
    ds_read_b64_tr_b16 v[234:235], v250 offset:2368
    v_mfma_f32_16x16x32_bf16 v[148:151], v[244:247], v[36:39], v[148:151]
    s_waitcnt lgkmcnt(4)
    v_mfma_f32_16x16x32_bf16 v[80:83], v[224:227], v[40:43], v[80:83]
    ds_read_b64_tr_b16 v[236:237], v250 offset:96
    ds_read_b64_tr_b16 v[238:239], v250 offset:2400
    v_mfma_f32_16x16x32_bf16 v[84:87], v[224:227], v[44:47], v[84:87]
    s_waitcnt lgkmcnt(4)
    v_mfma_f32_16x16x32_bf16 v[88:91], v[228:231], v[40:43], v[88:91]
    ds_read_b64_tr_b16 v[240:241], v250 offset:128
    ds_read_b64_tr_b16 v[242:243], v250 offset:2432
    v_mfma_f32_16x16x32_bf16 v[92:95], v[228:231], v[44:47], v[92:95]
    s_waitcnt lgkmcnt(4)
    v_mfma_f32_16x16x32_bf16 v[96:99], v[232:235], v[40:43], v[96:99]
    ds_read_b64_tr_b16 v[244:245], v250 offset:160
    ds_read_b64_tr_b16 v[246:247], v250 offset:2464
    v_mfma_f32_16x16x32_bf16 v[100:103], v[232:235], v[44:47], v[100:103]
    s_waitcnt lgkmcnt(4)
    v_mfma_f32_16x16x32_bf16 v[104:107], v[236:239], v[40:43], v[104:107]
    ds_read_b64_tr_b16 v[224:225], v250 offset:192
    ds_read_b64_tr_b16 v[226:227], v250 offset:2496
    v_mfma_f32_16x16x32_bf16 v[108:111], v[236:239], v[44:47], v[108:111]
    s_waitcnt lgkmcnt(4)
    v_mfma_f32_16x16x32_bf16 v[112:115], v[240:243], v[40:43], v[112:115]
    ds_read_b64_tr_b16 v[228:229], v250 offset:224
    ds_read_b64_tr_b16 v[230:231], v250 offset:2528
    v_mfma_f32_16x16x32_bf16 v[116:119], v[240:243], v[44:47], v[116:119]
    s_waitcnt lgkmcnt(4)
    v_mfma_f32_16x16x32_bf16 v[120:123], v[244:247], v[40:43], v[120:123]
    ds_read_b64_tr_b16 v[232:233], v250 offset:256
    ds_read_b64_tr_b16 v[234:235], v250 offset:2560
    v_mfma_f32_16x16x32_bf16 v[124:127], v[244:247], v[44:47], v[124:127]
    s_waitcnt lgkmcnt(4)
    v_mfma_f32_16x16x32_bf16 v[128:131], v[224:227], v[40:43], v[128:131]
    v_add_u32 v250, 46080, v248
    ds_read_b64_tr_b16 v[236:237], v250 offset:0
    ds_read_b64_tr_b16 v[238:239], v250 offset:2304
    v_mfma_f32_16x16x32_bf16 v[132:135], v[224:227], v[44:47], v[132:135]
    s_waitcnt lgkmcnt(4)
    v_mfma_f32_16x16x32_bf16 v[136:139], v[228:231], v[40:43], v[136:139]
    ds_read_b64_tr_b16 v[240:241], v250 offset:32
    ds_read_b64_tr_b16 v[242:243], v250 offset:2336
    v_mfma_f32_16x16x32_bf16 v[140:143], v[228:231], v[44:47], v[140:143]
    s_waitcnt lgkmcnt(4)
    v_mfma_f32_16x16x32_bf16 v[144:147], v[232:235], v[40:43], v[144:147]
    ds_read_b64_tr_b16 v[244:245], v250 offset:64
    ds_read_b64_tr_b16 v[246:247], v250 offset:2368
    v_mfma_f32_16x16x32_bf16 v[148:151], v[232:235], v[44:47], v[148:151]
    s_waitcnt lgkmcnt(4)
    v_mfma_f32_16x16x32_bf16 v[80:83], v[236:239], v[48:51], v[80:83]
    ds_read_b64_tr_b16 v[224:225], v250 offset:96
    ds_read_b64_tr_b16 v[226:227], v250 offset:2400
    v_mfma_f32_16x16x32_bf16 v[84:87], v[236:239], v[52:55], v[84:87]
    s_waitcnt lgkmcnt(4)
    v_mfma_f32_16x16x32_bf16 v[88:91], v[240:243], v[48:51], v[88:91]
    ds_read_b64_tr_b16 v[228:229], v250 offset:128
    ds_read_b64_tr_b16 v[230:231], v250 offset:2432
    v_mfma_f32_16x16x32_bf16 v[92:95], v[240:243], v[52:55], v[92:95]
    s_waitcnt lgkmcnt(4)
    v_mfma_f32_16x16x32_bf16 v[96:99], v[244:247], v[48:51], v[96:99]
    ds_read_b64_tr_b16 v[232:233], v250 offset:160
    ds_read_b64_tr_b16 v[234:235], v250 offset:2464
    v_mfma_f32_16x16x32_bf16 v[100:103], v[244:247], v[52:55], v[100:103]
    s_waitcnt lgkmcnt(4)
    v_mfma_f32_16x16x32_bf16 v[104:107], v[224:227], v[48:51], v[104:107]
    ds_read_b64_tr_b16 v[236:237], v250 offset:192
    ds_read_b64_tr_b16 v[238:239], v250 offset:2496
    v_mfma_f32_16x16x32_bf16 v[108:111], v[224:227], v[52:55], v[108:111]
    s_waitcnt lgkmcnt(4)
    v_mfma_f32_16x16x32_bf16 v[112:115], v[228:231], v[48:51], v[112:115]
    ds_read_b64_tr_b16 v[240:241], v250 offset:224
    ds_read_b64_tr_b16 v[242:243], v250 offset:2528
    v_mfma_f32_16x16x32_bf16 v[116:119], v[228:231], v[52:55], v[116:119]
    s_waitcnt lgkmcnt(4)
    v_mfma_f32_16x16x32_bf16 v[120:123], v[232:235], v[48:51], v[120:123]
    ds_read_b64_tr_b16 v[244:245], v250 offset:256
    ds_read_b64_tr_b16 v[246:247], v250 offset:2560
    v_mfma_f32_16x16x32_bf16 v[124:127], v[232:235], v[52:55], v[124:127]
    s_waitcnt lgkmcnt(4)
    v_mfma_f32_16x16x32_bf16 v[128:131], v[236:239], v[48:51], v[128:131]
    s_barrier
    v_add_u32 v250, 82944, v248
    ds_read_b64_tr_b16 v[224:225], v250 offset:0
    ds_read_b64_tr_b16 v[226:227], v250 offset:2304
    v_mfma_f32_16x16x32_bf16 v[132:135], v[236:239], v[52:55], v[132:135]
    s_waitcnt lgkmcnt(4)
    v_mfma_f32_16x16x32_bf16 v[136:139], v[240:243], v[48:51], v[136:139]
    ds_read_b64_tr_b16 v[228:229], v250 offset:32
    ds_read_b64_tr_b16 v[230:231], v250 offset:2336
    v_mfma_f32_16x16x32_bf16 v[140:143], v[240:243], v[52:55], v[140:143]
    s_waitcnt lgkmcnt(4)
    v_mfma_f32_16x16x32_bf16 v[144:147], v[244:247], v[48:51], v[144:147]
    ds_read_b64_tr_b16 v[232:233], v250 offset:64
    ds_read_b64_tr_b16 v[234:235], v250 offset:2368
    v_mfma_f32_16x16x32_bf16 v[148:151], v[244:247], v[52:55], v[148:151]
    s_waitcnt lgkmcnt(4)
    v_mfma_f32_16x16x32_bf16 v[80:83], v[224:227], v[56:59], v[80:83]
    ds_read_b64_tr_b16 v[236:237], v250 offset:96
    ds_read_b64_tr_b16 v[238:239], v250 offset:2400
    v_mfma_f32_16x16x32_bf16 v[84:87], v[224:227], v[60:63], v[84:87]
    s_waitcnt lgkmcnt(4)
    v_mfma_f32_16x16x32_bf16 v[88:91], v[228:231], v[56:59], v[88:91]
    ds_read_b64_tr_b16 v[240:241], v250 offset:128
    ds_read_b64_tr_b16 v[242:243], v250 offset:2432
    v_mfma_f32_16x16x32_bf16 v[92:95], v[228:231], v[60:63], v[92:95]
    s_waitcnt lgkmcnt(4)
    v_mfma_f32_16x16x32_bf16 v[96:99], v[232:235], v[56:59], v[96:99]
    ds_read_b64_tr_b16 v[244:245], v250 offset:160
    ds_read_b64_tr_b16 v[246:247], v250 offset:2464
    v_mfma_f32_16x16x32_bf16 v[100:103], v[232:235], v[60:63], v[100:103]
    s_waitcnt lgkmcnt(4)
    v_mfma_f32_16x16x32_bf16 v[104:107], v[236:239], v[56:59], v[104:107]
    ds_read_b64_tr_b16 v[224:225], v250 offset:192
    ds_read_b64_tr_b16 v[226:227], v250 offset:2496
    v_mfma_f32_16x16x32_bf16 v[108:111], v[236:239], v[60:63], v[108:111]
    s_waitcnt lgkmcnt(4)
    v_mfma_f32_16x16x32_bf16 v[112:115], v[240:243], v[56:59], v[112:115]
    ds_read_b64_tr_b16 v[228:229], v250 offset:224
    ds_read_b64_tr_b16 v[230:231], v250 offset:2528
    v_mfma_f32_16x16x32_bf16 v[116:119], v[240:243], v[60:63], v[116:119]
    s_waitcnt lgkmcnt(4)
    v_mfma_f32_16x16x32_bf16 v[120:123], v[244:247], v[56:59], v[120:123]
    ds_read_b64_tr_b16 v[232:233], v250 offset:256
    ds_read_b64_tr_b16 v[234:235], v250 offset:2560
    v_mfma_f32_16x16x32_bf16 v[124:127], v[244:247], v[60:63], v[124:127]
    s_waitcnt lgkmcnt(4)
    v_mfma_f32_16x16x32_bf16 v[128:131], v[224:227], v[56:59], v[128:131]
    v_add_u32 v250, 92160, v248
    ds_read_b64_tr_b16 v[236:237], v250 offset:0
    ds_read_b64_tr_b16 v[238:239], v250 offset:2304
    v_mfma_f32_16x16x32_bf16 v[132:135], v[224:227], v[60:63], v[132:135]
    s_waitcnt lgkmcnt(4)
    v_mfma_f32_16x16x32_bf16 v[136:139], v[228:231], v[56:59], v[136:139]
    ds_read_b64_tr_b16 v[240:241], v250 offset:32
    ds_read_b64_tr_b16 v[242:243], v250 offset:2336
    v_mfma_f32_16x16x32_bf16 v[140:143], v[228:231], v[60:63], v[140:143]
    s_waitcnt lgkmcnt(4)
    v_mfma_f32_16x16x32_bf16 v[144:147], v[232:235], v[56:59], v[144:147]
    ds_read_b64_tr_b16 v[244:245], v250 offset:64
    ds_read_b64_tr_b16 v[246:247], v250 offset:2368
    v_mfma_f32_16x16x32_bf16 v[148:151], v[232:235], v[60:63], v[148:151]
    s_waitcnt lgkmcnt(4)
    v_mfma_f32_16x16x32_bf16 v[80:83], v[236:239], v[64:67], v[80:83]
    ds_read_b64_tr_b16 v[224:225], v250 offset:96
    ds_read_b64_tr_b16 v[226:227], v250 offset:2400
    v_mfma_f32_16x16x32_bf16 v[84:87], v[236:239], v[68:71], v[84:87]
    s_waitcnt lgkmcnt(4)
    v_mfma_f32_16x16x32_bf16 v[88:91], v[240:243], v[64:67], v[88:91]
    ds_read_b64_tr_b16 v[228:229], v250 offset:128
    ds_read_b64_tr_b16 v[230:231], v250 offset:2432
    v_mfma_f32_16x16x32_bf16 v[92:95], v[240:243], v[68:71], v[92:95]
    s_waitcnt lgkmcnt(4)
    v_mfma_f32_16x16x32_bf16 v[96:99], v[244:247], v[64:67], v[96:99]
    ds_read_b64_tr_b16 v[232:233], v250 offset:160
    ds_read_b64_tr_b16 v[234:235], v250 offset:2464
    v_mfma_f32_16x16x32_bf16 v[100:103], v[244:247], v[68:71], v[100:103]
    s_waitcnt lgkmcnt(4)
    v_mfma_f32_16x16x32_bf16 v[104:107], v[224:227], v[64:67], v[104:107]
    ds_read_b64_tr_b16 v[236:237], v250 offset:192
    ds_read_b64_tr_b16 v[238:239], v250 offset:2496
    v_mfma_f32_16x16x32_bf16 v[108:111], v[224:227], v[68:71], v[108:111]
    s_waitcnt lgkmcnt(4)
    v_mfma_f32_16x16x32_bf16 v[112:115], v[228:231], v[64:67], v[112:115]
    ds_read_b64_tr_b16 v[240:241], v250 offset:224
    ds_read_b64_tr_b16 v[242:243], v250 offset:2528
    v_mfma_f32_16x16x32_bf16 v[116:119], v[228:231], v[68:71], v[116:119]
    s_waitcnt lgkmcnt(4)
    v_mfma_f32_16x16x32_bf16 v[120:123], v[232:235], v[64:67], v[120:123]
    ds_read_b64_tr_b16 v[244:245], v250 offset:256
    ds_read_b64_tr_b16 v[246:247], v250 offset:2560
    v_mfma_f32_16x16x32_bf16 v[124:127], v[232:235], v[68:71], v[124:127]
    s_waitcnt lgkmcnt(4)
    v_mfma_f32_16x16x32_bf16 v[128:131], v[236:239], v[64:67], v[128:131]
    v_add_u32 v250, 101376, v248
    ds_read_b64_tr_b16 v[224:225], v250 offset:0
    ds_read_b64_tr_b16 v[226:227], v250 offset:2304
    v_mfma_f32_16x16x32_bf16 v[132:135], v[236:239], v[68:71], v[132:135]
    s_waitcnt lgkmcnt(4)
    v_mfma_f32_16x16x32_bf16 v[136:139], v[240:243], v[64:67], v[136:139]
    ds_read_b64_tr_b16 v[228:229], v250 offset:32
    ds_read_b64_tr_b16 v[230:231], v250 offset:2336
    v_mfma_f32_16x16x32_bf16 v[140:143], v[240:243], v[68:71], v[140:143]
    s_waitcnt lgkmcnt(4)
    v_mfma_f32_16x16x32_bf16 v[144:147], v[244:247], v[64:67], v[144:147]
    ds_read_b64_tr_b16 v[232:233], v250 offset:64
    ds_read_b64_tr_b16 v[234:235], v250 offset:2368
    v_mfma_f32_16x16x32_bf16 v[148:151], v[244:247], v[68:71], v[148:151]
    s_waitcnt lgkmcnt(4)
    v_mfma_f32_16x16x32_bf16 v[80:83], v[224:227], v[72:75], v[80:83]
    ds_read_b64_tr_b16 v[236:237], v250 offset:96
    ds_read_b64_tr_b16 v[238:239], v250 offset:2400
    v_mfma_f32_16x16x32_bf16 v[84:87], v[224:227], v[76:79], v[84:87]
    s_waitcnt lgkmcnt(4)
    v_mfma_f32_16x16x32_bf16 v[88:91], v[228:231], v[72:75], v[88:91]
    ds_read_b64_tr_b16 v[240:241], v250 offset:128
    ds_read_b64_tr_b16 v[242:243], v250 offset:2432
    v_mfma_f32_16x16x32_bf16 v[92:95], v[228:231], v[76:79], v[92:95]
    s_waitcnt lgkmcnt(4)
    v_mfma_f32_16x16x32_bf16 v[96:99], v[232:235], v[72:75], v[96:99]
    ds_read_b64_tr_b16 v[244:245], v250 offset:160
    ds_read_b64_tr_b16 v[246:247], v250 offset:2464
    v_mfma_f32_16x16x32_bf16 v[100:103], v[232:235], v[76:79], v[100:103]
    s_waitcnt lgkmcnt(4)
    v_mfma_f32_16x16x32_bf16 v[104:107], v[236:239], v[72:75], v[104:107]
    ds_read_b64_tr_b16 v[224:225], v250 offset:192
    ds_read_b64_tr_b16 v[226:227], v250 offset:2496
    v_mfma_f32_16x16x32_bf16 v[108:111], v[236:239], v[76:79], v[108:111]
    s_waitcnt lgkmcnt(4)
    v_mfma_f32_16x16x32_bf16 v[112:115], v[240:243], v[72:75], v[112:115]
    ds_read_b64_tr_b16 v[228:229], v250 offset:224
    ds_read_b64_tr_b16 v[230:231], v250 offset:2528
    v_mfma_f32_16x16x32_bf16 v[116:119], v[240:243], v[76:79], v[116:119]
    s_waitcnt lgkmcnt(4)
    v_mfma_f32_16x16x32_bf16 v[120:123], v[244:247], v[72:75], v[120:123]
    ds_read_b64_tr_b16 v[232:233], v250 offset:256
    ds_read_b64_tr_b16 v[234:235], v250 offset:2560
    v_mfma_f32_16x16x32_bf16 v[124:127], v[244:247], v[76:79], v[124:127]
    s_waitcnt lgkmcnt(4)
    v_mfma_f32_16x16x32_bf16 v[128:131], v[224:227], v[72:75], v[128:131]
    v_add_u32 v250, 110592, v248
    ds_read_b64_tr_b16 v[236:237], v250 offset:0
    ds_read_b64_tr_b16 v[238:239], v250 offset:2304
    v_mfma_f32_16x16x32_bf16 v[132:135], v[224:227], v[76:79], v[132:135]
    s_waitcnt lgkmcnt(4)
    v_mfma_f32_16x16x32_bf16 v[136:139], v[228:231], v[72:75], v[136:139]
    ds_read_b64_tr_b16 v[240:241], v250 offset:32
    ds_read_b64_tr_b16 v[242:243], v250 offset:2336
    v_mfma_f32_16x16x32_bf16 v[140:143], v[228:231], v[76:79], v[140:143]
    s_waitcnt lgkmcnt(4)
    v_mfma_f32_16x16x32_bf16 v[144:147], v[232:235], v[72:75], v[144:147]
    ds_read_b64_tr_b16 v[244:245], v250 offset:64
    ds_read_b64_tr_b16 v[246:247], v250 offset:2368
    v_mfma_f32_16x16x32_bf16 v[148:151], v[232:235], v[76:79], v[148:151]
    s_load_dwordx4 s[8:11], s[0:1], 8
    s_waitcnt lgkmcnt(0)
    s_mov_b32 s24, s10
    s_mov_b32 s25, s11
    s_mov_b32 s26, 2359296
    s_mov_b32 s27, 0x20000
    s_sub_u32 s44, s8, 3456
    s_subb_u32 s45, s9, 0
    s_mov_b32 s46, 2362752
    s_mov_b32 s47, 0x20000
    s_add_u32 s8, s42, 54525952
    s_addc_u32 s9, s43, 0
    s_mov_b32 s10, 2359296
    s_mov_b32 s11, 0x20000
    s_lshr_b32 s60, s2, 3
    s_lshl_b32 s60, s60, 6
    s_and_b32 s61, s2, 7
    s_mul_i32 s61, s61, 72
    s_lshl_b32 s62, s30, 4
    s_add_u32 s62, s62, s60
    v_lshrrev_b32 v2, 3, v1
    v_add_u32 v2, s62, v2
    v_and_b32 v3, 7, v1
    v_mul_u32_u24 v4, 1152, v2
    v_lshl_add_u32 v4, v3, 4, v4
    s_lshl_b32 s62, s61, 1
    buffer_load_dwordx4 v[24:27], v4, s[24:27], s62 offen
    buffer_load_dwordx4 v[8:11], v4, s[44:47], s62 offen offset:3456
    v_cmp_gt_u32 vcc, 1, v2
    v_mov_b32 v3, 2146435072
    s_nop 0
    v_cndmask_b32 v3, v4, v3, vcc
    buffer_load_dwordx4 v[12:15], v3, s[44:47], s62 offen offset:2304
    v_cmp_gt_u32 vcc, 2, v2
    v_mov_b32 v3, 2146435072
    s_nop 0
    v_cndmask_b32 v3, v4, v3, vcc
    buffer_load_dwordx4 v[16:19], v3, s[44:47], s62 offen offset:1152
    v_cmp_gt_u32 vcc, 3, v2
    v_mov_b32 v3, 2146435072
    s_nop 0
    v_cndmask_b32 v3, v4, v3, vcc
    buffer_load_dwordx4 v[20:23], v3, s[44:47], s62 offen offset:0
    s_lshl_b32 s62, s30, 4
    s_add_u32 s62, s62, s60
    s_add_u32 s62, s62, 8
    v_lshrrev_b32 v2, 3, v1
    v_add_u32 v2, s62, v2
    v_and_b32 v3, 7, v1
    v_mul_u32_u24 v4, 1152, v2
    v_lshl_add_u32 v4, v3, 4, v4
    s_lshl_b32 s62, s61, 1
    buffer_load_dwordx4 v[44:47], v4, s[24:27], s62 offen
    buffer_load_dwordx4 v[28:31], v4, s[44:47], s62 offen offset:3456
    buffer_load_dwordx4 v[32:35], v4, s[44:47], s62 offen offset:2304
    buffer_load_dwordx4 v[36:39], v4, s[44:47], s62 offen offset:1152
    buffer_load_dwordx4 v[40:43], v4, s[44:47], s62 offen offset:0
    s_lshl_b32 s62, s30, 4
    s_add_u32 s62, s62, s60
    v_and_b32 v2, 15, v1
    v_add_u32 v2, s62, v2
    v_mov_b32 v3, 8
    v_mul_u32_u24 v4, 1152, v2
    v_lshl_add_u32 v4, v3, 4, v4
    s_lshl_b32 s62, s61, 1
    buffer_load_dwordx4 v[64:67], v4, s[24:27], s62 offen
    buffer_load_dwordx4 v[48:51], v4, s[44:47], s62 offen offset:3456
    v_cmp_gt_u32 vcc, 1, v2
    v_mov_b32 v3, 2146435072
    s_nop 0
    v_cndmask_b32 v3, v4, v3, vcc
    buffer_load_dwordx4 v[52:55], v3, s[44:47], s62 offen offset:2304
    v_cmp_gt_u32 vcc, 2, v2
    v_mov_b32 v3, 2146435072
    s_nop 0
    v_cndmask_b32 v3, v4, v3, vcc
    buffer_load_dwordx4 v[56:59], v3, s[44:47], s62 offen offset:1152
    v_cmp_gt_u32 vcc, 3, v2
    v_mov_b32 v3, 2146435072
    s_nop 0
    v_cndmask_b32 v3, v4, v3, vcc
    buffer_load_dwordx4 v[60:63], v3, s[44:47], s62 offen offset:0
    v_mfma_f32_16x16x32_bf16 v[80:83], v[236:239], v[152:155], v[80:83]
    ds_read_b64_tr_b16 v[224:225], v250 offset:96
    ds_read_b64_tr_b16 v[226:227], v250 offset:2400
    v_mfma_f32_16x16x32_bf16 v[84:87], v[236:239], v[156:159], v[84:87]
    v_mfma_f32_16x16x32_bf16 v[88:91], v[240:243], v[152:155], v[88:91]
    ds_read_b64_tr_b16 v[228:229], v250 offset:128
    ds_read_b64_tr_b16 v[230:231], v250 offset:2432
    v_mfma_f32_16x16x32_bf16 v[92:95], v[240:243], v[156:159], v[92:95]
    v_mfma_f32_16x16x32_bf16 v[96:99], v[244:247], v[152:155], v[96:99]
    ds_read_b64_tr_b16 v[232:233], v250 offset:160
    ds_read_b64_tr_b16 v[234:235], v250 offset:2464
    v_mfma_f32_16x16x32_bf16 v[100:103], v[244:247], v[156:159], v[100:103]
    s_waitcnt lgkmcnt(4)
    v_mfma_f32_16x16x32_bf16 v[104:107], v[224:227], v[152:155], v[104:107]
    ds_read_b64_tr_b16 v[236:237], v250 offset:192
    ds_read_b64_tr_b16 v[238:239], v250 offset:2496
    v_mfma_f32_16x16x32_bf16 v[108:111], v[224:227], v[156:159], v[108:111]
    s_waitcnt lgkmcnt(4)
    v_mfma_f32_16x16x32_bf16 v[112:115], v[228:231], v[152:155], v[112:115]
    ds_read_b64_tr_b16 v[240:241], v250 offset:224
    ds_read_b64_tr_b16 v[242:243], v250 offset:2528
    v_mfma_f32_16x16x32_bf16 v[116:119], v[228:231], v[156:159], v[116:119]
    s_waitcnt lgkmcnt(4)
    v_mfma_f32_16x16x32_bf16 v[120:123], v[232:235], v[152:155], v[120:123]
    ds_read_b64_tr_b16 v[244:245], v250 offset:256
    ds_read_b64_tr_b16 v[246:247], v250 offset:2560
    v_mfma_f32_16x16x32_bf16 v[124:127], v[232:235], v[156:159], v[124:127]
    s_waitcnt lgkmcnt(4)
    v_mfma_f32_16x16x32_bf16 v[128:131], v[236:239], v[152:155], v[128:131]
    s_barrier
    v_add_u32 v250, 119808, v248
    ds_read_b64_tr_b16 v[224:225], v250 offset:0
    ds_read_b64_tr_b16 v[226:227], v250 offset:2304
    v_mfma_f32_16x16x32_bf16 v[132:135], v[236:239], v[156:159], v[132:135]
    s_waitcnt lgkmcnt(4)
    v_mfma_f32_16x16x32_bf16 v[136:139], v[240:243], v[152:155], v[136:139]
    ds_read_b64_tr_b16 v[228:229], v250 offset:32
    ds_read_b64_tr_b16 v[230:231], v250 offset:2336
    v_mfma_f32_16x16x32_bf16 v[140:143], v[240:243], v[156:159], v[140:143]
    s_waitcnt lgkmcnt(4)
    v_mfma_f32_16x16x32_bf16 v[144:147], v[244:247], v[152:155], v[144:147]
    ds_read_b64_tr_b16 v[232:233], v250 offset:64
    ds_read_b64_tr_b16 v[234:235], v250 offset:2368
    v_mfma_f32_16x16x32_bf16 v[148:151], v[244:247], v[156:159], v[148:151]
    s_waitcnt lgkmcnt(4)
    v_mfma_f32_16x16x32_bf16 v[80:83], v[224:227], v[160:163], v[80:83]
    ds_read_b64_tr_b16 v[236:237], v250 offset:96
    ds_read_b64_tr_b16 v[238:239], v250 offset:2400
    v_mfma_f32_16x16x32_bf16 v[84:87], v[224:227], v[164:167], v[84:87]
    s_waitcnt lgkmcnt(4)
    v_mfma_f32_16x16x32_bf16 v[88:91], v[228:231], v[160:163], v[88:91]
    ds_read_b64_tr_b16 v[240:241], v250 offset:128
    ds_read_b64_tr_b16 v[242:243], v250 offset:2432
    v_mfma_f32_16x16x32_bf16 v[92:95], v[228:231], v[164:167], v[92:95]
    s_waitcnt lgkmcnt(4)
    v_mfma_f32_16x16x32_bf16 v[96:99], v[232:235], v[160:163], v[96:99]
    ds_read_b64_tr_b16 v[244:245], v250 offset:160
    ds_read_b64_tr_b16 v[246:247], v250 offset:2464
    v_mfma_f32_16x16x32_bf16 v[100:103], v[232:235], v[164:167], v[100:103]
    s_waitcnt lgkmcnt(4)
    v_mfma_f32_16x16x32_bf16 v[104:107], v[236:239], v[160:163], v[104:107]
    ds_read_b64_tr_b16 v[224:225], v250 offset:192
    ds_read_b64_tr_b16 v[226:227], v250 offset:2496
    v_mfma_f32_16x16x32_bf16 v[108:111], v[236:239], v[164:167], v[108:111]
    s_waitcnt lgkmcnt(4)
    v_mfma_f32_16x16x32_bf16 v[112:115], v[240:243], v[160:163], v[112:115]
    ds_read_b64_tr_b16 v[228:229], v250 offset:224
    ds_read_b64_tr_b16 v[230:231], v250 offset:2528
    v_mfma_f32_16x16x32_bf16 v[116:119], v[240:243], v[164:167], v[116:119]
    s_waitcnt lgkmcnt(4)
    v_mfma_f32_16x16x32_bf16 v[120:123], v[244:247], v[160:163], v[120:123]
    ds_read_b64_tr_b16 v[232:233], v250 offset:256
    ds_read_b64_tr_b16 v[234:235], v250 offset:2560
    v_mfma_f32_16x16x32_bf16 v[124:127], v[244:247], v[164:167], v[124:127]
    s_waitcnt lgkmcnt(4)
    v_mfma_f32_16x16x32_bf16 v[128:131], v[224:227], v[160:163], v[128:131]
    v_add_u32 v250, 129024, v248
    ds_read_b64_tr_b16 v[236:237], v250 offset:0
    ds_read_b64_tr_b16 v[238:239], v250 offset:2304
    v_mfma_f32_16x16x32_bf16 v[132:135], v[224:227], v[164:167], v[132:135]
    s_waitcnt lgkmcnt(4)
    v_mfma_f32_16x16x32_bf16 v[136:139], v[228:231], v[160:163], v[136:139]
    ds_read_b64_tr_b16 v[240:241], v250 offset:32
    ds_read_b64_tr_b16 v[242:243], v250 offset:2336
    v_mfma_f32_16x16x32_bf16 v[140:143], v[228:231], v[164:167], v[140:143]
    s_waitcnt lgkmcnt(4)
    v_mfma_f32_16x16x32_bf16 v[144:147], v[232:235], v[160:163], v[144:147]
    ds_read_b64_tr_b16 v[244:245], v250 offset:64
    ds_read_b64_tr_b16 v[246:247], v250 offset:2368
    v_mfma_f32_16x16x32_bf16 v[148:151], v[232:235], v[164:167], v[148:151]
    s_waitcnt lgkmcnt(4)
    v_mfma_f32_16x16x32_bf16 v[80:83], v[236:239], v[168:171], v[80:83]
    ds_read_b64_tr_b16 v[224:225], v250 offset:96
    ds_read_b64_tr_b16 v[226:227], v250 offset:2400
    v_mfma_f32_16x16x32_bf16 v[84:87], v[236:239], v[172:175], v[84:87]
    s_waitcnt lgkmcnt(4)
    v_mfma_f32_16x16x32_bf16 v[88:91], v[240:243], v[168:171], v[88:91]
    ds_read_b64_tr_b16 v[228:229], v250 offset:128
    ds_read_b64_tr_b16 v[230:231], v250 offset:2432
    v_mfma_f32_16x16x32_bf16 v[92:95], v[240:243], v[172:175], v[92:95]
    s_waitcnt lgkmcnt(4)
    v_mfma_f32_16x16x32_bf16 v[96:99], v[244:247], v[168:171], v[96:99]
    ds_read_b64_tr_b16 v[232:233], v250 offset:160
    ds_read_b64_tr_b16 v[234:235], v250 offset:2464
    v_mfma_f32_16x16x32_bf16 v[100:103], v[244:247], v[172:175], v[100:103]
    s_waitcnt lgkmcnt(4)
    v_mfma_f32_16x16x32_bf16 v[104:107], v[224:227], v[168:171], v[104:107]
    ds_read_b64_tr_b16 v[236:237], v250 offset:192
    ds_read_b64_tr_b16 v[238:239], v250 offset:2496
    v_mfma_f32_16x16x32_bf16 v[108:111], v[224:227], v[172:175], v[108:111]
    s_waitcnt lgkmcnt(4)
    v_mfma_f32_16x16x32_bf16 v[112:115], v[228:231], v[168:171], v[112:115]
    ds_read_b64_tr_b16 v[240:241], v250 offset:224
    ds_read_b64_tr_b16 v[242:243], v250 offset:2528
    v_mfma_f32_16x16x32_bf16 v[116:119], v[228:231], v[172:175], v[116:119]
    s_waitcnt lgkmcnt(4)
    v_mfma_f32_16x16x32_bf16 v[120:123], v[232:235], v[168:171], v[120:123]
    ds_read_b64_tr_b16 v[244:245], v250 offset:256
    ds_read_b64_tr_b16 v[246:247], v250 offset:2560
    v_mfma_f32_16x16x32_bf16 v[124:127], v[232:235], v[172:175], v[124:127]
    s_waitcnt lgkmcnt(4)
    v_mfma_f32_16x16x32_bf16 v[128:131], v[236:239], v[168:171], v[128:131]
    v_add_u32 v250, 138240, v248
    ds_read_b64_tr_b16 v[224:225], v250 offset:0
    ds_read_b64_tr_b16 v[226:227], v250 offset:2304
    v_mfma_f32_16x16x32_bf16 v[132:135], v[236:239], v[172:175], v[132:135]
    s_waitcnt lgkmcnt(4)
    v_mfma_f32_16x16x32_bf16 v[136:139], v[240:243], v[168:171], v[136:139]
    ds_read_b64_tr_b16 v[228:229], v250 offset:32
    ds_read_b64_tr_b16 v[230:231], v250 offset:2336
    v_mfma_f32_16x16x32_bf16 v[140:143], v[240:243], v[172:175], v[140:143]
    s_waitcnt lgkmcnt(4)
    v_mfma_f32_16x16x32_bf16 v[144:147], v[244:247], v[168:171], v[144:147]
    ds_read_b64_tr_b16 v[232:233], v250 offset:64
    ds_read_b64_tr_b16 v[234:235], v250 offset:2368
    v_mfma_f32_16x16x32_bf16 v[148:151], v[244:247], v[172:175], v[148:151]
    s_waitcnt lgkmcnt(4)
    v_mfma_f32_16x16x32_bf16 v[80:83], v[224:227], v[176:179], v[80:83]
    ds_read_b64_tr_b16 v[236:237], v250 offset:96
    ds_read_b64_tr_b16 v[238:239], v250 offset:2400
    v_mfma_f32_16x16x32_bf16 v[84:87], v[224:227], v[180:183], v[84:87]
    s_waitcnt lgkmcnt(4)
    v_mfma_f32_16x16x32_bf16 v[88:91], v[228:231], v[176:179], v[88:91]
    ds_read_b64_tr_b16 v[240:241], v250 offset:128
    ds_read_b64_tr_b16 v[242:243], v250 offset:2432
    v_mfma_f32_16x16x32_bf16 v[92:95], v[228:231], v[180:183], v[92:95]
    s_waitcnt lgkmcnt(4)
    v_mfma_f32_16x16x32_bf16 v[96:99], v[232:235], v[176:179], v[96:99]
    ds_read_b64_tr_b16 v[244:245], v250 offset:160
    ds_read_b64_tr_b16 v[246:247], v250 offset:2464
    v_mfma_f32_16x16x32_bf16 v[100:103], v[232:235], v[180:183], v[100:103]
    s_waitcnt lgkmcnt(4)
    v_mfma_f32_16x16x32_bf16 v[104:107], v[236:239], v[176:179], v[104:107]
    ds_read_b64_tr_b16 v[224:225], v250 offset:192
    ds_read_b64_tr_b16 v[226:227], v250 offset:2496
    v_mfma_f32_16x16x32_bf16 v[108:111], v[236:239], v[180:183], v[108:111]
    s_waitcnt lgkmcnt(4)
    v_mfma_f32_16x16x32_bf16 v[112:115], v[240:243], v[176:179], v[112:115]
    ds_read_b64_tr_b16 v[228:229], v250 offset:224
    ds_read_b64_tr_b16 v[230:231], v250 offset:2528
    v_mfma_f32_16x16x32_bf16 v[116:119], v[240:243], v[180:183], v[116:119]
    s_waitcnt lgkmcnt(4)
    v_mfma_f32_16x16x32_bf16 v[120:123], v[244:247], v[176:179], v[120:123]
    ds_read_b64_tr_b16 v[232:233], v250 offset:256
    ds_read_b64_tr_b16 v[234:235], v250 offset:2560
    v_mfma_f32_16x16x32_bf16 v[124:127], v[244:247], v[180:183], v[124:127]
    s_waitcnt lgkmcnt(4)
    v_mfma_f32_16x16x32_bf16 v[128:131], v[224:227], v[176:179], v[128:131]
    v_add_u32 v250, 55296, v248
    ds_read_b64_tr_b16 v[236:237], v250 offset:0
    ds_read_b64_tr_b16 v[238:239], v250 offset:2304
    v_mfma_f32_16x16x32_bf16 v[132:135], v[224:227], v[180:183], v[132:135]
    s_waitcnt lgkmcnt(4)
    v_mfma_f32_16x16x32_bf16 v[136:139], v[228:231], v[176:179], v[136:139]
    ds_read_b64_tr_b16 v[240:241], v250 offset:32
    ds_read_b64_tr_b16 v[242:243], v250 offset:2336
    v_mfma_f32_16x16x32_bf16 v[140:143], v[228:231], v[180:183], v[140:143]
    s_waitcnt lgkmcnt(4)
    v_mfma_f32_16x16x32_bf16 v[144:147], v[232:235], v[176:179], v[144:147]
    ds_read_b64_tr_b16 v[244:245], v250 offset:64
    ds_read_b64_tr_b16 v[246:247], v250 offset:2368
    v_mfma_f32_16x16x32_bf16 v[148:151], v[232:235], v[180:183], v[148:151]
    s_waitcnt lgkmcnt(4)
    v_mfma_f32_16x16x32_bf16 v[80:83], v[236:239], v[184:187], v[80:83]
    ds_read_b64_tr_b16 v[224:225], v250 offset:96
    ds_read_b64_tr_b16 v[226:227], v250 offset:2400
    v_mfma_f32_16x16x32_bf16 v[84:87], v[236:239], v[188:191], v[84:87]
    s_waitcnt lgkmcnt(4)
    v_mfma_f32_16x16x32_bf16 v[88:91], v[240:243], v[184:187], v[88:91]
    ds_read_b64_tr_b16 v[228:229], v250 offset:128
    ds_read_b64_tr_b16 v[230:231], v250 offset:2432
    v_mfma_f32_16x16x32_bf16 v[92:95], v[240:243], v[188:191], v[92:95]
    s_waitcnt lgkmcnt(4)
    v_mfma_f32_16x16x32_bf16 v[96:99], v[244:247], v[184:187], v[96:99]
    ds_read_b64_tr_b16 v[232:233], v250 offset:160
    ds_read_b64_tr_b16 v[234:235], v250 offset:2464
    v_mfma_f32_16x16x32_bf16 v[100:103], v[244:247], v[188:191], v[100:103]
    s_waitcnt lgkmcnt(4)
    v_mfma_f32_16x16x32_bf16 v[104:107], v[224:227], v[184:187], v[104:107]
    ds_read_b64_tr_b16 v[236:237], v250 offset:192
    ds_read_b64_tr_b16 v[238:239], v250 offset:2496
    v_mfma_f32_16x16x32_bf16 v[108:111], v[224:227], v[188:191], v[108:111]
    s_waitcnt lgkmcnt(4)
    v_mfma_f32_16x16x32_bf16 v[112:115], v[228:231], v[184:187], v[112:115]
    ds_read_b64_tr_b16 v[240:241], v250 offset:224
    ds_read_b64_tr_b16 v[242:243], v250 offset:2528
    v_mfma_f32_16x16x32_bf16 v[116:119], v[228:231], v[188:191], v[116:119]
    s_waitcnt lgkmcnt(4)
    v_mfma_f32_16x16x32_bf16 v[120:123], v[232:235], v[184:187], v[120:123]
    ds_read_b64_tr_b16 v[244:245], v250 offset:256
    ds_read_b64_tr_b16 v[246:247], v250 offset:2560
    v_mfma_f32_16x16x32_bf16 v[124:127], v[232:235], v[188:191], v[124:127]
    s_waitcnt lgkmcnt(4)
    v_mfma_f32_16x16x32_bf16 v[128:131], v[236:239], v[184:187], v[128:131]
    s_barrier
    v_add_u32 v250, 64512, v248
    ds_read_b64_tr_b16 v[224:225], v250 offset:0
    ds_read_b64_tr_b16 v[226:227], v250 offset:2304
    v_mfma_f32_16x16x32_bf16 v[132:135], v[236:239], v[188:191], v[132:135]
    s_waitcnt lgkmcnt(4)
    v_mfma_f32_16x16x32_bf16 v[136:139], v[240:243], v[184:187], v[136:139]
    ds_read_b64_tr_b16 v[228:229], v250 offset:32
    ds_read_b64_tr_b16 v[230:231], v250 offset:2336
    v_mfma_f32_16x16x32_bf16 v[140:143], v[240:243], v[188:191], v[140:143]
    s_waitcnt lgkmcnt(4)
    v_mfma_f32_16x16x32_bf16 v[144:147], v[244:247], v[184:187], v[144:147]
    ds_read_b64_tr_b16 v[232:233], v250 offset:64
    ds_read_b64_tr_b16 v[234:235], v250 offset:2368
    v_mfma_f32_16x16x32_bf16 v[148:151], v[244:247], v[188:191], v[148:151]
    s_waitcnt lgkmcnt(4)
    v_mfma_f32_16x16x32_bf16 v[80:83], v[224:227], v[192:195], v[80:83]
    ds_read_b64_tr_b16 v[236:237], v250 offset:96
    ds_read_b64_tr_b16 v[238:239], v250 offset:2400
    v_mfma_f32_16x16x32_bf16 v[84:87], v[224:227], v[196:199], v[84:87]
    s_waitcnt lgkmcnt(4)
    v_mfma_f32_16x16x32_bf16 v[88:91], v[228:231], v[192:195], v[88:91]
    ds_read_b64_tr_b16 v[240:241], v250 offset:128
    ds_read_b64_tr_b16 v[242:243], v250 offset:2432
    v_mfma_f32_16x16x32_bf16 v[92:95], v[228:231], v[196:199], v[92:95]
    s_waitcnt lgkmcnt(4)
    v_mfma_f32_16x16x32_bf16 v[96:99], v[232:235], v[192:195], v[96:99]
    ds_read_b64_tr_b16 v[244:245], v250 offset:160
    ds_read_b64_tr_b16 v[246:247], v250 offset:2464
    v_mfma_f32_16x16x32_bf16 v[100:103], v[232:235], v[196:199], v[100:103]
    s_waitcnt lgkmcnt(4)
    v_mfma_f32_16x16x32_bf16 v[104:107], v[236:239], v[192:195], v[104:107]
    ds_read_b64_tr_b16 v[224:225], v250 offset:192
    ds_read_b64_tr_b16 v[226:227], v250 offset:2496
    v_mfma_f32_16x16x32_bf16 v[108:111], v[236:239], v[196:199], v[108:111]
    s_waitcnt lgkmcnt(4)
    v_mfma_f32_16x16x32_bf16 v[112:115], v[240:243], v[192:195], v[112:115]
    ds_read_b64_tr_b16 v[228:229], v250 offset:224
    ds_read_b64_tr_b16 v[230:231], v250 offset:2528
    v_mfma_f32_16x16x32_bf16 v[116:119], v[240:243], v[196:199], v[116:119]
    s_waitcnt lgkmcnt(4)
    v_mfma_f32_16x16x32_bf16 v[120:123], v[244:247], v[192:195], v[120:123]
    ds_read_b64_tr_b16 v[232:233], v250 offset:256
    ds_read_b64_tr_b16 v[234:235], v250 offset:2560
    v_mfma_f32_16x16x32_bf16 v[124:127], v[244:247], v[196:199], v[124:127]
    s_waitcnt lgkmcnt(4)
    v_mfma_f32_16x16x32_bf16 v[128:131], v[224:227], v[192:195], v[128:131]
    v_add_u32 v250, 73728, v248
    ds_read_b64_tr_b16 v[236:237], v250 offset:0
    ds_read_b64_tr_b16 v[238:239], v250 offset:2304
    v_mfma_f32_16x16x32_bf16 v[132:135], v[224:227], v[196:199], v[132:135]
    s_waitcnt lgkmcnt(4)
    v_mfma_f32_16x16x32_bf16 v[136:139], v[228:231], v[192:195], v[136:139]
    ds_read_b64_tr_b16 v[240:241], v250 offset:32
    ds_read_b64_tr_b16 v[242:243], v250 offset:2336
    v_mfma_f32_16x16x32_bf16 v[140:143], v[228:231], v[196:199], v[140:143]
    s_waitcnt lgkmcnt(4)
    v_mfma_f32_16x16x32_bf16 v[144:147], v[232:235], v[192:195], v[144:147]
    ds_read_b64_tr_b16 v[244:245], v250 offset:64
    ds_read_b64_tr_b16 v[246:247], v250 offset:2368
    v_mfma_f32_16x16x32_bf16 v[148:151], v[232:235], v[196:199], v[148:151]
    s_waitcnt lgkmcnt(4)
    v_mfma_f32_16x16x32_bf16 v[80:83], v[236:239], v[200:203], v[80:83]
    ds_read_b64_tr_b16 v[224:225], v250 offset:96
    ds_read_b64_tr_b16 v[226:227], v250 offset:2400
    v_mfma_f32_16x16x32_bf16 v[84:87], v[236:239], v[204:207], v[84:87]
    s_waitcnt lgkmcnt(4)
    v_mfma_f32_16x16x32_bf16 v[88:91], v[240:243], v[200:203], v[88:91]
    ds_read_b64_tr_b16 v[228:229], v250 offset:128
    ds_read_b64_tr_b16 v[230:231], v250 offset:2432
    v_mfma_f32_16x16x32_bf16 v[92:95], v[240:243], v[204:207], v[92:95]
    s_waitcnt lgkmcnt(4)
    v_mfma_f32_16x16x32_bf16 v[96:99], v[244:247], v[200:203], v[96:99]
    ds_read_b64_tr_b16 v[232:233], v250 offset:160
    ds_read_b64_tr_b16 v[234:235], v250 offset:2464
    v_mfma_f32_16x16x32_bf16 v[100:103], v[244:247], v[204:207], v[100:103]
    s_waitcnt lgkmcnt(4)
    v_mfma_f32_16x16x32_bf16 v[104:107], v[224:227], v[200:203], v[104:107]
    ds_read_b64_tr_b16 v[236:237], v250 offset:192
    ds_read_b64_tr_b16 v[238:239], v250 offset:2496
    v_mfma_f32_16x16x32_bf16 v[108:111], v[224:227], v[204:207], v[108:111]
    s_waitcnt lgkmcnt(4)
    v_mfma_f32_16x16x32_bf16 v[112:115], v[228:231], v[200:203], v[112:115]
    ds_read_b64_tr_b16 v[240:241], v250 offset:224
    ds_read_b64_tr_b16 v[242:243], v250 offset:2528
    v_mfma_f32_16x16x32_bf16 v[116:119], v[228:231], v[204:207], v[116:119]
    s_waitcnt lgkmcnt(4)
    v_mfma_f32_16x16x32_bf16 v[120:123], v[232:235], v[200:203], v[120:123]
    ds_read_b64_tr_b16 v[244:245], v250 offset:256
    ds_read_b64_tr_b16 v[246:247], v250 offset:2560
    v_mfma_f32_16x16x32_bf16 v[124:127], v[232:235], v[204:207], v[124:127]
    s_waitcnt lgkmcnt(4)
    v_mfma_f32_16x16x32_bf16 v[128:131], v[236:239], v[200:203], v[128:131]
    v_add_u32 v250, 0, v248
    ds_read_b64_tr_b16 v[224:225], v250 offset:0
    ds_read_b64_tr_b16 v[226:227], v250 offset:2304
    v_mfma_f32_16x16x32_bf16 v[132:135], v[236:239], v[204:207], v[132:135]
    s_waitcnt lgkmcnt(4)
    v_mfma_f32_16x16x32_bf16 v[136:139], v[240:243], v[200:203], v[136:139]
    ds_read_b64_tr_b16 v[228:229], v250 offset:32
    ds_read_b64_tr_b16 v[230:231], v250 offset:2336
    v_mfma_f32_16x16x32_bf16 v[140:143], v[240:243], v[204:207], v[140:143]
    s_waitcnt lgkmcnt(4)
    v_mfma_f32_16x16x32_bf16 v[144:147], v[244:247], v[200:203], v[144:147]
    ds_read_b64_tr_b16 v[232:233], v250 offset:64
    ds_read_b64_tr_b16 v[234:235], v250 offset:2368
    v_mfma_f32_16x16x32_bf16 v[148:151], v[244:247], v[204:207], v[148:151]
    s_waitcnt lgkmcnt(4)
    v_mfma_f32_16x16x32_bf16 v[80:83], v[224:227], v[208:211], v[80:83]
    ds_read_b64_tr_b16 v[236:237], v250 offset:96
    ds_read_b64_tr_b16 v[238:239], v250 offset:2400
    v_mfma_f32_16x16x32_bf16 v[84:87], v[224:227], v[212:215], v[84:87]
    s_waitcnt lgkmcnt(4)
    v_mfma_f32_16x16x32_bf16 v[88:91], v[228:231], v[208:211], v[88:91]
    ds_read_b64_tr_b16 v[240:241], v250 offset:128
    ds_read_b64_tr_b16 v[242:243], v250 offset:2432
    v_mfma_f32_16x16x32_bf16 v[92:95], v[228:231], v[212:215], v[92:95]
    s_waitcnt lgkmcnt(4)
    v_mfma_f32_16x16x32_bf16 v[96:99], v[232:235], v[208:211], v[96:99]
    ds_read_b64_tr_b16 v[244:245], v250 offset:160
    ds_read_b64_tr_b16 v[246:247], v250 offset:2464
    v_mfma_f32_16x16x32_bf16 v[100:103], v[232:235], v[212:215], v[100:103]
    s_waitcnt lgkmcnt(4)
    v_mfma_f32_16x16x32_bf16 v[104:107], v[236:239], v[208:211], v[104:107]
    ds_read_b64_tr_b16 v[224:225], v250 offset:192
    ds_read_b64_tr_b16 v[226:227], v250 offset:2496
    v_mfma_f32_16x16x32_bf16 v[108:111], v[236:239], v[212:215], v[108:111]
    s_waitcnt lgkmcnt(4)
    v_mfma_f32_16x16x32_bf16 v[112:115], v[240:243], v[208:211], v[112:115]
    ds_read_b64_tr_b16 v[228:229], v250 offset:224
    ds_read_b64_tr_b16 v[230:231], v250 offset:2528
    v_mfma_f32_16x16x32_bf16 v[116:119], v[240:243], v[212:215], v[116:119]
    s_waitcnt lgkmcnt(4)
    v_mfma_f32_16x16x32_bf16 v[120:123], v[244:247], v[208:211], v[120:123]
    ds_read_b64_tr_b16 v[232:233], v250 offset:256
    ds_read_b64_tr_b16 v[234:235], v250 offset:2560
    v_mfma_f32_16x16x32_bf16 v[124:127], v[244:247], v[212:215], v[124:127]
    s_waitcnt lgkmcnt(4)
    v_mfma_f32_16x16x32_bf16 v[128:131], v[224:227], v[208:211], v[128:131]
    v_add_u32 v250, 9216, v248
    ds_read_b64_tr_b16 v[236:237], v250 offset:0
    ds_read_b64_tr_b16 v[238:239], v250 offset:2304
    v_mfma_f32_16x16x32_bf16 v[132:135], v[224:227], v[212:215], v[132:135]
    s_waitcnt lgkmcnt(4)
    v_mfma_f32_16x16x32_bf16 v[136:139], v[228:231], v[208:211], v[136:139]
    ds_read_b64_tr_b16 v[240:241], v250 offset:32
    ds_read_b64_tr_b16 v[242:243], v250 offset:2336
    v_mfma_f32_16x16x32_bf16 v[140:143], v[228:231], v[212:215], v[140:143]
    s_waitcnt lgkmcnt(4)
    v_mfma_f32_16x16x32_bf16 v[144:147], v[232:235], v[208:211], v[144:147]
    ds_read_b64_tr_b16 v[244:245], v250 offset:64
    ds_read_b64_tr_b16 v[246:247], v250 offset:2368
    v_mfma_f32_16x16x32_bf16 v[148:151], v[232:235], v[212:215], v[148:151]
    s_waitcnt lgkmcnt(4)
    v_mfma_f32_16x16x32_bf16 v[80:83], v[236:239], v[216:219], v[80:83]
    ds_read_b64_tr_b16 v[224:225], v250 offset:96
    ds_read_b64_tr_b16 v[226:227], v250 offset:2400
    v_mfma_f32_16x16x32_bf16 v[84:87], v[236:239], v[220:223], v[84:87]
    s_waitcnt lgkmcnt(4)
    v_mfma_f32_16x16x32_bf16 v[88:91], v[240:243], v[216:219], v[88:91]
    ds_read_b64_tr_b16 v[228:229], v250 offset:128
    ds_read_b64_tr_b16 v[230:231], v250 offset:2432
    v_mfma_f32_16x16x32_bf16 v[92:95], v[240:243], v[220:223], v[92:95]
    s_waitcnt lgkmcnt(4)
    v_mfma_f32_16x16x32_bf16 v[96:99], v[244:247], v[216:219], v[96:99]
    ds_read_b64_tr_b16 v[232:233], v250 offset:160
    ds_read_b64_tr_b16 v[234:235], v250 offset:2464
    v_mfma_f32_16x16x32_bf16 v[100:103], v[244:247], v[220:223], v[100:103]
    s_waitcnt lgkmcnt(4)
    v_mfma_f32_16x16x32_bf16 v[104:107], v[224:227], v[216:219], v[104:107]
    ds_read_b64_tr_b16 v[236:237], v250 offset:192
    ds_read_b64_tr_b16 v[238:239], v250 offset:2496
    v_mfma_f32_16x16x32_bf16 v[108:111], v[224:227], v[220:223], v[108:111]
    s_waitcnt lgkmcnt(4)
    v_mfma_f32_16x16x32_bf16 v[112:115], v[228:231], v[216:219], v[112:115]
    ds_read_b64_tr_b16 v[240:241], v250 offset:224
    ds_read_b64_tr_b16 v[242:243], v250 offset:2528
    v_mfma_f32_16x16x32_bf16 v[116:119], v[228:231], v[220:223], v[116:119]
    s_waitcnt lgkmcnt(4)
    v_mfma_f32_16x16x32_bf16 v[120:123], v[232:235], v[216:219], v[120:123]
    ds_read_b64_tr_b16 v[244:245], v250 offset:256
    ds_read_b64_tr_b16 v[246:247], v250 offset:2560
    v_mfma_f32_16x16x32_bf16 v[124:127], v[232:235], v[220:223], v[124:127]
    s_waitcnt lgkmcnt(4)
    v_mfma_f32_16x16x32_bf16 v[128:131], v[236:239], v[216:219], v[128:131]
    v_mfma_f32_16x16x32_bf16 v[132:135], v[236:239], v[220:223], v[132:135]
    s_waitcnt lgkmcnt(2)
    v_mfma_f32_16x16x32_bf16 v[136:139], v[240:243], v[216:219], v[136:139]
    v_mfma_f32_16x16x32_bf16 v[140:143], v[240:243], v[220:223], v[140:143]
    s_waitcnt lgkmcnt(0)
    v_mfma_f32_16x16x32_bf16 v[144:147], v[244:247], v[216:219], v[144:147]
    v_mfma_f32_16x16x32_bf16 v[148:151], v[244:247], v[220:223], v[148:151]
    s_branch recurrent_scan__ssm_conv_h3__mixer_gmlp__prompt_kernel_b516
recurrent_scan__ssm_conv_h3__mixer_gmlp__prompt_kernel_dz6:
    s_add_u32 s20, s42, 16777216
    s_addc_u32 s21, s43, 0
    s_mov_b32 s22, 9437184
    s_mov_b32 s23, 0x20000
    s_waitcnt vmcnt(0)
recurrent_scan__ssm_conv_h3__mixer_gmlp__prompt_kernel_poll17:
    v_readfirstlane_b32 s34, v233
    s_cmp_ge_u32 s34, 16
    s_cbranch_scc1 recurrent_scan__ssm_conv_h3__mixer_gmlp__prompt_kernel_pollok18
    buffer_load_dword v233, v234, s[48:51], 0 offen sc1
    s_waitcnt vmcnt(0)
    s_branch recurrent_scan__ssm_conv_h3__mixer_gmlp__prompt_kernel_poll17
recurrent_scan__ssm_conv_h3__mixer_gmlp__prompt_kernel_pollok18:
    s_lshl_b32 s34, s39, 14
    s_lshl_b32 s37, s30, 8
    s_add_u32 s34, s34, s37
    v_lshlrev_b32 v233, 10, v6
    v_lshl_add_u32 v233, v5, 4, v233
    v_add_u32 v233, s34, v233
    s_mov_b32 s37, 0
    buffer_load_dwordx4 v[168:171], v233, s[48:51], s37 offen sc1
    s_mov_b32 s37, 4096
    buffer_load_dwordx4 v[172:175], v233, s[48:51], s37 offen sc1
    s_mov_b32 s37, 8192
    buffer_load_dwordx4 v[176:179], v233, s[48:51], s37 offen sc1
    s_mov_b32 s37, 12288
    buffer_load_dwordx4 v[180:183], v233, s[48:51], s37 offen sc1
    s_load_dwordx4 s[4:7], s[0:1], 64
    s_lshl_b32 s34, s28, 4
    s_add_u32 s34, s34, s31
    v_lshrrev_b32 v2, 3, v1
    v_and_b32 v3, 3, v2
    v_xor_b32 v3, v3, v1
    v_and_b32 v3, 7, v3
    v_add_u32 v2, s34, v2
    v_lshlrev_b32 v2, 12, v2
    v_lshl_add_u32 v4, v3, 4, v2
    v_add_u32 v4, 4096, v4
    v_xor_b32 v3, 4, v3
    v_lshl_add_u32 v2, v3, 4, v2
    v_add_u32 v2, 35840, v2
    s_lshl_b32 s37, s28, 11
    s_add_u32 s37, s37, 82944
    s_waitcnt lgkmcnt(0)
    s_sub_u32 s16, s4, 4096
    s_subb_u32 s17, s5, 0
    s_mov_b32 s18, 8392704
    s_mov_b32 s19, 0x20000
    s_add_u32 m0, s37, 0
    s_lshl_b32 s34, s39, 8
    s_add_u32 s34, s34, 0
    s_and_b32 s34, s34, 0xfff
    buffer_load_dwordx4 v4, s[16:19], s34 offen lds
    buffer_load_dwordx4 v2, s[16:19], s34 offen offset:1024 lds
    s_add_u32 m0, s37, 16384
    s_lshl_b32 s34, s39, 8
    s_add_u32 s34, s34, 128
    s_and_b32 s34, s34, 0xfff
    buffer_load_dwordx4 v4, s[16:19], s34 offen lds
    buffer_load_dwordx4 v2, s[16:19], s34 offen offset:1024 lds
    s_add_u32 m0, s37, 32768
    s_lshl_b32 s34, s39, 8
    s_add_u32 s34, s34, 256
    s_and_b32 s34, s34, 0xfff
    buffer_load_dwordx4 v4, s[16:19], s34 offen lds
    buffer_load_dwordx4 v2, s[16:19], s34 offen offset:1024 lds
    s_add_u32 m0, s37, 49152
    s_lshl_b32 s34, s39, 8
    s_add_u32 s34, s34, 384
    s_and_b32 s34, s34, 0xfff
    buffer_load_dwordx4 v4, s[16:19], s34 offen lds
    buffer_load_dwordx4 v2, s[16:19], s34 offen offset:1024 lds
    s_waitcnt vmcnt(10)
    v_pk_add_f32 v[168:169], v[168:169], v[172:173]
    v_pk_add_f32 v[170:171], v[170:171], v[174:175]
    s_waitcnt vmcnt(9)
    v_pk_add_f32 v[168:169], v[168:169], v[176:177]
    v_pk_add_f32 v[170:171], v[170:171], v[178:179]
    s_waitcnt vmcnt(8)
    v_pk_add_f32 v[168:169], v[168:169], v[180:181]
    v_pk_add_f32 v[170:171], v[170:171], v[182:183]
    v_mov_b32 v172, v168
    v_mov_b32 v173, v169
    v_mov_b32 v174, v170
    v_mov_b32 v175, v171
    v_permlane32_swap_b32 v168, v172
    v_permlane32_swap_b32 v169, v173
    v_permlane32_swap_b32 v170, v174
    v_permlane32_swap_b32 v171, v175
    v_add_f32 v168, v168, v172
    v_add_f32 v169, v169, v173
    v_add_f32 v170, v170, v174
    v_add_f32 v171, v171, v175
    v_mov_b32 v172, v168
    v_mov_b32 v173, v169
    v_mov_b32 v174, v170
    v_mov_b32 v175, v171
    v_permlane16_swap_b32 v168, v172
    v_permlane16_swap_b32 v169, v173
    v_permlane16_swap_b32 v170, v174
    v_permlane16_swap_b32 v171, v175
    v_add_f32 v168, v168, v172
    v_add_f32 v169, v169, v173
    v_add_f32 v170, v170, v174
    v_add_f32 v171, v171, v175
    v_mul_f32 v168, 0x39e38e39, v168
    v_mul_f32 v169, 0x39e38e39, v169
    v_fma_f32 v169, -v168, v168, v169
    v_max_f32 v169, 0, v169
    v_cvt_pk_bf16_f32 v233, v168, v169
    v_lshlrev_b32 v168, 16, v233
    v_and_b32 v169, 0xffff0000, v233
    v_add_f32 v169, 0x3727c5ac, v169
    v_cvt_pk_bf16_f32 v233, v169, v169
    v_lshlrev_b32 v169, 16, v233
    v_sqrt_f32 v169, v169
    s_nop 0
    v_cvt_pk_bf16_f32 v233, v169, v169
    v_lshlrev_b32 v169, 16, v233
    v_rcp_f32 v169, v169
    v_mul_f32 v170, 0x39e38e39, v170
    v_mul_f32 v171, 0x39e38e39, v171
    v_fma_f32 v171, -v170, v170, v171
    v_max_f32 v171, 0, v171
    v_cvt_pk_bf16_f32 v233, v170, v171
    v_lshlrev_b32 v170, 16, v233
    v_and_b32 v171, 0xffff0000, v233
    v_add_f32 v171, 0x3727c5ac, v171
    v_cvt_pk_bf16_f32 v233, v171, v171
    v_lshlrev_b32 v171, 16, v233
    v_sqrt_f32 v171, v171
    s_nop 0
    v_cvt_pk_bf16_f32 v233, v171, v171
    v_lshlrev_b32 v171, 16, v233
    v_rcp_f32 v171, v171
    s_lshl_b32 s34, s28, 8
    v_lshlrev_b32 v233, 4, v5
    v_add_u32 v233, s34, v233
    ds_write_b128 v233, v[168:171] offset:4608
    v_lshlrev_b32 v234, 6, v6
    v_add_u32 v234, s34, v234
    s_waitcnt lgkmcnt(0)
    ds_read_b128 v[184:187], v234 offset:4608
    ds_read_b128 v[188:191], v234 offset:4624
    ds_read_b128 v[192:195], v234 offset:4640
    ds_read_b128 v[196:199], v234 offset:4656
    s_lshl_b32 s34, s32, 6
    s_lshl_b32 s37, s39, 2
    s_add_u32 s34, s34, s37
    s_add_u32 s34, s34, s30
    s_mul_i32 s34, s34, 9216
    v_add_u32 v231, s34, v7
    s_waitcnt lgkmcnt(0)
    v_mul_f32 v200, v160, v185
    v_mul_f32 v208, -v184, v185
    v_mul_f32 v201, v161, v187
    v_mul_f32 v209, -v186, v187
    v_mul_f32 v202, v162, v189
    v_mul_f32 v210, -v188, v189
    v_mul_f32 v203, v163, v191
    v_mul_f32 v211, -v190, v191
    v_mul_f32 v204, v164, v193
    v_mul_f32 v212, -v192, v193
    v_mul_f32 v205, v165, v195
    v_mul_f32 v213, -v194, v195
    v_mul_f32 v206, v166, v197
    v_mul_f32 v214, -v196, v197
    v_mul_f32 v207, v167, v199
    v_mul_f32 v215, -v198, v199
    s_add_u32 s34, s30, 4
    s_mul_i32 s34, s34, 9216
    v_add_u32 v232, s34, v7
    v_pk_fma_f32 v[8:9], v[8:9], v[200:201], v[208:209]
    v_pk_fma_f32 v[10:11], v[10:11], v[202:203], v[210:211]
    v_pk_fma_f32 v[12:13], v[12:13], v[204:205], v[212:213]
    v_pk_fma_f32 v[14:15], v[14:15], v[206:207], v[214:215]
    v_cvt_pk_bf16_f32 v8, v8, v9
    v_cvt_pk_bf16_f32 v9, v10, v11
    v_cvt_pk_bf16_f32 v10, v12, v13
    v_cvt_pk_bf16_f32 v11, v14, v15
    s_movk_i32 s38, 0
    buffer_store_dwordx4 v[8:11], v231, s[20:23], s38 offen sc1
    ds_write_b128 v232, v[8:11] offset:0
    v_pk_fma_f32 v[16:17], v[16:17], v[200:201], v[208:209]
    v_pk_fma_f32 v[18:19], v[18:19], v[202:203], v[210:211]
    v_pk_fma_f32 v[20:21], v[20:21], v[204:205], v[212:213]
    v_pk_fma_f32 v[22:23], v[22:23], v[206:207], v[214:215]
    v_cvt_pk_bf16_f32 v16, v16, v17
    v_cvt_pk_bf16_f32 v17, v18, v19
    v_cvt_pk_bf16_f32 v18, v20, v21
    v_cvt_pk_bf16_f32 v19, v22, v23
    s_movk_i32 s38, 1024
    buffer_store_dwordx4 v[16:19], v231, s[20:23], s38 offen sc1
    ds_write_b128 v232, v[16:19] offset:1024
    v_pk_fma_f32 v[24:25], v[24:25], v[200:201], v[208:209]
    v_pk_fma_f32 v[26:27], v[26:27], v[202:203], v[210:211]
    v_pk_fma_f32 v[28:29], v[28:29], v[204:205], v[212:213]
    v_pk_fma_f32 v[30:31], v[30:31], v[206:207], v[214:215]
    v_cvt_pk_bf16_f32 v24, v24, v25
    v_cvt_pk_bf16_f32 v25, v26, v27
    v_cvt_pk_bf16_f32 v26, v28, v29
    v_cvt_pk_bf16_f32 v27, v30, v31
    s_movk_i32 s38, 2048
    buffer_store_dwordx4 v[24:27], v231, s[20:23], s38 offen sc1
    ds_write_b128 v232, v[24:27] offset:2048
    v_pk_fma_f32 v[32:33], v[32:33], v[200:201], v[208:209]
    v_pk_fma_f32 v[34:35], v[34:35], v[202:203], v[210:211]
    v_pk_fma_f32 v[36:37], v[36:37], v[204:205], v[212:213]
    v_pk_fma_f32 v[38:39], v[38:39], v[206:207], v[214:215]
    v_cvt_pk_bf16_f32 v32, v32, v33
    v_cvt_pk_bf16_f32 v33, v34, v35
    v_cvt_pk_bf16_f32 v34, v36, v37
    v_cvt_pk_bf16_f32 v35, v38, v39
    s_movk_i32 s38, 3072
    buffer_store_dwordx4 v[32:35], v231, s[20:23], s38 offen sc1
    ds_write_b128 v232, v[32:35] offset:3072
    v_pk_fma_f32 v[40:41], v[40:41], v[200:201], v[208:209]
    v_pk_fma_f32 v[42:43], v[42:43], v[202:203], v[210:211]
    v_pk_fma_f32 v[44:45], v[44:45], v[204:205], v[212:213]
    v_pk_fma_f32 v[46:47], v[46:47], v[206:207], v[214:215]
    v_cvt_pk_bf16_f32 v40, v40, v41
    v_cvt_pk_bf16_f32 v41, v42, v43
    v_cvt_pk_bf16_f32 v42, v44, v45
    v_cvt_pk_bf16_f32 v43, v46, v47
    s_movk_i32 s38, 4096
    buffer_store_dwordx4 v[40:43], v231, s[20:23], s38 offen sc1
    ds_write_b128 v232, v[40:43] offset:4096
    v_pk_fma_f32 v[48:49], v[48:49], v[200:201], v[208:209]
    v_pk_fma_f32 v[50:51], v[50:51], v[202:203], v[210:211]
    v_pk_fma_f32 v[52:53], v[52:53], v[204:205], v[212:213]
    v_pk_fma_f32 v[54:55], v[54:55], v[206:207], v[214:215]
    v_cvt_pk_bf16_f32 v48, v48, v49
    v_cvt_pk_bf16_f32 v49, v50, v51
    v_cvt_pk_bf16_f32 v50, v52, v53
    v_cvt_pk_bf16_f32 v51, v54, v55
    s_movk_i32 s38, 5120
    buffer_store_dwordx4 v[48:51], v231, s[20:23], s38 offen sc1
    ds_write_b128 v232, v[48:51] offset:5120
    v_pk_fma_f32 v[56:57], v[56:57], v[200:201], v[208:209]
    v_pk_fma_f32 v[58:59], v[58:59], v[202:203], v[210:211]
    v_pk_fma_f32 v[60:61], v[60:61], v[204:205], v[212:213]
    v_pk_fma_f32 v[62:63], v[62:63], v[206:207], v[214:215]
    v_cvt_pk_bf16_f32 v56, v56, v57
    v_cvt_pk_bf16_f32 v57, v58, v59
    v_cvt_pk_bf16_f32 v58, v60, v61
    v_cvt_pk_bf16_f32 v59, v62, v63
    s_movk_i32 s38, 6144
    buffer_store_dwordx4 v[56:59], v231, s[20:23], s38 offen sc1
    ds_write_b128 v232, v[56:59] offset:6144
    v_pk_fma_f32 v[64:65], v[64:65], v[200:201], v[208:209]
    v_pk_fma_f32 v[66:67], v[66:67], v[202:203], v[210:211]
    v_pk_fma_f32 v[68:69], v[68:69], v[204:205], v[212:213]
    v_pk_fma_f32 v[70:71], v[70:71], v[206:207], v[214:215]
    v_cvt_pk_bf16_f32 v64, v64, v65
    v_cvt_pk_bf16_f32 v65, v66, v67
    v_cvt_pk_bf16_f32 v66, v68, v69
    v_cvt_pk_bf16_f32 v67, v70, v71
    s_movk_i32 s38, 7168
    buffer_store_dwordx4 v[64:67], v231, s[20:23], s38 offen sc1
    ds_write_b128 v232, v[64:67] offset:7168
    v_pk_fma_f32 v[72:73], v[72:73], v[200:201], v[208:209]
    v_pk_fma_f32 v[74:75], v[74:75], v[202:203], v[210:211]
    v_pk_fma_f32 v[76:77], v[76:77], v[204:205], v[212:213]
    v_pk_fma_f32 v[78:79], v[78:79], v[206:207], v[214:215]
    v_cvt_pk_bf16_f32 v72, v72, v73
    v_cvt_pk_bf16_f32 v73, v74, v75
    v_cvt_pk_bf16_f32 v74, v76, v77
    v_cvt_pk_bf16_f32 v75, v78, v79
    s_movk_i32 s38, 8192
    buffer_store_dwordx4 v[72:75], v231, s[20:23], s38 offen sc1
    ds_write_b128 v232, v[72:75] offset:8192
    s_lshl_b32 s59, s32, 8
    s_add_u32 s59, s59, 1867776
    s_lshl_b32 s60, s39, 2
    s_add_u32 s60, s60, s59
    s_and_b32 s61, s2, 7
    s_lshl_b32 s61, s61, 8
    s_add_u32 s61, s61, 1875968
    s_waitcnt vmcnt(0)
    v_mov_b32 v2, 160768
    v_mov_b32 v3, 1
    s_mov_b64 exec, 1
    ds_add_rtn_u32 v2, v2, v3
    s_waitcnt lgkmcnt(0)
    v_readfirstlane_b32 s34, v2
    s_cmp_eq_u32 s34, 7
    s_cselect_b32 s34, 0, 2146435072
    s_mov_b64 exec, 3
    v_mov_b32 v3, 1
    v_mov_b32 v2, s60
    v_writelane_b32 v2, s61, 1
    buffer_atomic_add v3, v2, s[48:51], s34 offen sc1
    s_mov_b64 exec, -1
    s_branch recurrent_scan__ssm_conv_h3__mixer_gmlp__prompt_kernel_bend19
recurrent_scan__ssm_conv_h3__mixer_gmlp__prompt_kernel_b516:
    s_add_u32 s48, s42, 67108864
    s_addc_u32 s49, s43, 0
    s_mov_b32 s50, 2097152
    s_mov_b32 s51, 0x20000
    s_waitcnt vmcnt(0)
    v_and_b32 v3, 7, v1
    v_lshlrev_b32 v3, 6, v3
    ds_read_b128 v[200:203], v3 offset:2304
    ds_read_b128 v[204:207], v3 offset:2320
    ds_read_b128 v[208:211], v3 offset:2336
    ds_read_b128 v[212:215], v3 offset:2352
    s_waitcnt lgkmcnt(0)
    v_and_b32 v152, 0xffff, v200
    v_lshlrev_b32 v153, 16, v202
    v_and_b32 v154, 0xffff, v204
    v_lshlrev_b32 v155, 16, v206
    v_and_b32 v156, 0xffff, v208
    v_lshlrev_b32 v157, 16, v210
    v_and_b32 v158, 0xffff, v212
    v_lshlrev_b32 v159, 16, v214
    v_lshrrev_b32 v160, 16, v200
    v_and_b32 v161, 0xffff0000, v202
    v_lshrrev_b32 v162, 16, v204
    v_and_b32 v163, 0xffff0000, v206
    v_lshrrev_b32 v164, 16, v208
    v_and_b32 v165, 0xffff0000, v210
    v_lshrrev_b32 v166, 16, v212
    v_and_b32 v167, 0xffff0000, v214
    v_and_b32 v168, 0xffff, v201
    v_lshlrev_b32 v169, 16, v203
    v_and_b32 v170, 0xffff, v205
    v_lshlrev_b32 v171, 16, v207
    v_and_b32 v172, 0xffff, v209
    v_lshlrev_b32 v173, 16, v211
    v_and_b32 v174, 0xffff, v213
    v_lshlrev_b32 v175, 16, v215
    v_lshrrev_b32 v176, 16, v201
    v_and_b32 v177, 0xffff0000, v203
    v_lshrrev_b32 v178, 16, v205
    v_and_b32 v179, 0xffff0000, v207
    v_lshrrev_b32 v180, 16, v209
    v_and_b32 v181, 0xffff0000, v211
    v_lshrrev_b32 v182, 16, v213
    v_and_b32 v183, 0xffff0000, v215
    v_dot2_f32_bf16 v184, v20, v176, 0
    v_dot2_f32_bf16 v185, v20, v177, 0
    v_dot2_f32_bf16 v186, v21, v178, 0
    v_dot2_f32_bf16 v187, v21, v179, 0
    v_dot2_f32_bf16 v188, v22, v180, 0
    v_dot2_f32_bf16 v189, v22, v181, 0
    v_dot2_f32_bf16 v190, v23, v182, 0
    v_dot2_f32_bf16 v191, v23, v183, 0
    v_dot2_f32_bf16 v192, v16, v168, 0
    v_dot2_f32_bf16 v193, v16, v169, 0
    v_dot2_f32_bf16 v194, v17, v170, 0
    v_dot2_f32_bf16 v195, v17, v171, 0
    v_dot2_f32_bf16 v196, v18, v172, 0
    v_dot2_f32_bf16 v197, v18, v173, 0
    v_dot2_f32_bf16 v198, v19, v174, 0
    v_dot2_f32_bf16 v199, v19, v175, 0
    v_cvt_pk_bf16_f32 v192, v192, v184
    v_cvt_pk_bf16_f32 v193, v193, v185
    v_cvt_pk_bf16_f32 v194, v194, v186
    v_cvt_pk_bf16_f32 v195, v195, v187
    v_cvt_pk_bf16_f32 v196, v196, v188
    v_cvt_pk_bf16_f32 v197, v197, v189
    v_cvt_pk_bf16_f32 v198, v198, v190
    v_cvt_pk_bf16_f32 v199, v199, v191
    v_dot2_f32_bf16 v184, v192, s53, 0
    v_dot2_f32_bf16 v185, v193, s53, 0
    v_dot2_f32_bf16 v186, v194, s53, 0
    v_dot2_f32_bf16 v187, v195, s53, 0
    v_dot2_f32_bf16 v188, v196, s53, 0
    v_dot2_f32_bf16 v189, v197, s53, 0
    v_dot2_f32_bf16 v190, v198, s53, 0
    v_dot2_f32_bf16 v191, v199, s53, 0
    v_dot2_f32_bf16 v192, v12, v160, 0
    v_dot2_f32_bf16 v193, v12, v161, 0
    v_dot2_f32_bf16 v194, v13, v162, 0
    v_dot2_f32_bf16 v195, v13, v163, 0
    v_dot2_f32_bf16 v196, v14, v164, 0
    v_dot2_f32_bf16 v197, v14, v165, 0
    v_dot2_f32_bf16 v198, v15, v166, 0
    v_dot2_f32_bf16 v199, v15, v167, 0
    v_cvt_pk_bf16_f32 v192, v192, v184
    v_cvt_pk_bf16_f32 v193, v193, v185
    v_cvt_pk_bf16_f32 v194, v194, v186
    v_cvt_pk_bf16_f32 v195, v195, v187
    v_cvt_pk_bf16_f32 v196, v196, v188
    v_cvt_pk_bf16_f32 v197, v197, v189
    v_cvt_pk_bf16_f32 v198, v198, v190
    v_cvt_pk_bf16_f32 v199, v199, v191
    v_dot2_f32_bf16 v184, v192, s53, 0
    v_dot2_f32_bf16 v185, v193, s53, 0
    v_dot2_f32_bf16 v186, v194, s53, 0
    v_dot2_f32_bf16 v187, v195, s53, 0
    v_dot2_f32_bf16 v188, v196, s53, 0
    v_dot2_f32_bf16 v189, v197, s53, 0
    v_dot2_f32_bf16 v190, v198, s53, 0
    v_dot2_f32_bf16 v191, v199, s53, 0
    v_dot2_f32_bf16 v192, v8, v152, 0
    v_dot2_f32_bf16 v193, v8, v153, 0
    v_dot2_f32_bf16 v194, v9, v154, 0
    v_dot2_f32_bf16 v195, v9, v155, 0
    v_dot2_f32_bf16 v196, v10, v156, 0
    v_dot2_f32_bf16 v197, v10, v157, 0
    v_dot2_f32_bf16 v198, v11, v158, 0
    v_dot2_f32_bf16 v199, v11, v159, 0
    v_cvt_pk_bf16_f32 v192, v192, v184
    v_cvt_pk_bf16_f32 v193, v193, v185
    v_cvt_pk_bf16_f32 v194, v194, v186
    v_cvt_pk_bf16_f32 v195, v195, v187
    v_cvt_pk_bf16_f32 v196, v196, v188
    v_cvt_pk_bf16_f32 v197, v197, v189
    v_cvt_pk_bf16_f32 v198, v198, v190
    v_cvt_pk_bf16_f32 v199, v199, v191
    v_dot2_f32_bf16 v184, v192, s53, 0
    v_dot2_f32_bf16 v185, v193, s53, 0
    v_dot2_f32_bf16 v186, v194, s53, 0
    v_dot2_f32_bf16 v187, v195, s53, 0
    v_dot2_f32_bf16 v188, v196, s53, 0
    v_dot2_f32_bf16 v189, v197, s53, 0
    v_dot2_f32_bf16 v190, v198, s53, 0
    v_dot2_f32_bf16 v191, v199, s53, 0
    v_and_b32 v192, 0xffff, v24
    v_and_b32 v193, 0xffff0000, v24
    v_and_b32 v194, 0xffff, v25
    v_and_b32 v195, 0xffff0000, v25
    v_and_b32 v196, 0xffff, v26
    v_and_b32 v197, 0xffff0000, v26
    v_and_b32 v198, 0xffff, v27
    v_and_b32 v199, 0xffff0000, v27
    v_cvt_pk_bf16_f32 v216, v184, v185
    v_cvt_pk_bf16_f32 v217, v186, v187
    v_cvt_pk_bf16_f32 v218, v188, v189
    v_cvt_pk_bf16_f32 v219, v190, v191
    v_dot2_f32_bf16 v184, v216, v192, 0
    v_dot2_f32_bf16 v185, v216, v193, 0
    v_dot2_f32_bf16 v186, v217, v194, 0
    v_dot2_f32_bf16 v187, v217, v195, 0
    v_dot2_f32_bf16 v188, v218, v196, 0
    v_dot2_f32_bf16 v189, v218, v197, 0
    v_dot2_f32_bf16 v190, v219, v198, 0
    v_dot2_f32_bf16 v191, v219, v199, 0
    s_lshl_b32 s62, s30, 4
    s_sub_u32 s62, 63, s62
    v_lshrrev_b32 v2, 3, v1
    v_and_b32 v3, 7, v1
    v_lshlrev_b32 v3, 4, v3
    v_sub_u32 v2, s62, v2
    v_mul_u32_u24 v2, 144, v2
    v_add_u32 v3, v2, v3
    v_add_u32 v3, 23040, v3
    v_cvt_pk_bf16_f32 v8, v184, v185
    v_cvt_pk_bf16_f32 v9, v186, v187
    v_cvt_pk_bf16_f32 v10, v188, v189
    v_cvt_pk_bf16_f32 v11, v190, v191
    ds_write_b128 v3, v[8:11]
    v_dot2_f32_bf16 v184, v40, v176, 0
    v_dot2_f32_bf16 v185, v40, v177, 0
    v_dot2_f32_bf16 v186, v41, v178, 0
    v_dot2_f32_bf16 v187, v41, v179, 0
    v_dot2_f32_bf16 v188, v42, v180, 0
    v_dot2_f32_bf16 v189, v42, v181, 0
    v_dot2_f32_bf16 v190, v43, v182, 0
    v_dot2_f32_bf16 v191, v43, v183, 0
    v_dot2_f32_bf16 v192, v36, v168, 0
    v_dot2_f32_bf16 v193, v36, v169, 0
    v_dot2_f32_bf16 v194, v37, v170, 0
    v_dot2_f32_bf16 v195, v37, v171, 0
    v_dot2_f32_bf16 v196, v38, v172, 0
    v_dot2_f32_bf16 v197, v38, v173, 0
    v_dot2_f32_bf16 v198, v39, v174, 0
    v_dot2_f32_bf16 v199, v39, v175, 0
    v_cvt_pk_bf16_f32 v192, v192, v184
    v_cvt_pk_bf16_f32 v193, v193, v185
    v_cvt_pk_bf16_f32 v194, v194, v186
    v_cvt_pk_bf16_f32 v195, v195, v187
    v_cvt_pk_bf16_f32 v196, v196, v188
    v_cvt_pk_bf16_f32 v197, v197, v189
    v_cvt_pk_bf16_f32 v198, v198, v190
    v_cvt_pk_bf16_f32 v199, v199, v191
    v_dot2_f32_bf16 v184, v192, s53, 0
    v_dot2_f32_bf16 v185, v193, s53, 0
    v_dot2_f32_bf16 v186, v194, s53, 0
    v_dot2_f32_bf16 v187, v195, s53, 0
    v_dot2_f32_bf16 v188, v196, s53, 0
    v_dot2_f32_bf16 v189, v197, s53, 0
    v_dot2_f32_bf16 v190, v198, s53, 0
    v_dot2_f32_bf16 v191, v199, s53, 0
    v_dot2_f32_bf16 v192, v32, v160, 0
    v_dot2_f32_bf16 v193, v32, v161, 0
    v_dot2_f32_bf16 v194, v33, v162, 0
    v_dot2_f32_bf16 v195, v33, v163, 0
    v_dot2_f32_bf16 v196, v34, v164, 0
    v_dot2_f32_bf16 v197, v34, v165, 0
    v_dot2_f32_bf16 v198, v35, v166, 0
    v_dot2_f32_bf16 v199, v35, v167, 0
    v_cvt_pk_bf16_f32 v192, v192, v184
    v_cvt_pk_bf16_f32 v193, v193, v185
    v_cvt_pk_bf16_f32 v194, v194, v186
    v_cvt_pk_bf16_f32 v195, v195, v187
    v_cvt_pk_bf16_f32 v196, v196, v188
    v_cvt_pk_bf16_f32 v197, v197, v189
    v_cvt_pk_bf16_f32 v198, v198, v190
    v_cvt_pk_bf16_f32 v199, v199, v191
    v_dot2_f32_bf16 v184, v192, s53, 0
    v_dot2_f32_bf16 v185, v193, s53, 0
    v_dot2_f32_bf16 v186, v194, s53, 0
    v_dot2_f32_bf16 v187, v195, s53, 0
    v_dot2_f32_bf16 v188, v196, s53, 0
    v_dot2_f32_bf16 v189, v197, s53, 0
    v_dot2_f32_bf16 v190, v198, s53, 0
    v_dot2_f32_bf16 v191, v199, s53, 0
    v_dot2_f32_bf16 v192, v28, v152, 0
    v_dot2_f32_bf16 v193, v28, v153, 0
    v_dot2_f32_bf16 v194, v29, v154, 0
    v_dot2_f32_bf16 v195, v29, v155, 0
    v_dot2_f32_bf16 v196, v30, v156, 0
    v_dot2_f32_bf16 v197, v30, v157, 0
    v_dot2_f32_bf16 v198, v31, v158, 0
    v_dot2_f32_bf16 v199, v31, v159, 0
    v_cvt_pk_bf16_f32 v192, v192, v184
    v_cvt_pk_bf16_f32 v193, v193, v185
    v_cvt_pk_bf16_f32 v194, v194, v186
    v_cvt_pk_bf16_f32 v195, v195, v187
    v_cvt_pk_bf16_f32 v196, v196, v188
    v_cvt_pk_bf16_f32 v197, v197, v189
    v_cvt_pk_bf16_f32 v198, v198, v190
    v_cvt_pk_bf16_f32 v199, v199, v191
    v_dot2_f32_bf16 v184, v192, s53, 0
    v_dot2_f32_bf16 v185, v193, s53, 0
    v_dot2_f32_bf16 v186, v194, s53, 0
    v_dot2_f32_bf16 v187, v195, s53, 0
    v_dot2_f32_bf16 v188, v196, s53, 0
    v_dot2_f32_bf16 v189, v197, s53, 0
    v_dot2_f32_bf16 v190, v198, s53, 0
    v_dot2_f32_bf16 v191, v199, s53, 0
    v_and_b32 v192, 0xffff, v44
    v_and_b32 v193, 0xffff0000, v44
    v_and_b32 v194, 0xffff, v45
    v_and_b32 v195, 0xffff0000, v45
    v_and_b32 v196, 0xffff, v46
    v_and_b32 v197, 0xffff0000, v46
    v_and_b32 v198, 0xffff, v47
    v_and_b32 v199, 0xffff0000, v47
    v_cvt_pk_bf16_f32 v216, v184, v185
    v_cvt_pk_bf16_f32 v217, v186, v187
    v_cvt_pk_bf16_f32 v218, v188, v189
    v_cvt_pk_bf16_f32 v219, v190, v191
    v_dot2_f32_bf16 v184, v216, v192, 0
    v_dot2_f32_bf16 v185, v216, v193, 0
    v_dot2_f32_bf16 v186, v217, v194, 0
    v_dot2_f32_bf16 v187, v217, v195, 0
    v_dot2_f32_bf16 v188, v218, v196, 0
    v_dot2_f32_bf16 v189, v218, v197, 0
    v_dot2_f32_bf16 v190, v219, v198, 0
    v_dot2_f32_bf16 v191, v219, v199, 0
    s_lshl_b32 s62, s30, 4
    s_sub_u32 s62, 55, s62
    v_lshrrev_b32 v2, 3, v1
    v_and_b32 v3, 7, v1
    v_lshlrev_b32 v3, 4, v3
    v_sub_u32 v2, s62, v2
    v_mul_u32_u24 v2, 144, v2
    v_add_u32 v3, v2, v3
    v_add_u32 v3, 23040, v3
    v_cvt_pk_bf16_f32 v28, v184, v185
    v_cvt_pk_bf16_f32 v29, v186, v187
    v_cvt_pk_bf16_f32 v30, v188, v189
    v_cvt_pk_bf16_f32 v31, v190, v191
    ds_write_b128 v3, v[28:31]
    v_mov_b32 v3, 512
    ds_read_b128 v[200:203], v3 offset:2304
    ds_read_b128 v[204:207], v3 offset:2320
    ds_read_b128 v[208:211], v3 offset:2336
    ds_read_b128 v[212:215], v3 offset:2352
    s_waitcnt lgkmcnt(0)
    v_and_b32 v152, 0xffff, v200
    v_lshlrev_b32 v153, 16, v202
    v_and_b32 v154, 0xffff, v204
    v_lshlrev_b32 v155, 16, v206
    v_and_b32 v156, 0xffff, v208
    v_lshlrev_b32 v157, 16, v210
    v_and_b32 v158, 0xffff, v212
    v_lshlrev_b32 v159, 16, v214
    v_lshrrev_b32 v160, 16, v200
    v_and_b32 v161, 0xffff0000, v202
    v_lshrrev_b32 v162, 16, v204
    v_and_b32 v163, 0xffff0000, v206
    v_lshrrev_b32 v164, 16, v208
    v_and_b32 v165, 0xffff0000, v210
    v_lshrrev_b32 v166, 16, v212
    v_and_b32 v167, 0xffff0000, v214
    v_and_b32 v168, 0xffff, v201
    v_lshlrev_b32 v169, 16, v203
    v_and_b32 v170, 0xffff, v205
    v_lshlrev_b32 v171, 16, v207
    v_and_b32 v172, 0xffff, v209
    v_lshlrev_b32 v173, 16, v211
    v_and_b32 v174, 0xffff, v213
    v_lshlrev_b32 v175, 16, v215
    v_lshrrev_b32 v176, 16, v201
    v_and_b32 v177, 0xffff0000, v203
    v_lshrrev_b32 v178, 16, v205
    v_and_b32 v179, 0xffff0000, v207
    v_lshrrev_b32 v180, 16, v209
    v_and_b32 v181, 0xffff0000, v211
    v_lshrrev_b32 v182, 16, v213
    v_and_b32 v183, 0xffff0000, v215
    v_dot2_f32_bf16 v184, v60, v176, 0
    v_dot2_f32_bf16 v185, v60, v177, 0
    v_dot2_f32_bf16 v186, v61, v178, 0
    v_dot2_f32_bf16 v187, v61, v179, 0
    v_dot2_f32_bf16 v188, v62, v180, 0
    v_dot2_f32_bf16 v189, v62, v181, 0
    v_dot2_f32_bf16 v190, v63, v182, 0
    v_dot2_f32_bf16 v191, v63, v183, 0
    v_dot2_f32_bf16 v192, v56, v168, 0
    v_dot2_f32_bf16 v193, v56, v169, 0
    v_dot2_f32_bf16 v194, v57, v170, 0
    v_dot2_f32_bf16 v195, v57, v171, 0
    v_dot2_f32_bf16 v196, v58, v172, 0
    v_dot2_f32_bf16 v197, v58, v173, 0
    v_dot2_f32_bf16 v198, v59, v174, 0
    v_dot2_f32_bf16 v199, v59, v175, 0
    v_cvt_pk_bf16_f32 v192, v192, v184
    v_cvt_pk_bf16_f32 v193, v193, v185
    v_cvt_pk_bf16_f32 v194, v194, v186
    v_cvt_pk_bf16_f32 v195, v195, v187
    v_cvt_pk_bf16_f32 v196, v196, v188
    v_cvt_pk_bf16_f32 v197, v197, v189
    v_cvt_pk_bf16_f32 v198, v198, v190
    v_cvt_pk_bf16_f32 v199, v199, v191
    v_dot2_f32_bf16 v184, v192, s53, 0
    v_dot2_f32_bf16 v185, v193, s53, 0
    v_dot2_f32_bf16 v186, v194, s53, 0
    v_dot2_f32_bf16 v187, v195, s53, 0
    v_dot2_f32_bf16 v188, v196, s53, 0
    v_dot2_f32_bf16 v189, v197, s53, 0
    v_dot2_f32_bf16 v190, v198, s53, 0
    v_dot2_f32_bf16 v191, v199, s53, 0
    v_dot2_f32_bf16 v192, v52, v160, 0
    v_dot2_f32_bf16 v193, v52, v161, 0
    v_dot2_f32_bf16 v194, v53, v162, 0
    v_dot2_f32_bf16 v195, v53, v163, 0
    v_dot2_f32_bf16 v196, v54, v164, 0
    v_dot2_f32_bf16 v197, v54, v165, 0
    v_dot2_f32_bf16 v198, v55, v166, 0
    v_dot2_f32_bf16 v199, v55, v167, 0
    v_cvt_pk_bf16_f32 v192, v192, v184
    v_cvt_pk_bf16_f32 v193, v193, v185
    v_cvt_pk_bf16_f32 v194, v194, v186
    v_cvt_pk_bf16_f32 v195, v195, v187
    v_cvt_pk_bf16_f32 v196, v196, v188
    v_cvt_pk_bf16_f32 v197, v197, v189
    v_cvt_pk_bf16_f32 v198, v198, v190
    v_cvt_pk_bf16_f32 v199, v199, v191
    v_dot2_f32_bf16 v184, v192, s53, 0
    v_dot2_f32_bf16 v185, v193, s53, 0
    v_dot2_f32_bf16 v186, v194, s53, 0
    v_dot2_f32_bf16 v187, v195, s53, 0
    v_dot2_f32_bf16 v188, v196, s53, 0
    v_dot2_f32_bf16 v189, v197, s53, 0
    v_dot2_f32_bf16 v190, v198, s53, 0
    v_dot2_f32_bf16 v191, v199, s53, 0
    v_dot2_f32_bf16 v192, v48, v152, 0
    v_dot2_f32_bf16 v193, v48, v153, 0
    v_dot2_f32_bf16 v194, v49, v154, 0
    v_dot2_f32_bf16 v195, v49, v155, 0
    v_dot2_f32_bf16 v196, v50, v156, 0
    v_dot2_f32_bf16 v197, v50, v157, 0
    v_dot2_f32_bf16 v198, v51, v158, 0
    v_dot2_f32_bf16 v199, v51, v159, 0
    v_cvt_pk_bf16_f32 v192, v192, v184
    v_cvt_pk_bf16_f32 v193, v193, v185
    v_cvt_pk_bf16_f32 v194, v194, v186
    v_cvt_pk_bf16_f32 v195, v195, v187
    v_cvt_pk_bf16_f32 v196, v196, v188
    v_cvt_pk_bf16_f32 v197, v197, v189
    v_cvt_pk_bf16_f32 v198, v198, v190
    v_cvt_pk_bf16_f32 v199, v199, v191
    v_dot2_f32_bf16 v184, v192, s53, 0
    v_dot2_f32_bf16 v185, v193, s53, 0
    v_dot2_f32_bf16 v186, v194, s53, 0
    v_dot2_f32_bf16 v187, v195, s53, 0
    v_dot2_f32_bf16 v188, v196, s53, 0
    v_dot2_f32_bf16 v189, v197, s53, 0
    v_dot2_f32_bf16 v190, v198, s53, 0
    v_dot2_f32_bf16 v191, v199, s53, 0
    v_and_b32 v192, 0xffff, v64
    v_and_b32 v193, 0xffff0000, v64
    v_and_b32 v194, 0xffff, v65
    v_and_b32 v195, 0xffff0000, v65
    v_and_b32 v196, 0xffff, v66
    v_and_b32 v197, 0xffff0000, v66
    v_and_b32 v198, 0xffff, v67
    v_and_b32 v199, 0xffff0000, v67
    v_cvt_pk_bf16_f32 v216, v184, v185
    v_cvt_pk_bf16_f32 v217, v186, v187
    v_cvt_pk_bf16_f32 v218, v188, v189
    v_cvt_pk_bf16_f32 v219, v190, v191
    v_dot2_f32_bf16 v184, v216, v192, 0
    v_dot2_f32_bf16 v185, v216, v193, 0
    v_dot2_f32_bf16 v186, v217, v194, 0
    v_dot2_f32_bf16 v187, v217, v195, 0
    v_dot2_f32_bf16 v188, v218, v196, 0
    v_dot2_f32_bf16 v189, v218, v197, 0
    v_dot2_f32_bf16 v190, v219, v198, 0
    v_dot2_f32_bf16 v191, v219, v199, 0
    s_lshl_b32 s62, s30, 4
    s_sub_u32 s62, 63, s62
    v_and_b32 v2, 15, v1
    v_mov_b32 v3, 128
    v_sub_u32 v2, s62, v2
    v_mul_u32_u24 v2, 144, v2
    v_add_u32 v3, v2, v3
    v_add_u32 v3, 23040, v3
    v_cvt_pk_bf16_f32 v48, v184, v185
    v_cvt_pk_bf16_f32 v49, v186, v187
    v_cvt_pk_bf16_f32 v50, v188, v189
    v_cvt_pk_bf16_f32 v51, v190, v191
    ds_write_b128 v3, v[48:51]
    s_waitcnt lgkmcnt(0)
    s_barrier
    v_lshrrev_b32 v2, 2, v5
    v_lshl_add_u32 v2, v6, 3, v2
    v_mul_u32_u24 v2, 144, v2
    v_and_b32 v3, 3, v5
    v_lshl_add_u32 v2, v3, 3, v2
    s_and_b32 s62, s30, 1
    s_mul_i32 s63, s62, 4608
    s_lshr_b32 s64, s30, 1
    s_lshl_b32 s64, s64, 5
    s_add_u32 s63, s63, s64
    s_add_u32 s63, s63, 23040
    v_add_u32 v2, s63, v2
    ds_read_b64_tr_b16 v[8:9], v2 offset:0
    ds_read_b64_tr_b16 v[10:11], v2 offset:576
    ds_read_b64_tr_b16 v[12:13], v2 offset:64
    ds_read_b64_tr_b16 v[14:15], v2 offset:640
    ds_read_b64_tr_b16 v[16:17], v2 offset:128
    ds_read_b64_tr_b16 v[18:19], v2 offset:704
    s_lshr_b32 s64, s64, 1
    v_add_u32 v4, s64, v5
    v_add_u32 v3, s61, v4
    v_lshlrev_b32 v3, 12, v3
    v_lshl_add_u32 v3, v6, 4, v3
    s_sub_u32 s60, 1984, s60
    s_lshl_b32 s60, s60, 1
    s_lshl_b32 s62, s62, 6
    s_add_u32 s60, s60, s62
    v_add_u32 v3, s60, v3
    v_cmp_gt_u32 vcc, 8, v4
    v_mov_b32 v4, 2146435072
    s_nop 0
    v_cndmask_b32 v4, v4, v3, vcc
    s_mov_b32 s62, 131072
    s_mov_b32 s60, 262144
    s_waitcnt lgkmcnt(0)
    buffer_store_dwordx4 v[8:11], v3, s[8:11], 0 offen sc1
    buffer_store_dwordx4 v[12:15], v3, s[8:11], s62 offen sc1
    buffer_store_dwordx4 v[16:19], v4, s[8:11], s60 offen sc1
    s_load_dwordx4 s[4:7], s[0:1], 64
    s_lshl_b32 s34, s28, 4
    s_add_u32 s34, s34, s31
    v_lshrrev_b32 v2, 3, v1
    v_and_b32 v3, 3, v2
    v_xor_b32 v3, v3, v1
    v_and_b32 v3, 7, v3
    v_add_u32 v2, s34, v2
    v_lshlrev_b32 v2, 12, v2
    v_lshl_add_u32 v4, v3, 4, v2
    v_add_u32 v4, 4096, v4
    v_xor_b32 v3, 4, v3
    v_lshl_add_u32 v2, v3, 4, v2
    v_add_u32 v2, 35840, v2
    s_lshl_b32 s37, s28, 11
    s_add_u32 s37, s37, 82944
    s_waitcnt lgkmcnt(0)
    s_sub_u32 s16, s4, 4096
    s_subb_u32 s17, s5, 0
    s_mov_b32 s18, 8392704
    s_mov_b32 s19, 0x20000
    s_add_u32 m0, s37, 0
    s_lshl_b32 s34, s39, 8
    s_add_u32 s34, s34, 0
    s_and_b32 s34, s34, 0xfff
    buffer_load_dwordx4 v4, s[16:19], s34 offen lds
    buffer_load_dwordx4 v2, s[16:19], s34 offen offset:1024 lds
    s_add_u32 m0, s37, 16384
    s_lshl_b32 s34, s39, 8
    s_add_u32 s34, s34, 128
    s_and_b32 s34, s34, 0xfff
    buffer_load_dwordx4 v4, s[16:19], s34 offen lds
    buffer_load_dwordx4 v2, s[16:19], s34 offen offset:1024 lds
    s_add_u32 m0, s37, 32768
    s_lshl_b32 s34, s39, 8
    s_add_u32 s34, s34, 256
    s_and_b32 s34, s34, 0xfff
    buffer_load_dwordx4 v4, s[16:19], s34 offen lds
    buffer_load_dwordx4 v2, s[16:19], s34 offen offset:1024 lds
    s_add_u32 m0, s37, 49152
    s_lshl_b32 s34, s39, 8
    s_add_u32 s34, s34, 384
    s_and_b32 s34, s34, 0xfff
    buffer_load_dwordx4 v4, s[16:19], s34 offen lds
    buffer_load_dwordx4 v2, s[16:19], s34 offen offset:1024 lds
    v_mov_b32 v228, 1.0
    v_mov_b32 v229, 1.0
    v_lshrrev_b32 v233, 2, v5
    v_and_b32 v234, 3, v5
    v_lshl_add_u32 v233, v233, 3, v234
    s_lshl_b32 s34, s30, 7
    v_lshlrev_b32 v232, 2, v233
    v_add_u32 v232, s34, v232
    ds_read_b32 v184, v232 offset:1280
    ds_read_b32 v186, v232 offset:1792
    ds_read_b32 v192, v232 offset:1296
    ds_read_b32 v194, v232 offset:1808
    s_lshl_b32 s34, s39, 3
    s_lshl_b32 s37, s30, 1
    s_add_u32 s34, s34, s37
    s_lshl_b32 s34, s34, 3
    s_lshr_b32 s37, s32, 1
    s_add_u32 s34, s34, s37
    s_mul_i32 s34, s34, 9216
    v_add_u32 v231, s34, v7
    v_add_u32 v230, 73728, v231
    s_and_b32 s37, s32, 1
    s_lshl_b32 s38, s37, 12
    s_lshl_b32 s37, s37, 3
    s_add_u32 s37, s37, 8192
    v_lshlrev_b32 v232, 4, v6
    s_waitcnt lgkmcnt(0)
    v_mul_f32 v188, 0xc0135761, v186
    v_mul_f32 v190, v186, v186
    v_mul_f32 v190, v190, v186
    v_mul_f32 v190, 0xbdd2d3e8, v190
    v_mov_b32 v185, v184
    v_mov_b32 v187, v186
    v_mov_b32 v189, v188
    v_mov_b32 v191, v190
    v_mul_f32 v196, 0xc0135761, v194
    v_mul_f32 v198, v194, v194
    v_mul_f32 v198, v198, v194
    v_mul_f32 v198, 0xbdd2d3e8, v198
    v_mov_b32 v193, v192
    v_mov_b32 v195, v194
    v_mov_b32 v197, v196
    v_mov_b32 v199, v198
    ds_read_b128 v[152:155], v232 offset:576
    ds_read_b128 v[156:159], v232 offset:640
    s_waitcnt lgkmcnt(0)
    v_pk_fma_f32 v[80:81], v[184:185], v[152:153], v[80:81] neg_lo:[1,0,0] neg_hi:[1,0,0]
    v_pk_fma_f32 v[82:83], v[184:185], v[154:155], v[82:83] neg_lo:[1,0,0] neg_hi:[1,0,0]
    v_pk_fma_f32 v[88:89], v[184:185], v[156:157], v[88:89] neg_lo:[1,0,0] neg_hi:[1,0,0]
    v_pk_fma_f32 v[90:91], v[184:185], v[158:159], v[90:91] neg_lo:[1,0,0] neg_hi:[1,0,0]
    v_pk_mul_f32 v[208:209], v[80:81], v[80:81]
    v_pk_mul_f32 v[210:211], v[82:83], v[82:83]
    v_pk_mul_f32 v[212:213], v[88:89], v[88:89]
    v_pk_mul_f32 v[214:215], v[90:91], v[90:91]
    v_pk_fma_f32 v[208:209], v[208:209], v[190:191], v[188:189]
    v_pk_fma_f32 v[210:211], v[210:211], v[190:191], v[188:189]
    v_pk_fma_f32 v[212:213], v[212:213], v[190:191], v[188:189]
    v_pk_fma_f32 v[214:215], v[214:215], v[190:191], v[188:189]
    v_pk_mul_f32 v[208:209], v[208:209], v[80:81]
    v_pk_mul_f32 v[210:211], v[210:211], v[82:83]
    v_pk_mul_f32 v[212:213], v[212:213], v[88:89]
    v_pk_mul_f32 v[214:215], v[214:215], v[90:91]
    v_exp_f32 v208, v208
    v_exp_f32 v209, v209
    v_exp_f32 v210, v210
    v_exp_f32 v211, v211
    v_exp_f32 v212, v212
    v_exp_f32 v213, v213
    v_exp_f32 v214, v214
    v_exp_f32 v215, v215
    v_pk_mul_f32 v[80:81], v[80:81], v[186:187]
    v_pk_mul_f32 v[82:83], v[82:83], v[186:187]
    v_pk_mul_f32 v[88:89], v[88:89], v[186:187]
    v_pk_mul_f32 v[90:91], v[90:91], v[186:187]
    v_pk_add_f32 v[208:209], v[208:209], v[228:229]
    v_pk_add_f32 v[210:211], v[210:211], v[228:229]
    v_pk_add_f32 v[212:213], v[212:213], v[228:229]
    v_pk_add_f32 v[214:215], v[214:215], v[228:229]
    v_rcp_f32 v208, v208
    v_rcp_f32 v209, v209
    v_rcp_f32 v210, v210
    v_rcp_f32 v211, v211
    v_rcp_f32 v212, v212
    v_rcp_f32 v213, v213
    v_rcp_f32 v214, v214
    v_rcp_f32 v215, v215
    v_pk_mul_f32 v[80:81], v[80:81], v[208:209]
    v_pk_mul_f32 v[82:83], v[82:83], v[210:211]
    v_pk_mul_f32 v[88:89], v[88:89], v[212:213]
    v_pk_mul_f32 v[90:91], v[90:91], v[214:215]
    v_cvt_pk_bf16_f32 v236, v80, v81
    v_cvt_pk_bf16_f32 v237, v82, v83
    v_cvt_pk_bf16_f32 v238, v88, v89
    v_cvt_pk_bf16_f32 v239, v90, v91
    v_pk_fma_f32 v[84:85], v[192:193], v[152:153], v[84:85] neg_lo:[1,0,0] neg_hi:[1,0,0]
    v_pk_fma_f32 v[86:87], v[192:193], v[154:155], v[86:87] neg_lo:[1,0,0] neg_hi:[1,0,0]
    v_pk_fma_f32 v[92:93], v[192:193], v[156:157], v[92:93] neg_lo:[1,0,0] neg_hi:[1,0,0]
    v_pk_fma_f32 v[94:95], v[192:193], v[158:159], v[94:95] neg_lo:[1,0,0] neg_hi:[1,0,0]
    v_pk_mul_f32 v[208:209], v[84:85], v[84:85]
    v_pk_mul_f32 v[210:211], v[86:87], v[86:87]
    v_pk_mul_f32 v[212:213], v[92:93], v[92:93]
    v_pk_mul_f32 v[214:215], v[94:95], v[94:95]
    v_pk_fma_f32 v[208:209], v[208:209], v[198:199], v[196:197]
    v_pk_fma_f32 v[210:211], v[210:211], v[198:199], v[196:197]
    v_pk_fma_f32 v[212:213], v[212:213], v[198:199], v[196:197]
    v_pk_fma_f32 v[214:215], v[214:215], v[198:199], v[196:197]
    v_pk_mul_f32 v[208:209], v[208:209], v[84:85]
    v_pk_mul_f32 v[210:211], v[210:211], v[86:87]
    v_pk_mul_f32 v[212:213], v[212:213], v[92:93]
    v_pk_mul_f32 v[214:215], v[214:215], v[94:95]
    v_exp_f32 v208, v208
    v_exp_f32 v209, v209
    v_exp_f32 v210, v210
    v_exp_f32 v211, v211
    v_exp_f32 v212, v212
    v_exp_f32 v213, v213
    v_exp_f32 v214, v214
    v_exp_f32 v215, v215
    v_pk_mul_f32 v[84:85], v[84:85], v[194:195]
    v_pk_mul_f32 v[86:87], v[86:87], v[194:195]
    v_pk_mul_f32 v[92:93], v[92:93], v[194:195]
    v_pk_mul_f32 v[94:95], v[94:95], v[194:195]
    v_pk_add_f32 v[208:209], v[208:209], v[228:229]
    v_pk_add_f32 v[210:211], v[210:211], v[228:229]
    v_pk_add_f32 v[212:213], v[212:213], v[228:229]
    v_pk_add_f32 v[214:215], v[214:215], v[228:229]
    v_rcp_f32 v208, v208
    v_rcp_f32 v209, v209
    v_rcp_f32 v210, v210
    v_rcp_f32 v211, v211
    v_rcp_f32 v212, v212
    v_rcp_f32 v213, v213
    v_rcp_f32 v214, v214
    v_rcp_f32 v215, v215
    v_pk_mul_f32 v[84:85], v[84:85], v[208:209]
    v_pk_mul_f32 v[86:87], v[86:87], v[210:211]
    v_pk_mul_f32 v[92:93], v[92:93], v[212:213]
    v_pk_mul_f32 v[94:95], v[94:95], v[214:215]
    v_cvt_pk_bf16_f32 v244, v84, v85
    v_cvt_pk_bf16_f32 v245, v86, v87
    v_cvt_pk_bf16_f32 v246, v92, v93
    v_cvt_pk_bf16_f32 v247, v94, v95
    ds_read_b128 v[152:155], v232 offset:704
    ds_read_b128 v[156:159], v232 offset:768
    s_waitcnt lgkmcnt(0)
    v_pk_fma_f32 v[96:97], v[184:185], v[152:153], v[96:97] neg_lo:[1,0,0] neg_hi:[1,0,0]
    v_pk_fma_f32 v[98:99], v[184:185], v[154:155], v[98:99] neg_lo:[1,0,0] neg_hi:[1,0,0]
    v_pk_fma_f32 v[104:105], v[184:185], v[156:157], v[104:105] neg_lo:[1,0,0] neg_hi:[1,0,0]
    v_pk_fma_f32 v[106:107], v[184:185], v[158:159], v[106:107] neg_lo:[1,0,0] neg_hi:[1,0,0]
    v_pk_mul_f32 v[208:209], v[96:97], v[96:97]
    v_pk_mul_f32 v[210:211], v[98:99], v[98:99]
    v_pk_mul_f32 v[212:213], v[104:105], v[104:105]
    v_pk_mul_f32 v[214:215], v[106:107], v[106:107]
    v_pk_fma_f32 v[208:209], v[208:209], v[190:191], v[188:189]
    v_pk_fma_f32 v[210:211], v[210:211], v[190:191], v[188:189]
    v_pk_fma_f32 v[212:213], v[212:213], v[190:191], v[188:189]
    v_pk_fma_f32 v[214:215], v[214:215], v[190:191], v[188:189]
    v_pk_mul_f32 v[208:209], v[208:209], v[96:97]
    v_pk_mul_f32 v[210:211], v[210:211], v[98:99]
    v_pk_mul_f32 v[212:213], v[212:213], v[104:105]
    v_pk_mul_f32 v[214:215], v[214:215], v[106:107]
    v_exp_f32 v208, v208
    v_exp_f32 v209, v209
    v_exp_f32 v210, v210
    v_exp_f32 v211, v211
    v_exp_f32 v212, v212
    v_exp_f32 v213, v213
    v_exp_f32 v214, v214
    v_exp_f32 v215, v215
    v_pk_mul_f32 v[96:97], v[96:97], v[186:187]
    v_pk_mul_f32 v[98:99], v[98:99], v[186:187]
    v_pk_mul_f32 v[104:105], v[104:105], v[186:187]
    v_pk_mul_f32 v[106:107], v[106:107], v[186:187]
    v_pk_add_f32 v[208:209], v[208:209], v[228:229]
    v_pk_add_f32 v[210:211], v[210:211], v[228:229]
    v_pk_add_f32 v[212:213], v[212:213], v[228:229]
    v_pk_add_f32 v[214:215], v[214:215], v[228:229]
    v_rcp_f32 v208, v208
    v_rcp_f32 v209, v209
    v_rcp_f32 v210, v210
    v_rcp_f32 v211, v211
    v_rcp_f32 v212, v212
    v_rcp_f32 v213, v213
    v_rcp_f32 v214, v214
    v_rcp_f32 v215, v215
    v_pk_mul_f32 v[96:97], v[96:97], v[208:209]
    v_pk_mul_f32 v[98:99], v[98:99], v[210:211]
    v_pk_mul_f32 v[104:105], v[104:105], v[212:213]
    v_pk_mul_f32 v[106:107], v[106:107], v[214:215]
    v_cvt_pk_bf16_f32 v240, v96, v97
    v_cvt_pk_bf16_f32 v241, v98, v99
    v_cvt_pk_bf16_f32 v242, v104, v105
    v_cvt_pk_bf16_f32 v243, v106, v107
    v_pk_fma_f32 v[100:101], v[192:193], v[152:153], v[100:101] neg_lo:[1,0,0] neg_hi:[1,0,0]
    v_pk_fma_f32 v[102:103], v[192:193], v[154:155], v[102:103] neg_lo:[1,0,0] neg_hi:[1,0,0]
    v_pk_fma_f32 v[108:109], v[192:193], v[156:157], v[108:109] neg_lo:[1,0,0] neg_hi:[1,0,0]
    v_pk_fma_f32 v[110:111], v[192:193], v[158:159], v[110:111] neg_lo:[1,0,0] neg_hi:[1,0,0]
    v_pk_mul_f32 v[208:209], v[100:101], v[100:101]
    v_pk_mul_f32 v[210:211], v[102:103], v[102:103]
    v_pk_mul_f32 v[212:213], v[108:109], v[108:109]
    v_pk_mul_f32 v[214:215], v[110:111], v[110:111]
    v_pk_fma_f32 v[208:209], v[208:209], v[198:199], v[196:197]
    v_pk_fma_f32 v[210:211], v[210:211], v[198:199], v[196:197]
    v_pk_fma_f32 v[212:213], v[212:213], v[198:199], v[196:197]
    v_pk_fma_f32 v[214:215], v[214:215], v[198:199], v[196:197]
    v_pk_mul_f32 v[208:209], v[208:209], v[100:101]
    v_pk_mul_f32 v[210:211], v[210:211], v[102:103]
    v_pk_mul_f32 v[212:213], v[212:213], v[108:109]
    v_pk_mul_f32 v[214:215], v[214:215], v[110:111]
    v_exp_f32 v208, v208
    v_exp_f32 v209, v209
    v_exp_f32 v210, v210
    v_exp_f32 v211, v211
    v_exp_f32 v212, v212
    v_exp_f32 v213, v213
    v_exp_f32 v214, v214
    v_exp_f32 v215, v215
    v_pk_mul_f32 v[100:101], v[100:101], v[194:195]
    v_pk_mul_f32 v[102:103], v[102:103], v[194:195]
    v_pk_mul_f32 v[108:109], v[108:109], v[194:195]
    v_pk_mul_f32 v[110:111], v[110:111], v[194:195]
    v_pk_add_f32 v[208:209], v[208:209], v[228:229]
    v_pk_add_f32 v[210:211], v[210:211], v[228:229]
    v_pk_add_f32 v[212:213], v[212:213], v[228:229]
    v_pk_add_f32 v[214:215], v[214:215], v[228:229]
    v_rcp_f32 v208, v208
    v_rcp_f32 v209, v209
    v_rcp_f32 v210, v210
    v_rcp_f32 v211, v211
    v_rcp_f32 v212, v212
    v_rcp_f32 v213, v213
    v_rcp_f32 v214, v214
    v_rcp_f32 v215, v215
    v_pk_mul_f32 v[100:101], v[100:101], v[208:209]
    v_pk_mul_f32 v[102:103], v[102:103], v[210:211]
    v_pk_mul_f32 v[108:109], v[108:109], v[212:213]
    v_pk_mul_f32 v[110:111], v[110:111], v[214:215]
    v_cvt_pk_bf16_f32 v248, v100, v101
    v_cvt_pk_bf16_f32 v249, v102, v103
    v_cvt_pk_bf16_f32 v250, v108, v109
    v_cvt_pk_bf16_f32 v251, v110, v111
    s_lshl_b32 s59, s32, 8
    s_add_u32 s59, s59, 1867776
    s_lshl_b32 s60, s39, 2
    s_add_u32 s60, s60, s59
    s_and_b32 s61, s2, 7
    s_lshl_b32 s61, s61, 8
    s_add_u32 s61, s61, 1875968
    s_waitcnt vmcnt(0)
    v_mov_b32 v2, 160768
    v_mov_b32 v3, 1
    s_mov_b64 exec, 1
    ds_add_rtn_u32 v2, v2, v3
    s_waitcnt lgkmcnt(0)
    v_readfirstlane_b32 s34, v2
    s_cmp_eq_u32 s34, 7
    s_cselect_b32 s34, 0, 2146435072
    s_mov_b64 exec, 3
    v_mov_b32 v3, 1
    v_mov_b32 v2, s60
    v_writelane_b32 v2, s61, 1
    buffer_atomic_add v3, v2, s[48:51], s34 offen sc1
    s_mov_b64 exec, -1
    ds_read_b128 v[152:155], v232 offset:832
    ds_read_b128 v[156:159], v232 offset:896
    s_waitcnt lgkmcnt(0)
    v_pk_fma_f32 v[112:113], v[184:185], v[152:153], v[112:113] neg_lo:[1,0,0] neg_hi:[1,0,0]
    v_pk_fma_f32 v[114:115], v[184:185], v[154:155], v[114:115] neg_lo:[1,0,0] neg_hi:[1,0,0]
    v_pk_fma_f32 v[120:121], v[184:185], v[156:157], v[120:121] neg_lo:[1,0,0] neg_hi:[1,0,0]
    v_pk_fma_f32 v[122:123], v[184:185], v[158:159], v[122:123] neg_lo:[1,0,0] neg_hi:[1,0,0]
    v_pk_mul_f32 v[208:209], v[112:113], v[112:113]
    v_pk_mul_f32 v[210:211], v[114:115], v[114:115]
    v_pk_mul_f32 v[212:213], v[120:121], v[120:121]
    v_pk_mul_f32 v[214:215], v[122:123], v[122:123]
    v_pk_fma_f32 v[208:209], v[208:209], v[190:191], v[188:189]
    v_pk_fma_f32 v[210:211], v[210:211], v[190:191], v[188:189]
    v_pk_fma_f32 v[212:213], v[212:213], v[190:191], v[188:189]
    v_pk_fma_f32 v[214:215], v[214:215], v[190:191], v[188:189]
    v_pk_mul_f32 v[208:209], v[208:209], v[112:113]
    v_pk_mul_f32 v[210:211], v[210:211], v[114:115]
    v_pk_mul_f32 v[212:213], v[212:213], v[120:121]
    v_pk_mul_f32 v[214:215], v[214:215], v[122:123]
    v_exp_f32 v208, v208
    v_exp_f32 v209, v209
    v_exp_f32 v210, v210
    v_exp_f32 v211, v211
    v_exp_f32 v212, v212
    v_exp_f32 v213, v213
    v_exp_f32 v214, v214
    v_exp_f32 v215, v215
    v_pk_mul_f32 v[112:113], v[112:113], v[186:187]
    v_pk_mul_f32 v[114:115], v[114:115], v[186:187]
    v_pk_mul_f32 v[120:121], v[120:121], v[186:187]
    v_pk_mul_f32 v[122:123], v[122:123], v[186:187]
    v_pk_add_f32 v[208:209], v[208:209], v[228:229]
    v_pk_add_f32 v[210:211], v[210:211], v[228:229]
    v_pk_add_f32 v[212:213], v[212:213], v[228:229]
    v_pk_add_f32 v[214:215], v[214:215], v[228:229]
    v_rcp_f32 v208, v208
    v_rcp_f32 v209, v209
    v_rcp_f32 v210, v210
    v_rcp_f32 v211, v211
    v_rcp_f32 v212, v212
    v_rcp_f32 v213, v213
    v_rcp_f32 v214, v214
    v_rcp_f32 v215, v215
    v_pk_mul_f32 v[112:113], v[112:113], v[208:209]
    v_pk_mul_f32 v[114:115], v[114:115], v[210:211]
    v_pk_mul_f32 v[120:121], v[120:121], v[212:213]
    v_pk_mul_f32 v[122:123], v[122:123], v[214:215]
    v_cvt_pk_bf16_f32 v160, v112, v113
    v_cvt_pk_bf16_f32 v161, v114, v115
    v_cvt_pk_bf16_f32 v162, v120, v121
    v_cvt_pk_bf16_f32 v163, v122, v123
    v_pk_fma_f32 v[116:117], v[192:193], v[152:153], v[116:117] neg_lo:[1,0,0] neg_hi:[1,0,0]
    v_pk_fma_f32 v[118:119], v[192:193], v[154:155], v[118:119] neg_lo:[1,0,0] neg_hi:[1,0,0]
    v_pk_fma_f32 v[124:125], v[192:193], v[156:157], v[124:125] neg_lo:[1,0,0] neg_hi:[1,0,0]
    v_pk_fma_f32 v[126:127], v[192:193], v[158:159], v[126:127] neg_lo:[1,0,0] neg_hi:[1,0,0]
    v_pk_mul_f32 v[208:209], v[116:117], v[116:117]
    v_pk_mul_f32 v[210:211], v[118:119], v[118:119]
    v_pk_mul_f32 v[212:213], v[124:125], v[124:125]
    v_pk_mul_f32 v[214:215], v[126:127], v[126:127]
    v_pk_fma_f32 v[208:209], v[208:209], v[198:199], v[196:197]
    v_pk_fma_f32 v[210:211], v[210:211], v[198:199], v[196:197]
    v_pk_fma_f32 v[212:213], v[212:213], v[198:199], v[196:197]
    v_pk_fma_f32 v[214:215], v[214:215], v[198:199], v[196:197]
    v_pk_mul_f32 v[208:209], v[208:209], v[116:117]
    v_pk_mul_f32 v[210:211], v[210:211], v[118:119]
    v_pk_mul_f32 v[212:213], v[212:213], v[124:125]
    v_pk_mul_f32 v[214:215], v[214:215], v[126:127]
    v_exp_f32 v208, v208
    v_exp_f32 v209, v209
    v_exp_f32 v210, v210
    v_exp_f32 v211, v211
    v_exp_f32 v212, v212
    v_exp_f32 v213, v213
    v_exp_f32 v214, v214
    v_exp_f32 v215, v215
    v_pk_mul_f32 v[116:117], v[116:117], v[194:195]
    v_pk_mul_f32 v[118:119], v[118:119], v[194:195]
    v_pk_mul_f32 v[124:125], v[124:125], v[194:195]
    v_pk_mul_f32 v[126:127], v[126:127], v[194:195]
    v_pk_add_f32 v[208:209], v[208:209], v[228:229]
    v_pk_add_f32 v[210:211], v[210:211], v[228:229]
    v_pk_add_f32 v[212:213], v[212:213], v[228:229]
    v_pk_add_f32 v[214:215], v[214:215], v[228:229]
    v_rcp_f32 v208, v208
    v_rcp_f32 v209, v209
    v_rcp_f32 v210, v210
    v_rcp_f32 v211, v211
    v_rcp_f32 v212, v212
    v_rcp_f32 v213, v213
    v_rcp_f32 v214, v214
    v_rcp_f32 v215, v215
    v_pk_mul_f32 v[116:117], v[116:117], v[208:209]
    v_pk_mul_f32 v[118:119], v[118:119], v[210:211]
    v_pk_mul_f32 v[124:125], v[124:125], v[212:213]
    v_pk_mul_f32 v[126:127], v[126:127], v[214:215]
    v_cvt_pk_bf16_f32 v168, v116, v117
    v_cvt_pk_bf16_f32 v169, v118, v119
    v_cvt_pk_bf16_f32 v170, v124, v125
    v_cvt_pk_bf16_f32 v171, v126, v127
    ds_read_b128 v[152:155], v232 offset:960
    ds_read_b128 v[156:159], v232 offset:1024
    s_waitcnt lgkmcnt(0)
    v_pk_fma_f32 v[128:129], v[184:185], v[152:153], v[128:129] neg_lo:[1,0,0] neg_hi:[1,0,0]
    v_pk_fma_f32 v[130:131], v[184:185], v[154:155], v[130:131] neg_lo:[1,0,0] neg_hi:[1,0,0]
    v_pk_fma_f32 v[136:137], v[184:185], v[156:157], v[136:137] neg_lo:[1,0,0] neg_hi:[1,0,0]
    v_pk_fma_f32 v[138:139], v[184:185], v[158:159], v[138:139] neg_lo:[1,0,0] neg_hi:[1,0,0]
    v_pk_mul_f32 v[208:209], v[128:129], v[128:129]
    v_pk_mul_f32 v[210:211], v[130:131], v[130:131]
    v_pk_mul_f32 v[212:213], v[136:137], v[136:137]
    v_pk_mul_f32 v[214:215], v[138:139], v[138:139]
    v_pk_fma_f32 v[208:209], v[208:209], v[190:191], v[188:189]
    v_pk_fma_f32 v[210:211], v[210:211], v[190:191], v[188:189]
    v_pk_fma_f32 v[212:213], v[212:213], v[190:191], v[188:189]
    v_pk_fma_f32 v[214:215], v[214:215], v[190:191], v[188:189]
    v_pk_mul_f32 v[208:209], v[208:209], v[128:129]
    v_pk_mul_f32 v[210:211], v[210:211], v[130:131]
    v_pk_mul_f32 v[212:213], v[212:213], v[136:137]
    v_pk_mul_f32 v[214:215], v[214:215], v[138:139]
    v_exp_f32 v208, v208
    v_exp_f32 v209, v209
    v_exp_f32 v210, v210
    v_exp_f32 v211, v211
    v_exp_f32 v212, v212
    v_exp_f32 v213, v213
    v_exp_f32 v214, v214
    v_exp_f32 v215, v215
    v_pk_mul_f32 v[128:129], v[128:129], v[186:187]
    v_pk_mul_f32 v[130:131], v[130:131], v[186:187]
    v_pk_mul_f32 v[136:137], v[136:137], v[186:187]
    v_pk_mul_f32 v[138:139], v[138:139], v[186:187]
    v_pk_add_f32 v[208:209], v[208:209], v[228:229]
    v_pk_add_f32 v[210:211], v[210:211], v[228:229]
    v_pk_add_f32 v[212:213], v[212:213], v[228:229]
    v_pk_add_f32 v[214:215], v[214:215], v[228:229]
    v_rcp_f32 v208, v208
    v_rcp_f32 v209, v209
    v_rcp_f32 v210, v210
    v_rcp_f32 v211, v211
    v_rcp_f32 v212, v212
    v_rcp_f32 v213, v213
    v_rcp_f32 v214, v214
    v_rcp_f32 v215, v215
    v_pk_mul_f32 v[128:129], v[128:129], v[208:209]
    v_pk_mul_f32 v[130:131], v[130:131], v[210:211]
    v_pk_mul_f32 v[136:137], v[136:137], v[212:213]
    v_pk_mul_f32 v[138:139], v[138:139], v[214:215]
    v_cvt_pk_bf16_f32 v164, v128, v129
    v_cvt_pk_bf16_f32 v165, v130, v131
    v_cvt_pk_bf16_f32 v166, v136, v137
    v_cvt_pk_bf16_f32 v167, v138, v139
    v_pk_fma_f32 v[132:133], v[192:193], v[152:153], v[132:133] neg_lo:[1,0,0] neg_hi:[1,0,0]
    v_pk_fma_f32 v[134:135], v[192:193], v[154:155], v[134:135] neg_lo:[1,0,0] neg_hi:[1,0,0]
    v_pk_fma_f32 v[140:141], v[192:193], v[156:157], v[140:141] neg_lo:[1,0,0] neg_hi:[1,0,0]
    v_pk_fma_f32 v[142:143], v[192:193], v[158:159], v[142:143] neg_lo:[1,0,0] neg_hi:[1,0,0]
    v_pk_mul_f32 v[208:209], v[132:133], v[132:133]
    v_pk_mul_f32 v[210:211], v[134:135], v[134:135]
    v_pk_mul_f32 v[212:213], v[140:141], v[140:141]
    v_pk_mul_f32 v[214:215], v[142:143], v[142:143]
    v_pk_fma_f32 v[208:209], v[208:209], v[198:199], v[196:197]
    v_pk_fma_f32 v[210:211], v[210:211], v[198:199], v[196:197]
    v_pk_fma_f32 v[212:213], v[212:213], v[198:199], v[196:197]
    v_pk_fma_f32 v[214:215], v[214:215], v[198:199], v[196:197]
    v_pk_mul_f32 v[208:209], v[208:209], v[132:133]
    v_pk_mul_f32 v[210:211], v[210:211], v[134:135]
    v_pk_mul_f32 v[212:213], v[212:213], v[140:141]
    v_pk_mul_f32 v[214:215], v[214:215], v[142:143]
    v_exp_f32 v208, v208
    v_exp_f32 v209, v209
    v_exp_f32 v210, v210
    v_exp_f32 v211, v211
    v_exp_f32 v212, v212
    v_exp_f32 v213, v213
    v_exp_f32 v214, v214
    v_exp_f32 v215, v215
    v_pk_mul_f32 v[132:133], v[132:133], v[194:195]
    v_pk_mul_f32 v[134:135], v[134:135], v[194:195]
    v_pk_mul_f32 v[140:141], v[140:141], v[194:195]
    v_pk_mul_f32 v[142:143], v[142:143], v[194:195]
    v_pk_add_f32 v[208:209], v[208:209], v[228:229]
    v_pk_add_f32 v[210:211], v[210:211], v[228:229]
    v_pk_add_f32 v[212:213], v[212:213], v[228:229]
    v_pk_add_f32 v[214:215], v[214:215], v[228:229]
    v_rcp_f32 v208, v208
    v_rcp_f32 v209, v209
    v_rcp_f32 v210, v210
    v_rcp_f32 v211, v211
    v_rcp_f32 v212, v212
    v_rcp_f32 v213, v213
    v_rcp_f32 v214, v214
    v_rcp_f32 v215, v215
    v_pk_mul_f32 v[132:133], v[132:133], v[208:209]
    v_pk_mul_f32 v[134:135], v[134:135], v[210:211]
    v_pk_mul_f32 v[140:141], v[140:141], v[212:213]
    v_pk_mul_f32 v[142:143], v[142:143], v[214:215]
    v_cvt_pk_bf16_f32 v172, v132, v133
    v_cvt_pk_bf16_f32 v173, v134, v135
    v_cvt_pk_bf16_f32 v174, v140, v141
    v_cvt_pk_bf16_f32 v175, v142, v143
    ds_read_b128 v[152:155], v232 offset:1088
    s_waitcnt lgkmcnt(0)
    v_pk_fma_f32 v[144:145], v[184:185], v[152:153], v[144:145] neg_lo:[1,0,0] neg_hi:[1,0,0]
    v_pk_fma_f32 v[146:147], v[184:185], v[154:155], v[146:147] neg_lo:[1,0,0] neg_hi:[1,0,0]
    v_pk_fma_f32 v[148:149], v[192:193], v[152:153], v[148:149] neg_lo:[1,0,0] neg_hi:[1,0,0]
    v_pk_fma_f32 v[150:151], v[192:193], v[154:155], v[150:151] neg_lo:[1,0,0] neg_hi:[1,0,0]
    v_pk_mul_f32 v[208:209], v[144:145], v[144:145]
    v_pk_mul_f32 v[210:211], v[146:147], v[146:147]
    v_pk_mul_f32 v[212:213], v[148:149], v[148:149]
    v_pk_mul_f32 v[214:215], v[150:151], v[150:151]
    v_pk_fma_f32 v[208:209], v[208:209], v[190:191], v[188:189]
    v_pk_fma_f32 v[210:211], v[210:211], v[190:191], v[188:189]
    v_pk_fma_f32 v[212:213], v[212:213], v[198:199], v[196:197]
    v_pk_fma_f32 v[214:215], v[214:215], v[198:199], v[196:197]
    v_pk_mul_f32 v[208:209], v[208:209], v[144:145]
    v_pk_mul_f32 v[210:211], v[210:211], v[146:147]
    v_pk_mul_f32 v[212:213], v[212:213], v[148:149]
    v_pk_mul_f32 v[214:215], v[214:215], v[150:151]
    v_exp_f32 v208, v208
    v_exp_f32 v209, v209
    v_exp_f32 v210, v210
    v_exp_f32 v211, v211
    v_exp_f32 v212, v212
    v_exp_f32 v213, v213
    v_exp_f32 v214, v214
    v_exp_f32 v215, v215
    v_pk_mul_f32 v[144:145], v[144:145], v[186:187]
    v_pk_mul_f32 v[146:147], v[146:147], v[186:187]
    v_pk_mul_f32 v[148:149], v[148:149], v[194:195]
    v_pk_mul_f32 v[150:151], v[150:151], v[194:195]
    v_pk_add_f32 v[208:209], v[208:209], v[228:229]
    v_pk_add_f32 v[210:211], v[210:211], v[228:229]
    v_pk_add_f32 v[212:213], v[212:213], v[228:229]
    v_pk_add_f32 v[214:215], v[214:215], v[228:229]
    v_rcp_f32 v208, v208
    v_rcp_f32 v209, v209
    v_rcp_f32 v210, v210
    v_rcp_f32 v211, v211
    v_rcp_f32 v212, v212
    v_rcp_f32 v213, v213
    v_rcp_f32 v214, v214
    v_rcp_f32 v215, v215
    v_pk_mul_f32 v[144:145], v[144:145], v[208:209]
    v_pk_mul_f32 v[146:147], v[146:147], v[210:211]
    v_pk_mul_f32 v[148:149], v[148:149], v[212:213]
    v_pk_mul_f32 v[150:151], v[150:151], v[214:215]
    v_cvt_pk_bf16_f32 v176, v144, v145
    v_cvt_pk_bf16_f32 v177, v146, v147
    v_cvt_pk_bf16_f32 v178, v148, v149
    v_cvt_pk_bf16_f32 v179, v150, v151
recurrent_scan__ssm_conv_h3__mixer_gmlp__prompt_kernel_bend19:
    s_add_u32 s20, s42, 33554432
    s_addc_u32 s21, s43, 0
    s_mov_b32 s22, 9437184
    s_mov_b32 s23, 0x20000
    s_mov_b32 s24, s6
    s_mov_b32 s25, s7
    s_mov_b32 s26, 4096
    s_mov_b32 s27, 0x20000
    s_mov_b32 s35, 36864
    s_mov_b32 s36, 0
    s_mov_b32 s33, 0
    v_lshrrev_b32 v4, 2, v5
    v_and_b32 v3, 3, v5
    v_lshl_add_u32 v4, v4, 3, v3
    s_lshl_b32 s34, s30, 5
    s_add_u32 s34, s34, s31
    v_add_u32 v138, s34, v4
    v_lshlrev_b32 v138, 1, v138
    buffer_load_ushort v140, v138, s[24:27], 0 offen offset:0
    buffer_load_ushort v141, v138, s[24:27], 0 offen offset:8
    s_lshr_b32 s34, s34, 4
    s_lshl_b32 s34, s34, 3
    s_lshr_b32 s62, s32, 1
    s_add_u32 s34, s34, s62
    s_mul_i32 s34, s34, 9216
    s_and_b32 s62, s32, 1
    s_lshl_b32 s63, s62, 12
    s_add_u32 s63, s63, s34
    s_xor_b32 s64, s29, 1
    s_lshl_b32 s64, s64, 11
    s_add_u32 s63, s63, s64
    v_add_u32 v136, s63, v7
    s_lshl_b32 s62, s62, 3
    s_add_u32 s62, s62, s34
    s_add_u32 s62, s62, 8192
    v_add_u32 v137, s62, v7
    s_mov_b32 s65, 73728
    s_waitcnt lgkmcnt(0)
    s_cmp_eq_u32 s29, 1
    s_cbranch_scc1 recurrent_scan__ssm_conv_h3__mixer_gmlp__prompt_kernel_ld220
    v_xor_b32 v2, v6, v5
    v_and_b32 v2, 7, v2
    v_lshlrev_b32 v2, 4, v2
    v_lshl_add_u32 v2, v4, 7, v2
    s_lshl_b32 s34, s30, 12
    s_add_u32 s34, s34, 82944
    v_add_u32 v133, s34, v2
    v_mov_b32 v8, 0
    v_mov_b32 v9, 0
    v_mov_b32 v10, 0
    v_mov_b32 v11, 0
    v_mov_b32 v12, 0
    v_mov_b32 v13, 0
    v_mov_b32 v14, 0
    v_mov_b32 v15, 0
    v_mov_b32 v16, 0
    v_mov_b32 v17, 0
    v_mov_b32 v18, 0
    v_mov_b32 v19, 0
    v_mov_b32 v20, 0
    v_mov_b32 v21, 0
    v_mov_b32 v22, 0
    v_mov_b32 v23, 0
    v_mov_b32 v24, 0
    v_mov_b32 v25, 0
    v_mov_b32 v26, 0
    v_mov_b32 v27, 0
    v_mov_b32 v28, 0
    v_mov_b32 v29, 0
    v_mov_b32 v30, 0
    v_mov_b32 v31, 0
    v_mov_b32 v32, 0
    v_mov_b32 v33, 0
    v_mov_b32 v34, 0
    v_mov_b32 v35, 0
    v_mov_b32 v36, 0
    v_mov_b32 v37, 0
    v_mov_b32 v38, 0
    v_mov_b32 v39, 0
    v_mov_b32 v40, 0
    v_mov_b32 v41, 0
    v_mov_b32 v42, 0
    v_mov_b32 v43, 0
    v_mov_b32 v44, 0
    v_mov_b32 v45, 0
    v_mov_b32 v46, 0
    v_mov_b32 v47, 0
    v_mov_b32 v48, 0
    v_mov_b32 v49, 0
    v_mov_b32 v50, 0
    v_mov_b32 v51, 0
    v_mov_b32 v52, 0
    v_mov_b32 v53, 0
    v_mov_b32 v54, 0
    v_mov_b32 v55, 0
    v_mov_b32 v56, 0
    v_mov_b32 v57, 0
    v_mov_b32 v58, 0
    v_mov_b32 v59, 0
    v_mov_b32 v60, 0
    v_mov_b32 v61, 0
    v_mov_b32 v62, 0
    v_mov_b32 v63, 0
    v_mov_b32 v64, 0
    v_mov_b32 v65, 0
    v_mov_b32 v66, 0
    v_mov_b32 v67, 0
    v_mov_b32 v68, 0
    v_mov_b32 v69, 0
    v_mov_b32 v70, 0
    v_mov_b32 v71, 0
    v_mov_b32 v72, 0
    v_mov_b32 v73, 0
    v_mov_b32 v74, 0
    v_mov_b32 v75, 0
    v_mov_b32 v76, 0
    v_mov_b32 v77, 0
    v_mov_b32 v78, 0
    v_mov_b32 v79, 0
    s_barrier
    v_add_u32 v134, s36, v133
    ds_read_b128 v[116:119], v134 offset:0
    v_xor_b32 v135, 64, v134
    ds_read_b128 v[120:123], v134 offset:512
    v_add_u32 v132, s35, v7
    ds_read_b128 v[80:83], v132 offset:0
    s_add_u32 s35, s35, 9216
    ds_read_b128 v[84:87], v132 offset:1024
    s_cmp_eq_u32 s35, 82944
    s_cselect_b32 s35, 0, s35
    ds_read_b128 v[88:91], v132 offset:2048
    s_add_u32 s36, s36, 16384
    ds_read_b128 v[92:95], v132 offset:3072
    s_and_b32 s36, s36, 65535
    ds_read_b128 v[96:99], v132 offset:4096
    ds_read_b128 v[100:103], v132 offset:5120
recurrent_scan__ssm_conv_h3__mixer_gmlp__prompt_kernel_loop222:
    s_waitcnt lgkmcnt(4)
    v_mfma_f32_16x16x32_bf16 v[8:11], v[80:83], v[116:119], v[8:11]
    ds_read_b128 v[104:107], v132 offset:6144
    v_mfma_f32_16x16x32_bf16 v[12:15], v[80:83], v[120:123], v[12:15]
    v_mfma_f32_16x16x32_bf16 v[16:19], v[84:87], v[116:119], v[16:19]
    ds_read_b128 v[108:111], v132 offset:7168
    v_mfma_f32_16x16x32_bf16 v[20:23], v[84:87], v[120:123], v[20:23]
    s_waitcnt lgkmcnt(4)
    v_mfma_f32_16x16x32_bf16 v[24:27], v[88:91], v[116:119], v[24:27]
    ds_read_b128 v[112:115], v132 offset:8192
    v_mfma_f32_16x16x32_bf16 v[28:31], v[88:91], v[120:123], v[28:31]
    v_mfma_f32_16x16x32_bf16 v[32:35], v[92:95], v[116:119], v[32:35]
    ds_read_b128 v[124:127], v135 offset:0
    v_mfma_f32_16x16x32_bf16 v[36:39], v[92:95], v[120:123], v[36:39]
    ds_read_b128 v[128:131], v135 offset:512
    s_waitcnt lgkmcnt(5)
    v_mfma_f32_16x16x32_bf16 v[40:43], v[96:99], v[116:119], v[40:43]
    v_add_u32 v132, s35, v7
    ds_read_b128 v[80:83], v132 offset:0
    v_mfma_f32_16x16x32_bf16 v[44:47], v[96:99], v[120:123], v[44:47]
    s_add_u32 s35, s35, 9216
    ds_read_b128 v[84:87], v132 offset:1024
    v_mfma_f32_16x16x32_bf16 v[48:51], v[100:103], v[116:119], v[48:51]
    s_cmp_eq_u32 s35, 82944
    s_cselect_b32 s35, 0, s35
    ds_read_b128 v[88:91], v132 offset:2048
    v_mfma_f32_16x16x32_bf16 v[52:55], v[100:103], v[120:123], v[52:55]
    s_waitcnt lgkmcnt(6)
    v_mfma_f32_16x16x32_bf16 v[56:59], v[104:107], v[116:119], v[56:59]
    ds_read_b128 v[92:95], v132 offset:3072
    v_mfma_f32_16x16x32_bf16 v[60:63], v[104:107], v[120:123], v[60:63]
    v_mfma_f32_16x16x32_bf16 v[64:67], v[108:111], v[116:119], v[64:67]
    ds_read_b128 v[96:99], v132 offset:4096
    v_mfma_f32_16x16x32_bf16 v[68:71], v[108:111], v[120:123], v[68:71]
    s_waitcnt lgkmcnt(7)
    v_mfma_f32_16x16x32_bf16 v[72:75], v[112:115], v[116:119], v[72:75]
    ds_read_b128 v[100:103], v132 offset:5120
    v_mfma_f32_16x16x32_bf16 v[76:79], v[112:115], v[120:123], v[76:79]
    s_waitcnt lgkmcnt(4)
    v_mfma_f32_16x16x32_bf16 v[8:11], v[80:83], v[124:127], v[8:11]
    ds_read_b128 v[104:107], v132 offset:6144
    v_mfma_f32_16x16x32_bf16 v[12:15], v[80:83], v[128:131], v[12:15]
    v_mfma_f32_16x16x32_bf16 v[16:19], v[84:87], v[124:127], v[16:19]
    ds_read_b128 v[108:111], v132 offset:7168
    v_mfma_f32_16x16x32_bf16 v[20:23], v[84:87], v[128:131], v[20:23]
    s_waitcnt lgkmcnt(4)
    v_mfma_f32_16x16x32_bf16 v[24:27], v[88:91], v[124:127], v[24:27]
    ds_read_b128 v[112:115], v132 offset:8192
    v_mfma_f32_16x16x32_bf16 v[28:31], v[88:91], v[128:131], v[28:31]
    v_mfma_f32_16x16x32_bf16 v[32:35], v[92:95], v[124:127], v[32:35]
    s_waitcnt vmcnt(0)
    s_barrier
    v_add_u32 v134, s36, v133
    ds_read_b128 v[116:119], v134 offset:0
    v_mfma_f32_16x16x32_bf16 v[36:39], v[92:95], v[128:131], v[36:39]
    v_xor_b32 v135, 64, v134
    ds_read_b128 v[120:123], v134 offset:512
    s_waitcnt lgkmcnt(5)
    v_mfma_f32_16x16x32_bf16 v[40:43], v[96:99], v[124:127], v[40:43]
    v_add_u32 v132, s35, v7
    ds_read_b128 v[80:83], v132 offset:0
    v_mfma_f32_16x16x32_bf16 v[44:47], v[96:99], v[128:131], v[44:47]
    s_add_u32 s35, s35, 9216
    ds_read_b128 v[84:87], v132 offset:1024
    v_mfma_f32_16x16x32_bf16 v[48:51], v[100:103], v[124:127], v[48:51]
    s_cmp_eq_u32 s35, 82944
    s_cselect_b32 s35, 0, s35
    ds_read_b128 v[88:91], v132 offset:2048
    v_mfma_f32_16x16x32_bf16 v[52:55], v[100:103], v[128:131], v[52:55]
    s_waitcnt lgkmcnt(6)
    v_mfma_f32_16x16x32_bf16 v[56:59], v[104:107], v[124:127], v[56:59]
    s_add_u32 s36, s36, 16384
    ds_read_b128 v[92:95], v132 offset:3072
    v_mfma_f32_16x16x32_bf16 v[60:63], v[104:107], v[128:131], v[60:63]
    v_mfma_f32_16x16x32_bf16 v[64:67], v[108:111], v[124:127], v[64:67]
    s_and_b32 s36, s36, 65535
    ds_read_b128 v[96:99], v132 offset:4096
    v_mfma_f32_16x16x32_bf16 v[68:71], v[108:111], v[128:131], v[68:71]
    s_waitcnt lgkmcnt(7)
    v_mfma_f32_16x16x32_bf16 v[72:75], v[112:115], v[124:127], v[72:75]
    ds_read_b128 v[100:103], v132 offset:5120
    v_mfma_f32_16x16x32_bf16 v[76:79], v[112:115], v[128:131], v[76:79]
    s_add_u32 s33, s33, 1
    s_cmp_lt_u32 s33, 32
    s_cbranch_scc1 recurrent_scan__ssm_conv_h3__mixer_gmlp__prompt_kernel_loop222
    s_lshl_b32 s34, s30, 13
    s_add_u32 s34, s34, 116736
    v_add_u32 v2, s34, v7
    s_waitcnt lgkmcnt(0)
    s_barrier
    ds_write_b128 v2, v[8:11] offset:0
    ds_write_b128 v2, v[12:15] offset:1024
    ds_write_b128 v2, v[16:19] offset:2048
    ds_write_b128 v2, v[20:23] offset:3072
    ds_write_b128 v2, v[24:27] offset:4096
    ds_write_b128 v2, v[28:31] offset:5120
    ds_write_b128 v2, v[32:35] offset:6144
    ds_write_b128 v2, v[36:39] offset:7168
    s_mul_i32 s34, s30, 5120
    s_add_u32 s34, s34, 95232
    v_add_u32 v2, s34, v7
    s_waitcnt lgkmcnt(0)
    s_barrier
    ds_read_b128 v[236:239], v2 offset:0
    ds_read_b128 v[240:243], v2 offset:1024
    ds_read_b128 v[244:247], v2 offset:2048
    ds_read_b128 v[248:251], v2 offset:3072
    ds_read_b128 v[252:255], v2 offset:4096
    s_waitcnt lgkmcnt(0)
    s_waitcnt vmcnt(0)
    v_lshlrev_b32 v96, 16, v140
    v_lshlrev_b32 v97, 16, v140
    v_lshlrev_b32 v98, 16, v141
    v_lshlrev_b32 v99, 16, v141
    v_pk_add_f32 v[40:41], v[40:41], v[96:97]
    v_lshlrev_b32 v80, 16, v236
    v_and_b32 v81, 0xffff0000, v236
    v_pk_add_f32 v[42:43], v[42:43], v[96:97]
    v_lshlrev_b32 v82, 16, v237
    v_and_b32 v83, 0xffff0000, v237
    v_pk_mul_f32 v[40:41], v[40:41], v[80:81]
    v_pk_mul_f32 v[42:43], v[42:43], v[82:83]
    v_cvt_pk_bf16_f32 v236, v40, v41
    v_cvt_pk_bf16_f32 v237, v42, v43
    v_pk_add_f32 v[48:49], v[48:49], v[96:97]
    v_lshlrev_b32 v88, 16, v238
    v_and_b32 v89, 0xffff0000, v238
    v_pk_add_f32 v[50:51], v[50:51], v[96:97]
    v_lshlrev_b32 v90, 16, v239
    v_and_b32 v91, 0xffff0000, v239
    v_pk_mul_f32 v[48:49], v[48:49], v[88:89]
    v_pk_mul_f32 v[50:51], v[50:51], v[90:91]
    v_cvt_pk_bf16_f32 v238, v48, v49
    v_cvt_pk_bf16_f32 v239, v50, v51
    buffer_store_dwordx4 v[236:239], v136, s[20:23], 0 offen offset:0 sc1
    v_pk_add_f32 v[56:57], v[56:57], v[96:97]
    v_lshlrev_b32 v80, 16, v240
    v_and_b32 v81, 0xffff0000, v240
    v_pk_add_f32 v[58:59], v[58:59], v[96:97]
    v_lshlrev_b32 v82, 16, v241
    v_and_b32 v83, 0xffff0000, v241
    v_pk_mul_f32 v[56:57], v[56:57], v[80:81]
    v_pk_mul_f32 v[58:59], v[58:59], v[82:83]
    v_cvt_pk_bf16_f32 v240, v56, v57
    v_cvt_pk_bf16_f32 v241, v58, v59
    v_pk_add_f32 v[64:65], v[64:65], v[96:97]
    v_lshlrev_b32 v88, 16, v242
    v_and_b32 v89, 0xffff0000, v242
    v_pk_add_f32 v[66:67], v[66:67], v[96:97]
    v_lshlrev_b32 v90, 16, v243
    v_and_b32 v91, 0xffff0000, v243
    v_pk_mul_f32 v[64:65], v[64:65], v[88:89]
    v_pk_mul_f32 v[66:67], v[66:67], v[90:91]
    v_cvt_pk_bf16_f32 v242, v64, v65
    v_cvt_pk_bf16_f32 v243, v66, v67
    buffer_store_dwordx4 v[240:243], v136, s[20:23], 0 offen offset:1024 sc1
    v_pk_add_f32 v[72:73], v[72:73], v[96:97]
    v_lshlrev_b32 v80, 16, v252
    v_and_b32 v81, 0xffff0000, v252
    v_pk_add_f32 v[74:75], v[74:75], v[96:97]
    v_lshlrev_b32 v82, 16, v253
    v_and_b32 v83, 0xffff0000, v253
    v_pk_mul_f32 v[72:73], v[72:73], v[80:81]
    v_pk_mul_f32 v[74:75], v[74:75], v[82:83]
    v_cvt_pk_bf16_f32 v252, v72, v73
    v_cvt_pk_bf16_f32 v253, v74, v75
    buffer_store_dwordx2 v[252:253], v137, s[20:23], 0 offen sc1
    v_pk_add_f32 v[44:45], v[44:45], v[98:99]
    v_lshlrev_b32 v80, 16, v244
    v_and_b32 v81, 0xffff0000, v244
    v_pk_add_f32 v[46:47], v[46:47], v[98:99]
    v_lshlrev_b32 v82, 16, v245
    v_and_b32 v83, 0xffff0000, v245
    v_pk_mul_f32 v[44:45], v[44:45], v[80:81]
    v_pk_mul_f32 v[46:47], v[46:47], v[82:83]
    v_cvt_pk_bf16_f32 v244, v44, v45
    v_cvt_pk_bf16_f32 v245, v46, v47
    v_pk_add_f32 v[52:53], v[52:53], v[98:99]
    v_lshlrev_b32 v88, 16, v246
    v_and_b32 v89, 0xffff0000, v246
    v_pk_add_f32 v[54:55], v[54:55], v[98:99]
    v_lshlrev_b32 v90, 16, v247
    v_and_b32 v91, 0xffff0000, v247
    v_pk_mul_f32 v[52:53], v[52:53], v[88:89]
    v_pk_mul_f32 v[54:55], v[54:55], v[90:91]
    v_cvt_pk_bf16_f32 v246, v52, v53
    v_cvt_pk_bf16_f32 v247, v54, v55
    buffer_store_dwordx4 v[244:247], v136, s[20:23], s65 offen offset:0 sc1
    v_pk_add_f32 v[60:61], v[60:61], v[98:99]
    v_lshlrev_b32 v80, 16, v248
    v_and_b32 v81, 0xffff0000, v248
    v_pk_add_f32 v[62:63], v[62:63], v[98:99]
    v_lshlrev_b32 v82, 16, v249
    v_and_b32 v83, 0xffff0000, v249
    v_pk_mul_f32 v[60:61], v[60:61], v[80:81]
    v_pk_mul_f32 v[62:63], v[62:63], v[82:83]
    v_cvt_pk_bf16_f32 v248, v60, v61
    v_cvt_pk_bf16_f32 v249, v62, v63
    v_pk_add_f32 v[68:69], v[68:69], v[98:99]
    v_lshlrev_b32 v88, 16, v250
    v_and_b32 v89, 0xffff0000, v250
    v_pk_add_f32 v[70:71], v[70:71], v[98:99]
    v_lshlrev_b32 v90, 16, v251
    v_and_b32 v91, 0xffff0000, v251
    v_pk_mul_f32 v[68:69], v[68:69], v[88:89]
    v_pk_mul_f32 v[70:71], v[70:71], v[90:91]
    v_cvt_pk_bf16_f32 v250, v68, v69
    v_cvt_pk_bf16_f32 v251, v70, v71
    buffer_store_dwordx4 v[248:251], v136, s[20:23], s65 offen offset:1024 sc1
    v_pk_add_f32 v[76:77], v[76:77], v[98:99]
    v_lshlrev_b32 v80, 16, v254
    v_and_b32 v81, 0xffff0000, v254
    v_pk_add_f32 v[78:79], v[78:79], v[98:99]
    v_lshlrev_b32 v82, 16, v255
    v_and_b32 v83, 0xffff0000, v255
    v_pk_mul_f32 v[76:77], v[76:77], v[80:81]
    v_pk_mul_f32 v[78:79], v[78:79], v[82:83]
    v_cvt_pk_bf16_f32 v254, v76, v77
    v_cvt_pk_bf16_f32 v255, v78, v79
    buffer_store_dwordx2 v[254:255], v137, s[20:23], s65 offen sc1
    s_barrier
    s_branch recurrent_scan__ssm_conv_h3__mixer_gmlp__prompt_kernel_epi221
recurrent_scan__ssm_conv_h3__mixer_gmlp__prompt_kernel_ld220:
    s_add_u32 s12, s42, 16777216
    s_addc_u32 s13, s43, 0
    s_mov_b32 s14, 9437184
    s_mov_b32 s15, 0x20000
    s_load_dwordx2 s[62:63], s[0:1], 80
    s_load_dwordx2 s[66:67], s[0:1], 32
    s_mul_i32 s34, s32, 589824
    v_add_u32 v8, s34, v7
    s_mov_b32 s57, s2
    s_waitcnt lgkmcnt(0)
    s_mov_b32 s8, s62
    s_mov_b32 s9, s63
    s_mov_b32 s10, 2654208
    s_mov_b32 s11, 0x20000
    s_add_u32 s44, s42, 62914560
    s_addc_u32 s45, s43, 0
    s_mov_b32 s46, 2654208
    s_mov_b32 s47, 0x20000
    s_cmp_lt_u32 s2, 216
    s_cselect_b32 s10, s10, 0
    s_cselect_b32 s46, s46, 0
    v_lshlrev_b32 v17, 2, v1
    v_add_u32 v17, s59, v17
    v_mov_b32 v2, 2146435072
    v_cmp_gt_u32 vcc, 16, v1
    s_nop 1
    v_cndmask_b32 v17, v2, v17, vcc
    s_mov_b32 s55, 0
    s_add_u32 s4, s39, 1
    s_and_b32 s4, s4, 15
    s_cmp_ge_u32 s30, 2
    s_cbranch_scc1 recurrent_scan__ssm_conv_h3__mixer_gmlp__prompt_kernel_wload223
    s_lshl_b32 s38, s39, 2
    s_add_u32 s38, s38, s30
    s_add_u32 s38, s38, 8
    s_and_b32 s38, s38, 63
    s_add_u32 s35, s30, 3
    s_mul_i32 s35, s35, 9216
    s_barrier
recurrent_scan__ssm_conv_h3__mixer_gmlp__prompt_kernel_nb25:
    s_bitcmp1_b32 s55, s4
    s_cbranch_scc1 recurrent_scan__ssm_conv_h3__mixer_gmlp__prompt_kernel_nbo26
    buffer_load_dword v2, v17, s[48:51], 0 offen sc1
    s_waitcnt vmcnt(0)
    v_cmp_ne_u32 vcc, 0, v2
    s_mov_b32 s55, vcc_lo
    s_branch recurrent_scan__ssm_conv_h3__mixer_gmlp__prompt_kernel_nb25
recurrent_scan__ssm_conv_h3__mixer_gmlp__prompt_kernel_nbo26:
    s_lshl_b32 s37, s4, 2
    s_add_u32 s37, s37, s30
    s_mul_i32 s37, s37, 9216
    s_sub_u32 s58, s30, 1
    s_cmp_eq_u32 s30, 0
    s_cselect_b32 s58, 8, s58
    s_mul_i32 s58, s58, 9216
    s_add_u32 m0, s58, 0
    s_add_u32 s52, s37, 0
    buffer_load_dwordx4 v8, s[12:15], s52 offen offset:0 sc1 lds
    buffer_load_dwordx4 v8, s[12:15], s52 offen offset:1024 sc1 lds
    buffer_load_dwordx4 v8, s[12:15], s52 offen offset:2048 sc1 lds
    buffer_load_dwordx4 v8, s[12:15], s52 offen offset:3072 sc1 lds
    s_add_u32 m0, s58, 4096
    s_add_u32 s52, s37, 4096
    buffer_load_dwordx4 v8, s[12:15], s52 offen offset:0 sc1 lds
    buffer_load_dwordx4 v8, s[12:15], s52 offen offset:1024 sc1 lds
    buffer_load_dwordx4 v8, s[12:15], s52 offen offset:2048 sc1 lds
    buffer_load_dwordx4 v8, s[12:15], s52 offen offset:3072 sc1 lds
    s_add_u32 m0, s58, 8192
    s_add_u32 s52, s37, 8192
    buffer_load_dwordx4 v8, s[12:15], s52 offen offset:0 sc1 lds
    s_barrier
    s_lshr_b32 s4, s38, 2
recurrent_scan__ssm_conv_h3__mixer_gmlp__prompt_kernel_nb27:
    s_bitcmp1_b32 s55, s4
    s_cbranch_scc1 recurrent_scan__ssm_conv_h3__mixer_gmlp__prompt_kernel_nbo28
    buffer_load_dword v2, v17, s[48:51], 0 offen sc1
    s_waitcnt vmcnt(0)
    v_cmp_ne_u32 vcc, 0, v2
    s_mov_b32 s55, vcc_lo
    s_branch recurrent_scan__ssm_conv_h3__mixer_gmlp__prompt_kernel_nb27
recurrent_scan__ssm_conv_h3__mixer_gmlp__prompt_kernel_nbo28:
    s_mul_i32 s37, s38, 9216
    s_add_u32 m0, s35, 0
    s_add_u32 s52, s37, 0
    buffer_load_dwordx4 v8, s[12:15], s52 offen offset:0 sc1 lds
    buffer_load_dwordx4 v8, s[12:15], s52 offen offset:1024 sc1 lds
    buffer_load_dwordx4 v8, s[12:15], s52 offen offset:2048 sc1 lds
    buffer_load_dwordx4 v8, s[12:15], s52 offen offset:3072 sc1 lds
    s_add_u32 m0, s35, 4096
    s_add_u32 s52, s37, 4096
    buffer_load_dwordx4 v8, s[12:15], s52 offen offset:0 sc1 lds
    buffer_load_dwordx4 v8, s[12:15], s52 offen offset:1024 sc1 lds
    buffer_load_dwordx4 v8, s[12:15], s52 offen offset:2048 sc1 lds
    buffer_load_dwordx4 v8, s[12:15], s52 offen offset:3072 sc1 lds
    s_add_u32 m0, s35, 8192
    s_add_u32 s52, s37, 8192
    buffer_load_dwordx4 v8, s[12:15], s52 offen offset:0 sc1 lds
    s_add_u32 s35, s35, 18432
    s_add_u32 s38, s38, 2
    s_and_b32 s38, s38, 63
    s_cmp_ge_u32 s35, 82944
    s_cselect_b32 s34, 82944, 0
    s_sub_u32 s35, s35, s34
    s_waitcnt vmcnt(9)
    s_barrier
    s_lshr_b32 s4, s38, 2
recurrent_scan__ssm_conv_h3__mixer_gmlp__prompt_kernel_nb29:
    s_bitcmp1_b32 s55, s4
    s_cbranch_scc1 recurrent_scan__ssm_conv_h3__mixer_gmlp__prompt_kernel_nbo30
    buffer_load_dword v2, v17, s[48:51], 0 offen sc1
    s_waitcnt vmcnt(0)
    v_cmp_ne_u32 vcc, 0, v2
    s_mov_b32 s55, vcc_lo
    s_branch recurrent_scan__ssm_conv_h3__mixer_gmlp__prompt_kernel_nb29
recurrent_scan__ssm_conv_h3__mixer_gmlp__prompt_kernel_nbo30:
    s_mul_i32 s37, s38, 9216
    s_add_u32 m0, s35, 0
    s_add_u32 s52, s37, 0
    buffer_load_dwordx4 v8, s[12:15], s52 offen offset:0 sc1 lds
    buffer_load_dwordx4 v8, s[12:15], s52 offen offset:1024 sc1 lds
    buffer_load_dwordx4 v8, s[12:15], s52 offen offset:2048 sc1 lds
    buffer_load_dwordx4 v8, s[12:15], s52 offen offset:3072 sc1 lds
    s_add_u32 m0, s35, 4096
    s_add_u32 s52, s37, 4096
    buffer_load_dwordx4 v8, s[12:15], s52 offen offset:0 sc1 lds
    buffer_load_dwordx4 v8, s[12:15], s52 offen offset:1024 sc1 lds
    buffer_load_dwordx4 v8, s[12:15], s52 offen offset:2048 sc1 lds
    buffer_load_dwordx4 v8, s[12:15], s52 offen offset:3072 sc1 lds
    s_add_u32 m0, s35, 8192
    s_add_u32 s52, s37, 8192
    buffer_load_dwordx4 v8, s[12:15], s52 offen offset:0 sc1 lds
    s_add_u32 s35, s35, 18432
    s_add_u32 s38, s38, 2
    s_and_b32 s38, s38, 63
    s_cmp_ge_u32 s35, 82944
    s_cselect_b32 s34, 82944, 0
    s_sub_u32 s35, s35, s34
    s_barrier
    s_mov_b32 s33, 6
    s_lshr_b32 s4, s38, 2
recurrent_scan__ssm_conv_h3__mixer_gmlp__prompt_kernel_nb31:
    s_bitcmp1_b32 s55, s4
    s_cbranch_scc1 recurrent_scan__ssm_conv_h3__mixer_gmlp__prompt_kernel_nbo32
    buffer_load_dword v2, v17, s[48:51], 0 offen sc1
    s_waitcnt vmcnt(0)
    v_cmp_ne_u32 vcc, 0, v2
    s_mov_b32 s55, vcc_lo
    s_branch recurrent_scan__ssm_conv_h3__mixer_gmlp__prompt_kernel_nb31
recurrent_scan__ssm_conv_h3__mixer_gmlp__prompt_kernel_nbo32:
    s_mul_i32 s37, s38, 9216
    s_add_u32 m0, s35, 0
    s_add_u32 s52, s37, 0
    buffer_load_dwordx4 v8, s[12:15], s52 offen offset:0 sc1 lds
    buffer_load_dwordx4 v8, s[12:15], s52 offen offset:1024 sc1 lds
    buffer_load_dwordx4 v8, s[12:15], s52 offen offset:2048 sc1 lds
    buffer_load_dwordx4 v8, s[12:15], s52 offen offset:3072 sc1 lds
    s_add_u32 m0, s35, 4096
    s_add_u32 s52, s37, 4096
    buffer_load_dwordx4 v8, s[12:15], s52 offen offset:0 sc1 lds
    buffer_load_dwordx4 v8, s[12:15], s52 offen offset:1024 sc1 lds
    buffer_load_dwordx4 v8, s[12:15], s52 offen offset:2048 sc1 lds
    buffer_load_dwordx4 v8, s[12:15], s52 offen offset:3072 sc1 lds
    s_add_u32 m0, s35, 8192
    s_add_u32 s52, s37, 8192
    buffer_load_dwordx4 v8, s[12:15], s52 offen offset:0 sc1 lds
    s_add_u32 s35, s35, 18432
    s_add_u32 s38, s38, 2
    s_and_b32 s38, s38, 63
    s_cmp_ge_u32 s35, 82944
    s_cselect_b32 s34, 82944, 0
    s_sub_u32 s35, s35, s34
    s_add_u32 s33, s33, 1
    s_and_b32 s58, s2, 3
    s_lshl_b32 s58, s58, 3
    s_bfe_u32 s59, s2, 0x30003
    s_add_u32 s59, s59, s58
    s_bfe_u32 s58, s2, 0x10002
    s_lshl_b32 s58, s58, 2
    s_lshr_b32 s60, s2, 6
    s_add_u32 s60, s60, s58
    s_lshl_b32 s59, s59, 2
    s_lshr_b32 s58, s60, 1
    s_add_u32 s59, s59, s58
    s_lshl_b32 s54, s59, 2
    s_add_u32 s54, s54, s30
    s_add_u32 s62, s59, 512
    s_cmp_lt_u32 s59, 64
    s_cselect_b32 s62, s62, 9999
    s_cmp_eq_u32 s30, 0
    s_cselect_b32 s62, s62, 9999
    s_bitcmp1_b32 s60, 0
    s_cselect_b32 s54, s54, s62
    s_lshl_b32 s58, s54, 12
    s_mov_b32 s3, s58
    s_mov_b32 s24, s66
    s_mov_b32 s25, s67
    s_mov_b32 s26, 2359296
    s_mov_b32 s27, 0x20000
    s_waitcnt vmcnt(18)
    s_barrier
    s_lshr_b32 s4, s38, 2
recurrent_scan__ssm_conv_h3__mixer_gmlp__prompt_kernel_nb33:
    s_bitcmp1_b32 s55, s4
    s_cbranch_scc1 recurrent_scan__ssm_conv_h3__mixer_gmlp__prompt_kernel_nbo34
    buffer_load_dword v2, v17, s[48:51], 0 offen sc1
    s_waitcnt vmcnt(0)
    v_cmp_ne_u32 vcc, 0, v2
    s_mov_b32 s55, vcc_lo
    s_branch recurrent_scan__ssm_conv_h3__mixer_gmlp__prompt_kernel_nb33
recurrent_scan__ssm_conv_h3__mixer_gmlp__prompt_kernel_nbo34:
    s_mul_i32 s37, s38, 9216
    s_add_u32 m0, s35, 0
    s_add_u32 s52, s37, 0
    buffer_load_dwordx4 v8, s[12:15], s52 offen offset:0 sc1 lds
    buffer_load_dwordx4 v8, s[12:15], s52 offen offset:1024 sc1 lds
    buffer_load_dwordx4 v8, s[12:15], s52 offen offset:2048 sc1 lds
    buffer_load_dwordx4 v8, s[12:15], s52 offen offset:3072 sc1 lds
    s_add_u32 m0, s35, 4096
    s_add_u32 s52, s37, 4096
    buffer_load_dwordx4 v8, s[12:15], s52 offen offset:0 sc1 lds
    buffer_load_dwordx4 v8, s[12:15], s52 offen offset:1024 sc1 lds
    buffer_load_dwordx4 v8, s[12:15], s52 offen offset:2048 sc1 lds
    buffer_load_dwordx4 v8, s[12:15], s52 offen offset:3072 sc1 lds
    s_add_u32 m0, s35, 8192
    s_add_u32 s52, s37, 8192
    buffer_load_dwordx4 v8, s[12:15], s52 offen offset:0 sc1 lds
    s_add_u32 s35, s35, 18432
    s_add_u32 s38, s38, 2
    s_and_b32 s38, s38, 63
    s_cmp_ge_u32 s35, 82944
    s_cselect_b32 s34, 82944, 0
    s_sub_u32 s35, s35, s34
    s_add_u32 s33, s33, 1
    s_waitcnt vmcnt(18)
    s_barrier
recurrent_scan__ssm_conv_h3__mixer_gmlp__prompt_kernel_wo35:
    s_lshr_b32 s4, s38, 2
recurrent_scan__ssm_conv_h3__mixer_gmlp__prompt_kernel_nb36:
    s_bitcmp1_b32 s55, s4
    s_cbranch_scc1 recurrent_scan__ssm_conv_h3__mixer_gmlp__prompt_kernel_nbo37
    buffer_load_dword v2, v17, s[48:51], 0 offen sc1
    s_waitcnt vmcnt(0)
    v_cmp_ne_u32 vcc, 0, v2
    s_mov_b32 s55, vcc_lo
    s_branch recurrent_scan__ssm_conv_h3__mixer_gmlp__prompt_kernel_nb36
recurrent_scan__ssm_conv_h3__mixer_gmlp__prompt_kernel_nbo37:
    s_mul_i32 s37, s38, 9216
    s_add_u32 m0, s35, 0
    s_add_u32 s52, s37, 0
    buffer_load_dwordx4 v8, s[12:15], s52 offen offset:0 sc1 lds
    buffer_load_dwordx4 v8, s[12:15], s52 offen offset:1024 sc1 lds
    buffer_load_dwordx4 v8, s[12:15], s52 offen offset:2048 sc1 lds
    buffer_load_dwordx4 v8, s[12:15], s52 offen offset:3072 sc1 lds
    s_add_u32 m0, s35, 4096
    s_add_u32 s52, s37, 4096
    buffer_load_dwordx4 v8, s[12:15], s52 offen offset:0 sc1 lds
    buffer_load_dwordx4 v8, s[12:15], s52 offen offset:1024 sc1 lds
    buffer_load_dwordx4 v8, s[12:15], s52 offen offset:2048 sc1 lds
    buffer_load_dwordx4 v8, s[12:15], s52 offen offset:3072 sc1 lds
    s_add_u32 m0, s35, 8192
    s_add_u32 s52, s37, 8192
    buffer_load_dwordx4 v8, s[12:15], s52 offen offset:0 sc1 lds
    s_add_u32 s35, s35, 18432
    s_add_u32 s38, s38, 2
    s_and_b32 s38, s38, 63
    s_cmp_ge_u32 s35, 82944
    s_cselect_b32 s34, 82944, 0
    s_sub_u32 s35, s35, s34
    s_add_u32 s33, s33, 1
    s_mul_i32 s58, s57, 21846
    s_lshr_b32 s58, s58, 16
    s_mul_i32 s59, s58, 3
    s_sub_u32 s59, s57, s59
    s_mul_i32 s60, s58, 7282
    s_lshr_b32 s60, s60, 16
    s_mul_i32 s61, s60, 9
    s_sub_u32 s61, s58, s61
    s_lshr_b32 s62, s61, 2
    s_lshl_b32 s63, s60, 1
    s_add_u32 s62, s62, s63
    s_mul_i32 s62, s62, 144
    s_and_b32 s64, s61, 3
    s_lshl_b32 s64, s64, 5
    s_add_u32 s62, s62, s64
    s_mul_i32 s63, s63, 144
    s_add_u32 s63, s63, 128
    s_cmp_eq_u32 s61, 8
    s_cselect_b32 s62, s63, s62
    s_cselect_b32 s63, 144, 16
    s_mul_i32 s64, s59, 384
    s_lshr_b32 s54, s30, 1
    s_mul_i32 s54, s54, s63
    s_add_u32 s62, s62, s54
    s_and_b32 s54, s30, 1
    s_lshl_b32 s54, s54, 3
    s_add_u32 s62, s62, s54
    s_mul_i32 s62, s62, 1152
    s_add_u32 s62, s62, s64
    v_add_u32 v40, 0, v1
    buffer_load_dwordx4 v[116:119], v7, s[24:27], s3 offen offset:0
    buffer_load_dwordx4 v[120:123], v7, s[24:27], s3 offen offset:1024
    s_waitcnt vmcnt(18)
    s_barrier
    s_lshr_b32 s4, s38, 2
recurrent_scan__ssm_conv_h3__mixer_gmlp__prompt_kernel_nb38:
    s_bitcmp1_b32 s55, s4
    s_cbranch_scc1 recurrent_scan__ssm_conv_h3__mixer_gmlp__prompt_kernel_nbo39
    buffer_load_dword v2, v17, s[48:51], 0 offen sc1
    s_waitcnt vmcnt(0)
    v_cmp_ne_u32 vcc, 0, v2
    s_mov_b32 s55, vcc_lo
    s_branch recurrent_scan__ssm_conv_h3__mixer_gmlp__prompt_kernel_nb38
recurrent_scan__ssm_conv_h3__mixer_gmlp__prompt_kernel_nbo39:
    s_mul_i32 s37, s38, 9216
    s_add_u32 m0, s35, 0
    s_add_u32 s52, s37, 0
    buffer_load_dwordx4 v8, s[12:15], s52 offen offset:0 sc1 lds
    buffer_load_dwordx4 v8, s[12:15], s52 offen offset:1024 sc1 lds
    buffer_load_dwordx4 v8, s[12:15], s52 offen offset:2048 sc1 lds
    buffer_load_dwordx4 v8, s[12:15], s52 offen offset:3072 sc1 lds
    s_add_u32 m0, s35, 4096
    s_add_u32 s52, s37, 4096
    buffer_load_dwordx4 v8, s[12:15], s52 offen offset:0 sc1 lds
    buffer_load_dwordx4 v8, s[12:15], s52 offen offset:1024 sc1 lds
    buffer_load_dwordx4 v8, s[12:15], s52 offen offset:2048 sc1 lds
    buffer_load_dwordx4 v8, s[12:15], s52 offen offset:3072 sc1 lds
    s_add_u32 m0, s35, 8192
    s_add_u32 s52, s37, 8192
    buffer_load_dwordx4 v8, s[12:15], s52 offen offset:0 sc1 lds
    s_add_u32 s35, s35, 18432
    s_add_u32 s38, s38, 2
    s_and_b32 s38, s38, 63
    s_cmp_ge_u32 s35, 82944
    s_cselect_b32 s34, 82944, 0
    s_sub_u32 s35, s35, s34
    s_add_u32 s33, s33, 1
    v_mul_u32_u24 v41, 2731, v40
    v_lshrrev_b32 v41, 16, v41
    v_mul_u32_u24 v42, 24, v41
    v_sub_u32 v42, v40, v42
    v_mul_u32_u24 v41, 1152, v41
    v_lshl_add_u32 v41, v42, 4, v41
    buffer_load_dwordx4 v[44:47], v41, s[8:11], s62 offen
    v_add_u32 v40, 64, v1
    v_mul_u32_u24 v41, 2731, v40
    v_lshrrev_b32 v41, 16, v41
    v_mul_u32_u24 v42, 24, v41
    v_sub_u32 v42, v40, v42
    v_mul_u32_u24 v41, 1152, v41
    v_lshl_add_u32 v41, v42, 4, v41
    buffer_load_dwordx4 v[48:51], v41, s[8:11], s62 offen
    v_add_u32 v40, 128, v1
    v_mul_u32_u24 v41, 2731, v40
    v_lshrrev_b32 v41, 16, v41
    v_mul_u32_u24 v42, 24, v41
    v_sub_u32 v42, v40, v42
    v_mul_u32_u24 v41, 1152, v41
    v_lshl_add_u32 v41, v42, 4, v41
    buffer_load_dwordx4 v[52:55], v41, s[8:11], s62 offen
    buffer_load_dwordx4 v[124:127], v7, s[24:27], s3 offen offset:2048
    buffer_load_dwordx4 v[128:131], v7, s[24:27], s3 offen offset:3072
    s_waitcnt vmcnt(18)
    s_barrier
    s_lshr_b32 s4, s38, 2
recurrent_scan__ssm_conv_h3__mixer_gmlp__prompt_kernel_nb40:
    s_bitcmp1_b32 s55, s4
    s_cbranch_scc1 recurrent_scan__ssm_conv_h3__mixer_gmlp__prompt_kernel_nbo41
    buffer_load_dword v2, v17, s[48:51], 0 offen sc1
    s_waitcnt vmcnt(0)
    v_cmp_ne_u32 vcc, 0, v2
    s_mov_b32 s55, vcc_lo
    s_branch recurrent_scan__ssm_conv_h3__mixer_gmlp__prompt_kernel_nb40
recurrent_scan__ssm_conv_h3__mixer_gmlp__prompt_kernel_nbo41:
    s_mul_i32 s37, s38, 9216
    s_add_u32 m0, s35, 0
    s_add_u32 s52, s37, 0
    buffer_load_dwordx4 v8, s[12:15], s52 offen offset:0 sc1 lds
    buffer_load_dwordx4 v8, s[12:15], s52 offen offset:1024 sc1 lds
    buffer_load_dwordx4 v8, s[12:15], s52 offen offset:2048 sc1 lds
    buffer_load_dwordx4 v8, s[12:15], s52 offen offset:3072 sc1 lds
    s_add_u32 m0, s35, 4096
    s_add_u32 s52, s37, 4096
    buffer_load_dwordx4 v8, s[12:15], s52 offen offset:0 sc1 lds
    buffer_load_dwordx4 v8, s[12:15], s52 offen offset:1024 sc1 lds
    buffer_load_dwordx4 v8, s[12:15], s52 offen offset:2048 sc1 lds
    buffer_load_dwordx4 v8, s[12:15], s52 offen offset:3072 sc1 lds
    s_add_u32 m0, s35, 8192
    s_add_u32 s52, s37, 8192
    buffer_load_dwordx4 v8, s[12:15], s52 offen offset:0 sc1 lds
    s_add_u32 s35, s35, 18432
    s_add_u32 s38, s38, 2
    s_and_b32 s38, s38, 63
    s_cmp_ge_u32 s35, 82944
    s_cselect_b32 s34, 82944, 0
    s_sub_u32 s35, s35, s34
    s_add_u32 s33, s33, 1
    buffer_load_dwordx4 v[132:135], v7, s[24:27], s3 offen offset:2
    buffer_load_dwordx4 v[144:147], v7, s[24:27], s3 offen offset:1026
    s_waitcnt vmcnt(27)
    s_barrier
    s_lshr_b32 s4, s38, 2
recurrent_scan__ssm_conv_h3__mixer_gmlp__prompt_kernel_nb42:
    s_bitcmp1_b32 s55, s4
    s_cbranch_scc1 recurrent_scan__ssm_conv_h3__mixer_gmlp__prompt_kernel_nbo43
    buffer_load_dword v2, v17, s[48:51], 0 offen sc1
    s_waitcnt vmcnt(0)
    v_cmp_ne_u32 vcc, 0, v2
    s_mov_b32 s55, vcc_lo
    s_branch recurrent_scan__ssm_conv_h3__mixer_gmlp__prompt_kernel_nb42
recurrent_scan__ssm_conv_h3__mixer_gmlp__prompt_kernel_nbo43:
    s_mul_i32 s37, s38, 9216
    s_add_u32 m0, s35, 0
    s_add_u32 s52, s37, 0
    buffer_load_dwordx4 v8, s[12:15], s52 offen offset:0 sc1 lds
    buffer_load_dwordx4 v8, s[12:15], s52 offen offset:1024 sc1 lds
    buffer_load_dwordx4 v8, s[12:15], s52 offen offset:2048 sc1 lds
    buffer_load_dwordx4 v8, s[12:15], s52 offen offset:3072 sc1 lds
    s_add_u32 m0, s35, 4096
    s_add_u32 s52, s37, 4096
    buffer_load_dwordx4 v8, s[12:15], s52 offen offset:0 sc1 lds
    buffer_load_dwordx4 v8, s[12:15], s52 offen offset:1024 sc1 lds
    buffer_load_dwordx4 v8, s[12:15], s52 offen offset:2048 sc1 lds
    buffer_load_dwordx4 v8, s[12:15], s52 offen offset:3072 sc1 lds
    s_add_u32 m0, s35, 8192
    s_add_u32 s52, s37, 8192
    buffer_load_dwordx4 v8, s[12:15], s52 offen offset:0 sc1 lds
    s_add_u32 s35, s35, 18432
    s_add_u32 s38, s38, 2
    s_and_b32 s38, s38, 63
    s_cmp_ge_u32 s35, 82944
    s_cselect_b32 s34, 82944, 0
    s_sub_u32 s35, s35, s34
    s_add_u32 s33, s33, 1
    s_waitcnt vmcnt(22)
    s_mul_i32 s54, s30, 3072
    s_add_u32 s54, s54, 148480
    v_lshlrev_b32 v40, 4, v1
    v_add_u32 v40, s54, v40
    ds_write_b128 v40, v[44:47] offset:0
    ds_write_b128 v40, v[48:51] offset:1024
    ds_write_b128 v40, v[52:55] offset:2048
    s_waitcnt lgkmcnt(0)
    buffer_load_dwordx4 v[148:151], v7, s[24:27], s3 offen offset:2050
    buffer_load_dwordx4 v[152:155], v7, s[24:27], s3 offen offset:3074
    s_barrier
    s_lshr_b32 s4, s38, 2
recurrent_scan__ssm_conv_h3__mixer_gmlp__prompt_kernel_nb44:
    s_bitcmp1_b32 s55, s4
    s_cbranch_scc1 recurrent_scan__ssm_conv_h3__mixer_gmlp__prompt_kernel_nbo45
    buffer_load_dword v2, v17, s[48:51], 0 offen sc1
    s_waitcnt vmcnt(0)
    v_cmp_ne_u32 vcc, 0, v2
    s_mov_b32 s55, vcc_lo
    s_branch recurrent_scan__ssm_conv_h3__mixer_gmlp__prompt_kernel_nb44
recurrent_scan__ssm_conv_h3__mixer_gmlp__prompt_kernel_nbo45:
    s_mul_i32 s37, s38, 9216
    s_add_u32 m0, s35, 0
    s_add_u32 s52, s37, 0
    buffer_load_dwordx4 v8, s[12:15], s52 offen offset:0 sc1 lds
    buffer_load_dwordx4 v8, s[12:15], s52 offen offset:1024 sc1 lds
    buffer_load_dwordx4 v8, s[12:15], s52 offen offset:2048 sc1 lds
    buffer_load_dwordx4 v8, s[12:15], s52 offen offset:3072 sc1 lds
    s_add_u32 m0, s35, 4096
    s_add_u32 s52, s37, 4096
    buffer_load_dwordx4 v8, s[12:15], s52 offen offset:0 sc1 lds
    buffer_load_dwordx4 v8, s[12:15], s52 offen offset:1024 sc1 lds
    buffer_load_dwordx4 v8, s[12:15], s52 offen offset:2048 sc1 lds
    buffer_load_dwordx4 v8, s[12:15], s52 offen offset:3072 sc1 lds
    s_add_u32 m0, s35, 8192
    s_add_u32 s52, s37, 8192
    buffer_load_dwordx4 v8, s[12:15], s52 offen offset:0 sc1 lds
    s_add_u32 s35, s35, 18432
    s_add_u32 s38, s38, 2
    s_and_b32 s38, s38, 63
    s_cmp_ge_u32 s35, 82944
    s_cselect_b32 s34, 82944, 0
    s_sub_u32 s35, s35, s34
    s_add_u32 s33, s33, 1
    v_lshrrev_b32 v40, 2, v5
    v_lshl_add_u32 v40, v6, 2, v40
    v_mul_u32_u24 v40, 384, v40
    v_and_b32 v41, 3, v5
    v_lshl_add_u32 v40, v41, 3, v40
    s_mul_i32 s54, s30, 96
    s_add_u32 s54, s54, 148480
    v_add_u32 v40, s54, v40
    ds_read_b64_tr_b16 v[44:45], v40 offset:0
    ds_read_b64_tr_b16 v[46:47], v40 offset:6144
    ds_read_b64_tr_b16 v[48:49], v40 offset:32
    ds_read_b64_tr_b16 v[50:51], v40 offset:6176
    ds_read_b64_tr_b16 v[52:53], v40 offset:64
    ds_read_b64_tr_b16 v[54:55], v40 offset:6208
    s_mul_i32 s54, s59, 12
    s_mul_i32 s60, s30, 3
    s_add_u32 s54, s54, s60
    s_mul_i32 s54, s54, 72
    s_add_u32 s54, s54, s58
    s_lshl_b32 s60, s54, 10
    s_add_u32 s61, s60, 73728
    s_add_u32 s62, s60, 147456
    v_lshlrev_b32 v42, 4, v1
    s_waitcnt lgkmcnt(0)
    buffer_store_dwordx4 v[44:47], v42, s[44:47], s60 offen sc1
    buffer_store_dwordx4 v[48:51], v42, s[44:47], s61 offen sc1
    buffer_store_dwordx4 v[52:55], v42, s[44:47], s62 offen sc1
    buffer_load_dwordx4 v[156:159], v7, s[24:27], s3 offen offset:4
    buffer_load_dwordx4 v[180:183], v7, s[24:27], s3 offen offset:1028
    s_waitcnt vmcnt(27)
    s_barrier
    s_lshr_b32 s4, s38, 2
recurrent_scan__ssm_conv_h3__mixer_gmlp__prompt_kernel_nb46:
    s_bitcmp1_b32 s55, s4
    s_cbranch_scc1 recurrent_scan__ssm_conv_h3__mixer_gmlp__prompt_kernel_nbo47
    buffer_load_dword v2, v17, s[48:51], 0 offen sc1
    s_waitcnt vmcnt(0)
    v_cmp_ne_u32 vcc, 0, v2
    s_mov_b32 s55, vcc_lo
    s_branch recurrent_scan__ssm_conv_h3__mixer_gmlp__prompt_kernel_nb46
recurrent_scan__ssm_conv_h3__mixer_gmlp__prompt_kernel_nbo47:
    s_mul_i32 s37, s38, 9216
    s_add_u32 m0, s35, 0
    s_add_u32 s52, s37, 0
    buffer_load_dwordx4 v8, s[12:15], s52 offen offset:0 sc1 lds
    buffer_load_dwordx4 v8, s[12:15], s52 offen offset:1024 sc1 lds
    buffer_load_dwordx4 v8, s[12:15], s52 offen offset:2048 sc1 lds
    buffer_load_dwordx4 v8, s[12:15], s52 offen offset:3072 sc1 lds
    s_add_u32 m0, s35, 4096
    s_add_u32 s52, s37, 4096
    buffer_load_dwordx4 v8, s[12:15], s52 offen offset:0 sc1 lds
    buffer_load_dwordx4 v8, s[12:15], s52 offen offset:1024 sc1 lds
    buffer_load_dwordx4 v8, s[12:15], s52 offen offset:2048 sc1 lds
    buffer_load_dwordx4 v8, s[12:15], s52 offen offset:3072 sc1 lds
    s_add_u32 m0, s35, 8192
    s_add_u32 s52, s37, 8192
    buffer_load_dwordx4 v8, s[12:15], s52 offen offset:0 sc1 lds
    s_add_u32 s35, s35, 18432
    s_add_u32 s38, s38, 2
    s_and_b32 s38, s38, 63
    s_cmp_ge_u32 s35, 82944
    s_cselect_b32 s34, 82944, 0
    s_sub_u32 s35, s35, s34
    s_add_u32 s33, s33, 1
    buffer_load_dwordx4 v[184:187], v7, s[24:27], s3 offen offset:2052
    buffer_load_dwordx4 v[188:191], v7, s[24:27], s3 offen offset:3076
    s_waitcnt vmcnt(27)
    s_barrier
    s_lshr_b32 s4, s38, 2
recurrent_scan__ssm_conv_h3__mixer_gmlp__prompt_kernel_nb48:
    s_bitcmp1_b32 s55, s4
    s_cbranch_scc1 recurrent_scan__ssm_conv_h3__mixer_gmlp__prompt_kernel_nbo49
    buffer_load_dword v2, v17, s[48:51], 0 offen sc1
    s_waitcnt vmcnt(0)
    v_cmp_ne_u32 vcc, 0, v2
    s_mov_b32 s55, vcc_lo
    s_branch recurrent_scan__ssm_conv_h3__mixer_gmlp__prompt_kernel_nb48
recurrent_scan__ssm_conv_h3__mixer_gmlp__prompt_kernel_nbo49:
    s_mul_i32 s37, s38, 9216
    s_add_u32 m0, s35, 0
    s_add_u32 s52, s37, 0
    buffer_load_dwordx4 v8, s[12:15], s52 offen offset:0 sc1 lds
    buffer_load_dwordx4 v8, s[12:15], s52 offen offset:1024 sc1 lds
    buffer_load_dwordx4 v8, s[12:15], s52 offen offset:2048 sc1 lds
    buffer_load_dwordx4 v8, s[12:15], s52 offen offset:3072 sc1 lds
    s_add_u32 m0, s35, 4096
    s_add_u32 s52, s37, 4096
    buffer_load_dwordx4 v8, s[12:15], s52 offen offset:0 sc1 lds
    buffer_load_dwordx4 v8, s[12:15], s52 offen offset:1024 sc1 lds
    buffer_load_dwordx4 v8, s[12:15], s52 offen offset:2048 sc1 lds
    buffer_load_dwordx4 v8, s[12:15], s52 offen offset:3072 sc1 lds
    s_add_u32 m0, s35, 8192
    s_add_u32 s52, s37, 8192
    buffer_load_dwordx4 v8, s[12:15], s52 offen offset:0 sc1 lds
    s_add_u32 s35, s35, 18432
    s_add_u32 s38, s38, 2
    s_and_b32 s38, s38, 63
    s_cmp_ge_u32 s35, 82944
    s_cselect_b32 s34, 82944, 0
    s_sub_u32 s35, s35, s34
    s_add_u32 s33, s33, 1
    buffer_load_dwordx4 v[192:195], v7, s[24:27], s3 offen offset:6
    buffer_load_dwordx4 v[196:199], v7, s[24:27], s3 offen offset:1030
    s_waitcnt vmcnt(27)
    s_barrier
    s_lshr_b32 s4, s38, 2
recurrent_scan__ssm_conv_h3__mixer_gmlp__prompt_kernel_nb50:
    s_bitcmp1_b32 s55, s4
    s_cbranch_scc1 recurrent_scan__ssm_conv_h3__mixer_gmlp__prompt_kernel_nbo51
    buffer_load_dword v2, v17, s[48:51], 0 offen sc1
    s_waitcnt vmcnt(0)
    v_cmp_ne_u32 vcc, 0, v2
    s_mov_b32 s55, vcc_lo
    s_branch recurrent_scan__ssm_conv_h3__mixer_gmlp__prompt_kernel_nb50
recurrent_scan__ssm_conv_h3__mixer_gmlp__prompt_kernel_nbo51:
    s_mul_i32 s37, s38, 9216
    s_add_u32 m0, s35, 0
    s_add_u32 s52, s37, 0
    buffer_load_dwordx4 v8, s[12:15], s52 offen offset:0 sc1 lds
    buffer_load_dwordx4 v8, s[12:15], s52 offen offset:1024 sc1 lds
    buffer_load_dwordx4 v8, s[12:15], s52 offen offset:2048 sc1 lds
    buffer_load_dwordx4 v8, s[12:15], s52 offen offset:3072 sc1 lds
    s_add_u32 m0, s35, 4096
    s_add_u32 s52, s37, 4096
    buffer_load_dwordx4 v8, s[12:15], s52 offen offset:0 sc1 lds
    buffer_load_dwordx4 v8, s[12:15], s52 offen offset:1024 sc1 lds
    buffer_load_dwordx4 v8, s[12:15], s52 offen offset:2048 sc1 lds
    buffer_load_dwordx4 v8, s[12:15], s52 offen offset:3072 sc1 lds
    s_add_u32 m0, s35, 8192
    s_add_u32 s52, s37, 8192
    buffer_load_dwordx4 v8, s[12:15], s52 offen offset:0 sc1 lds
    s_add_u32 s35, s35, 18432
    s_add_u32 s38, s38, 2
    s_and_b32 s38, s38, 63
    s_cmp_ge_u32 s35, 82944
    s_cselect_b32 s34, 82944, 0
    s_sub_u32 s35, s35, s34
    s_add_u32 s33, s33, 1
    buffer_load_dwordx4 v[200:203], v7, s[24:27], s3 offen offset:2054
    buffer_load_dwordx4 v[204:207], v7, s[24:27], s3 offen offset:3078
    s_waitcnt vmcnt(24)
    s_barrier
    s_lshr_b32 s4, s38, 2
recurrent_scan__ssm_conv_h3__mixer_gmlp__prompt_kernel_nb52:
    s_bitcmp1_b32 s55, s4
    s_cbranch_scc1 recurrent_scan__ssm_conv_h3__mixer_gmlp__prompt_kernel_nbo53
    buffer_load_dword v2, v17, s[48:51], 0 offen sc1
    s_waitcnt vmcnt(0)
    v_cmp_ne_u32 vcc, 0, v2
    s_mov_b32 s55, vcc_lo
    s_branch recurrent_scan__ssm_conv_h3__mixer_gmlp__prompt_kernel_nb52
recurrent_scan__ssm_conv_h3__mixer_gmlp__prompt_kernel_nbo53:
    s_mul_i32 s37, s38, 9216
    s_add_u32 m0, s35, 0
    s_add_u32 s52, s37, 0
    buffer_load_dwordx4 v8, s[12:15], s52 offen offset:0 sc1 lds
    buffer_load_dwordx4 v8, s[12:15], s52 offen offset:1024 sc1 lds
    buffer_load_dwordx4 v8, s[12:15], s52 offen offset:2048 sc1 lds
    buffer_load_dwordx4 v8, s[12:15], s52 offen offset:3072 sc1 lds
    s_add_u32 m0, s35, 4096
    s_add_u32 s52, s37, 4096
    buffer_load_dwordx4 v8, s[12:15], s52 offen offset:0 sc1 lds
    buffer_load_dwordx4 v8, s[12:15], s52 offen offset:1024 sc1 lds
    buffer_load_dwordx4 v8, s[12:15], s52 offen offset:2048 sc1 lds
    buffer_load_dwordx4 v8, s[12:15], s52 offen offset:3072 sc1 lds
    s_add_u32 m0, s35, 8192
    s_add_u32 s52, s37, 8192
    buffer_load_dwordx4 v8, s[12:15], s52 offen offset:0 sc1 lds
    s_add_u32 s35, s35, 18432
    s_add_u32 s38, s38, 2
    s_and_b32 s38, s38, 63
    s_cmp_ge_u32 s35, 82944
    s_cselect_b32 s34, 82944, 0
    s_sub_u32 s35, s35, s34
    s_add_u32 s33, s33, 1
    s_lshl_b32 s60, s59, 8
    s_add_u32 s60, s60, 1880064
    s_cmp_eq_u32 s30, 0
    s_cselect_b32 s60, s60, 2146435072
    s_cmp_lt_u32 s57, 216
    s_cselect_b32 s60, s60, 2146435072
    v_mov_b32 v2, s60
    v_mov_b32 v3, 1
    s_mov_b64 exec, 1
    buffer_atomic_add v3, v2, s[48:51], 0 offen sc1
    s_mov_b64 exec, -1
    s_waitcnt vmcnt(23)
    s_barrier
    s_lshr_b32 s4, s38, 2
recurrent_scan__ssm_conv_h3__mixer_gmlp__prompt_kernel_nb54:
    s_bitcmp1_b32 s55, s4
    s_cbranch_scc1 recurrent_scan__ssm_conv_h3__mixer_gmlp__prompt_kernel_nbo55
    buffer_load_dword v2, v17, s[48:51], 0 offen sc1
    s_waitcnt vmcnt(0)
    v_cmp_ne_u32 vcc, 0, v2
    s_mov_b32 s55, vcc_lo
    s_branch recurrent_scan__ssm_conv_h3__mixer_gmlp__prompt_kernel_nb54
recurrent_scan__ssm_conv_h3__mixer_gmlp__prompt_kernel_nbo55:
    s_mul_i32 s37, s38, 9216
    s_add_u32 m0, s35, 0
    s_add_u32 s52, s37, 0
    buffer_load_dwordx4 v8, s[12:15], s52 offen offset:0 sc1 lds
    buffer_load_dwordx4 v8, s[12:15], s52 offen offset:1024 sc1 lds
    buffer_load_dwordx4 v8, s[12:15], s52 offen offset:2048 sc1 lds
    buffer_load_dwordx4 v8, s[12:15], s52 offen offset:3072 sc1 lds
    s_add_u32 m0, s35, 4096
    s_add_u32 s52, s37, 4096
    buffer_load_dwordx4 v8, s[12:15], s52 offen offset:0 sc1 lds
    buffer_load_dwordx4 v8, s[12:15], s52 offen offset:1024 sc1 lds
    buffer_load_dwordx4 v8, s[12:15], s52 offen offset:2048 sc1 lds
    buffer_load_dwordx4 v8, s[12:15], s52 offen offset:3072 sc1 lds
    s_add_u32 m0, s35, 8192
    s_add_u32 s52, s37, 8192
    buffer_load_dwordx4 v8, s[12:15], s52 offen offset:0 sc1 lds
    s_add_u32 s35, s35, 18432
    s_add_u32 s38, s38, 2
    s_and_b32 s38, s38, 63
    s_cmp_ge_u32 s35, 82944
    s_cselect_b32 s34, 82944, 0
    s_sub_u32 s35, s35, s34
    s_add_u32 s33, s33, 1
    s_and_b32 s58, s2, 3
    s_lshl_b32 s58, s58, 3
    s_bfe_u32 s59, s2, 0x30003
    s_add_u32 s59, s59, s58
    s_bfe_u32 s58, s2, 0x10002
    s_lshl_b32 s58, s58, 2
    s_lshr_b32 s60, s2, 6
    s_add_u32 s60, s60, s58
    s_lshl_b32 s59, s59, 2
    s_lshr_b32 s58, s60, 1
    s_add_u32 s59, s59, s58
    s_lshl_b32 s54, s59, 2
    s_add_u32 s54, s54, s30
    s_add_u32 s62, s59, 512
    s_cmp_lt_u32 s59, 64
    s_cselect_b32 s62, s62, 9999
    s_cmp_eq_u32 s30, 0
    s_cselect_b32 s62, s62, 9999
    s_bitcmp1_b32 s60, 0
    s_cselect_b32 s54, s54, s62
    s_lshl_b32 s58, s54, 12
    s_min_u32 s61, s54, 575
    s_mul_i32 s61, s61, 911
    s_lshr_b32 s61, s61, 16
    s_lshl_b32 s61, s61, 8
    s_add_u32 s61, s61, 1875968
    s_mov_b32 s8, s66
    s_mov_b32 s9, s67
    s_mov_b32 s10, 2359296
    s_mov_b32 s11, 0x20000
    s_add_u32 s44, s42, 54525952
    s_addc_u32 s45, s43, 0
    s_mov_b32 s46, 2359296
    s_mov_b32 s47, 0x20000
    v_mov_b32 v18, s61
    buffer_load_dword v19, v18, s[48:51], 0 offen sc1
    s_waitcnt vmcnt(22)
    s_barrier
    s_lshr_b32 s4, s38, 2
recurrent_scan__ssm_conv_h3__mixer_gmlp__prompt_kernel_nb56:
    s_bitcmp1_b32 s55, s4
    s_cbranch_scc1 recurrent_scan__ssm_conv_h3__mixer_gmlp__prompt_kernel_nbo57
    buffer_load_dword v2, v17, s[48:51], 0 offen sc1
    s_waitcnt vmcnt(0)
    v_cmp_ne_u32 vcc, 0, v2
    s_mov_b32 s55, vcc_lo
    s_branch recurrent_scan__ssm_conv_h3__mixer_gmlp__prompt_kernel_nb56
recurrent_scan__ssm_conv_h3__mixer_gmlp__prompt_kernel_nbo57:
    s_mul_i32 s37, s38, 9216
    s_add_u32 m0, s35, 0
    s_add_u32 s52, s37, 0
    buffer_load_dwordx4 v8, s[12:15], s52 offen offset:0 sc1 lds
    buffer_load_dwordx4 v8, s[12:15], s52 offen offset:1024 sc1 lds
    buffer_load_dwordx4 v8, s[12:15], s52 offen offset:2048 sc1 lds
    buffer_load_dwordx4 v8, s[12:15], s52 offen offset:3072 sc1 lds
    s_add_u32 m0, s35, 4096
    s_add_u32 s52, s37, 4096
    buffer_load_dwordx4 v8, s[12:15], s52 offen offset:0 sc1 lds
    buffer_load_dwordx4 v8, s[12:15], s52 offen offset:1024 sc1 lds
    buffer_load_dwordx4 v8, s[12:15], s52 offen offset:2048 sc1 lds
    buffer_load_dwordx4 v8, s[12:15], s52 offen offset:3072 sc1 lds
    s_add_u32 m0, s35, 8192
    s_add_u32 s52, s37, 8192
    buffer_load_dwordx4 v8, s[12:15], s52 offen offset:0 sc1 lds
    s_add_u32 s35, s35, 18432
    s_add_u32 s38, s38, 2
    s_and_b32 s38, s38, 63
    s_cmp_ge_u32 s35, 82944
    s_cselect_b32 s34, 82944, 0
    s_sub_u32 s35, s35, s34
    s_add_u32 s33, s33, 1
    s_waitcnt vmcnt(20)
    s_barrier
    s_lshr_b32 s4, s38, 2
recurrent_scan__ssm_conv_h3__mixer_gmlp__prompt_kernel_nb58:
    s_bitcmp1_b32 s55, s4
    s_cbranch_scc1 recurrent_scan__ssm_conv_h3__mixer_gmlp__prompt_kernel_nbo59
    buffer_load_dword v2, v17, s[48:51], 0 offen sc1
    s_waitcnt vmcnt(0)
    v_cmp_ne_u32 vcc, 0, v2
    s_mov_b32 s55, vcc_lo
    s_branch recurrent_scan__ssm_conv_h3__mixer_gmlp__prompt_kernel_nb58
recurrent_scan__ssm_conv_h3__mixer_gmlp__prompt_kernel_nbo59:
    s_mul_i32 s37, s38, 9216
    s_add_u32 m0, s35, 0
    s_add_u32 s52, s37, 0
    buffer_load_dwordx4 v8, s[12:15], s52 offen offset:0 sc1 lds
    buffer_load_dwordx4 v8, s[12:15], s52 offen offset:1024 sc1 lds
    buffer_load_dwordx4 v8, s[12:15], s52 offen offset:2048 sc1 lds
    buffer_load_dwordx4 v8, s[12:15], s52 offen offset:3072 sc1 lds
    s_add_u32 m0, s35, 4096
    s_add_u32 s52, s37, 4096
    buffer_load_dwordx4 v8, s[12:15], s52 offen offset:0 sc1 lds
    buffer_load_dwordx4 v8, s[12:15], s52 offen offset:1024 sc1 lds
    buffer_load_dwordx4 v8, s[12:15], s52 offen offset:2048 sc1 lds
    buffer_load_dwordx4 v8, s[12:15], s52 offen offset:3072 sc1 lds
    s_add_u32 m0, s35, 8192
    s_add_u32 s52, s37, 8192
    buffer_load_dwordx4 v8, s[12:15], s52 offen offset:0 sc1 lds
    s_add_u32 s35, s35, 18432
    s_add_u32 s38, s38, 2
    s_and_b32 s38, s38, 63
    s_cmp_ge_u32 s35, 82944
    s_cselect_b32 s34, 82944, 0
    s_sub_u32 s35, s35, s34
    s_add_u32 s33, s33, 1
    s_waitcnt vmcnt(18)
    v_readfirstlane_b32 s34, v19
    s_cmp_ge_u32 s34, 32
    s_cbranch_scc1 recurrent_scan__ssm_conv_h3__mixer_gmlp__prompt_kernel_ckok60
    v_mov_b32 v2, 2146435072
    v_mov_b32 v3, 0
    v_writelane_b32 v2, s61, 0
    s_mov_b32 s34, 32
    v_writelane_b32 v3, s34, 0
recurrent_scan__ssm_conv_h3__mixer_gmlp__prompt_kernel_pl61:
    buffer_load_dword v4, v2, s[48:51], 0 offen sc1
    s_waitcnt vmcnt(0)
    v_cmp_lt_u32 vcc, v4, v3
    s_cmp_eq_u64 vcc, 0
    s_cbranch_scc1 recurrent_scan__ssm_conv_h3__mixer_gmlp__prompt_kernel_plok62
    s_sleep 1
    s_branch recurrent_scan__ssm_conv_h3__mixer_gmlp__prompt_kernel_pl61
recurrent_scan__ssm_conv_h3__mixer_gmlp__prompt_kernel_plok62:
recurrent_scan__ssm_conv_h3__mixer_gmlp__prompt_kernel_ckok60:
    s_barrier
    s_lshr_b32 s4, s38, 2
recurrent_scan__ssm_conv_h3__mixer_gmlp__prompt_kernel_nb63:
    s_bitcmp1_b32 s55, s4
    s_cbranch_scc1 recurrent_scan__ssm_conv_h3__mixer_gmlp__prompt_kernel_nbo64
    buffer_load_dword v2, v17, s[48:51], 0 offen sc1
    s_waitcnt vmcnt(0)
    v_cmp_ne_u32 vcc, 0, v2
    s_mov_b32 s55, vcc_lo
    s_branch recurrent_scan__ssm_conv_h3__mixer_gmlp__prompt_kernel_nb63
recurrent_scan__ssm_conv_h3__mixer_gmlp__prompt_kernel_nbo64:
    s_mul_i32 s37, s38, 9216
    s_add_u32 m0, s35, 0
    s_add_u32 s52, s37, 0
    buffer_load_dwordx4 v8, s[12:15], s52 offen offset:0 sc1 lds
    buffer_load_dwordx4 v8, s[12:15], s52 offen offset:1024 sc1 lds
    buffer_load_dwordx4 v8, s[12:15], s52 offen offset:2048 sc1 lds
    buffer_load_dwordx4 v8, s[12:15], s52 offen offset:3072 sc1 lds
    s_add_u32 m0, s35, 4096
    s_add_u32 s52, s37, 4096
    buffer_load_dwordx4 v8, s[12:15], s52 offen offset:0 sc1 lds
    buffer_load_dwordx4 v8, s[12:15], s52 offen offset:1024 sc1 lds
    buffer_load_dwordx4 v8, s[12:15], s52 offen offset:2048 sc1 lds
    buffer_load_dwordx4 v8, s[12:15], s52 offen offset:3072 sc1 lds
    s_add_u32 m0, s35, 8192
    s_add_u32 s52, s37, 8192
    buffer_load_dwordx4 v8, s[12:15], s52 offen offset:0 sc1 lds
    s_add_u32 s35, s35, 18432
    s_add_u32 s38, s38, 2
    s_and_b32 s38, s38, 63
    s_cmp_ge_u32 s35, 82944
    s_cselect_b32 s34, 82944, 0
    s_sub_u32 s35, s35, s34
    s_add_u32 s33, s33, 1
    buffer_load_dwordx4 v[100:103], v7, s[44:47], s58 offen offset:0 sc1
    buffer_load_dwordx4 v[104:107], v7, s[44:47], s58 offen offset:1024 sc1
    buffer_load_dwordx4 v[108:111], v7, s[44:47], s58 offen offset:2048 sc1
    buffer_load_dwordx4 v[112:115], v7, s[44:47], s58 offen offset:3072 sc1
    s_waitcnt vmcnt(22)
    s_barrier
    s_lshr_b32 s4, s38, 2
recurrent_scan__ssm_conv_h3__mixer_gmlp__prompt_kernel_nb65:
    s_bitcmp1_b32 s55, s4
    s_cbranch_scc1 recurrent_scan__ssm_conv_h3__mixer_gmlp__prompt_kernel_nbo66
    buffer_load_dword v2, v17, s[48:51], 0 offen sc1
    s_waitcnt vmcnt(0)
    v_cmp_ne_u32 vcc, 0, v2
    s_mov_b32 s55, vcc_lo
    s_branch recurrent_scan__ssm_conv_h3__mixer_gmlp__prompt_kernel_nb65
recurrent_scan__ssm_conv_h3__mixer_gmlp__prompt_kernel_nbo66:
    s_mul_i32 s37, s38, 9216
    s_add_u32 m0, s35, 0
    s_add_u32 s52, s37, 0
    buffer_load_dwordx4 v8, s[12:15], s52 offen offset:0 sc1 lds
    buffer_load_dwordx4 v8, s[12:15], s52 offen offset:1024 sc1 lds
    buffer_load_dwordx4 v8, s[12:15], s52 offen offset:2048 sc1 lds
    buffer_load_dwordx4 v8, s[12:15], s52 offen offset:3072 sc1 lds
    s_add_u32 m0, s35, 4096
    s_add_u32 s52, s37, 4096
    buffer_load_dwordx4 v8, s[12:15], s52 offen offset:0 sc1 lds
    buffer_load_dwordx4 v8, s[12:15], s52 offen offset:1024 sc1 lds
    buffer_load_dwordx4 v8, s[12:15], s52 offen offset:2048 sc1 lds
    buffer_load_dwordx4 v8, s[12:15], s52 offen offset:3072 sc1 lds
    s_add_u32 m0, s35, 8192
    s_add_u32 s52, s37, 8192
    buffer_load_dwordx4 v8, s[12:15], s52 offen offset:0 sc1 lds
    s_add_u32 s35, s35, 18432
    s_add_u32 s38, s38, 2
    s_and_b32 s38, s38, 63
    s_cmp_ge_u32 s35, 82944
    s_cselect_b32 s34, 82944, 0
    s_sub_u32 s35, s35, s34
    s_add_u32 s33, s33, 1
    s_getpc_b64 s[60:61]
recurrent_scan__ssm_conv_h3__mixer_gmlp__prompt_kernel_pc67:
    s_mov_b32 s62, recurrent_scan__ssm_conv_h3__mixer_gmlp__prompt_kernel_end1-recurrent_scan__ssm_conv_h3__mixer_gmlp__prompt_kernel_pc67
    s_mov_b32 s63, 0x20000
    s_mul_i32 s58, s30, 8192
    s_add_u32 s58, s58, recurrent_scan__ssm_conv_h3__mixer_gmlp__prompt_kernel_epi221-recurrent_scan__ssm_conv_h3__mixer_gmlp__prompt_kernel_pc67
    v_lshlrev_b32 v18, 7, v1
    buffer_load_dword v19, v18, s[60:63], s58 offen
    s_waitcnt vmcnt(23)
    s_barrier
recurrent_scan__ssm_conv_h3__mixer_gmlp__prompt_kernel_lloop268:
    s_lshr_b32 s4, s38, 2
recurrent_scan__ssm_conv_h3__mixer_gmlp__prompt_kernel_nb69:
    s_bitcmp1_b32 s55, s4
    s_cbranch_scc1 recurrent_scan__ssm_conv_h3__mixer_gmlp__prompt_kernel_nbo70
    buffer_load_dword v2, v17, s[48:51], 0 offen sc1
    s_waitcnt vmcnt(0)
    v_cmp_ne_u32 vcc, 0, v2
    s_mov_b32 s55, vcc_lo
    s_branch recurrent_scan__ssm_conv_h3__mixer_gmlp__prompt_kernel_nb69
recurrent_scan__ssm_conv_h3__mixer_gmlp__prompt_kernel_nbo70:
    s_mul_i32 s37, s38, 9216
    s_add_u32 m0, s35, 0
    s_add_u32 s52, s37, 0
    buffer_load_dwordx4 v8, s[12:15], s52 offen offset:0 sc1 lds
    buffer_load_dwordx4 v8, s[12:15], s52 offen offset:1024 sc1 lds
    buffer_load_dwordx4 v8, s[12:15], s52 offen offset:2048 sc1 lds
    buffer_load_dwordx4 v8, s[12:15], s52 offen offset:3072 sc1 lds
    s_add_u32 m0, s35, 4096
    s_add_u32 s52, s37, 4096
    buffer_load_dwordx4 v8, s[12:15], s52 offen offset:0 sc1 lds
    buffer_load_dwordx4 v8, s[12:15], s52 offen offset:1024 sc1 lds
    buffer_load_dwordx4 v8, s[12:15], s52 offen offset:2048 sc1 lds
    buffer_load_dwordx4 v8, s[12:15], s52 offen offset:3072 sc1 lds
    s_add_u32 m0, s35, 8192
    s_add_u32 s52, s37, 8192
    buffer_load_dwordx4 v8, s[12:15], s52 offen offset:0 sc1 lds
    s_add_u32 s35, s35, 18432
    s_add_u32 s38, s38, 2
    s_and_b32 s38, s38, 63
    s_cmp_ge_u32 s35, 82944
    s_cselect_b32 s34, 82944, 0
    s_sub_u32 s35, s35, s34
    s_add_u32 s33, s33, 1
    s_cmp_lt_u32 s33, 32
    s_waitcnt vmcnt(18)
    s_barrier
    s_cbranch_scc1 recurrent_scan__ssm_conv_h3__mixer_gmlp__prompt_kernel_lloop268
    s_waitcnt vmcnt(9)
    s_barrier
    s_waitcnt vmcnt(0)
    s_barrier
    s_and_b32 s34, s2, 3
    s_lshl_b32 s34, s34, 3
    s_bfe_u32 s52, s2, 0x30003
    s_add_u32 s52, s52, s34
    s_bfe_u32 s34, s2, 0x10002
    s_lshl_b32 s34, s34, 2
    s_lshr_b32 s53, s2, 6
    s_add_u32 s53, s53, s34
    s_lshr_b32 s34, s53, 1
    s_mul_i32 s36, s34, 9
    s_and_b32 s57, s53, 1
    s_mul_i32 s34, s57, 5
    s_add_u32 s36, s36, s34
    s_lshl_b32 s35, s36, 4
    s_lshl_b32 s37, s52, 6
    s_load_dwordx4 s[60:63], s[0:1], 32
    s_lshl_b32 s59, s52, 2
    s_lshr_b32 s34, s53, 1
    s_add_u32 s59, s59, s34
    s_lshl_b32 s54, s59, 2
    s_add_u32 s54, s54, s30
    s_add_u32 s55, s59, 512
    s_cmp_lt_u32 s59, 64
    s_cselect_b32 s55, s55, 9999
    s_cmp_eq_u32 s30, 0
    s_cselect_b32 s55, s55, 9999
    s_cmp_eq_u32 s57, 1
    s_cselect_b32 s54, s54, s55
    s_mul_i32 s55, s30, 21248
    s_waitcnt lgkmcnt(0)
    s_mov_b32 s8, s60
    s_mov_b32 s9, s61
    s_mov_b32 s10, 2359296
    s_mov_b32 s11, 0x20000
    s_add_u32 s12, s42, 54525952
    s_addc_u32 s13, s43, 0
    s_mov_b32 s14, 2359296
    s_mov_b32 s15, 0x20000
    s_mov_b32 s16, s62
    s_mov_b32 s17, s63
    s_mov_b32 s18, 1152
    s_mov_b32 s19, 0x20000
    s_waitcnt vmcnt(0)
    s_barrier
    s_branch recurrent_scan__ssm_conv_h3__mixer_gmlp__prompt_kernel_ljoin224
recurrent_scan__ssm_conv_h3__mixer_gmlp__prompt_kernel_wload223:
    s_lshl_b32 s56, s39, 8
    s_add_u32 s56, s56, 512
    s_and_b32 s56, s56, 0xfff
    s_sub_u32 s34, s30, 2
    s_lshl_b32 s53, s34, 13
    s_add_u32 s53, s53, 82944
    s_lshl_b32 s34, s34, 6
    s_add_u32 s34, s34, s31
    v_lshrrev_b32 v2, 3, v1
    v_and_b32 v3, 3, v2
    v_xor_b32 v3, v3, v1
    v_and_b32 v3, 7, v3
    v_add_u32 v2, s34, v2
    v_lshlrev_b32 v2, 12, v2
    v_xor_b32 v4, 0, v3
    v_lshl_add_u32 v4, v4, 4, v2
    v_add_u32 v9, 4096, v4
    v_xor_b32 v4, 4, v3
    v_lshl_add_u32 v4, v4, 4, v2
    v_add_u32 v10, 35840, v4
    v_xor_b32 v4, 0, v3
    v_lshl_add_u32 v4, v4, 4, v2
    v_add_u32 v11, 67584, v4
    v_xor_b32 v4, 4, v3
    v_lshl_add_u32 v4, v4, 4, v2
    v_add_u32 v12, 99328, v4
    v_xor_b32 v4, 0, v3
    v_lshl_add_u32 v4, v4, 4, v2
    v_add_u32 v13, 135168, v4
    v_xor_b32 v4, 4, v3
    v_lshl_add_u32 v4, v4, 4, v2
    v_add_u32 v14, 166912, v4
    v_xor_b32 v4, 0, v3
    v_lshl_add_u32 v4, v4, 4, v2
    v_add_u32 v15, 198656, v4
    v_xor_b32 v4, 4, v3
    v_lshl_add_u32 v4, v4, 4, v2
    v_add_u32 v16, 230400, v4
    s_barrier
recurrent_scan__ssm_conv_h3__mixer_gmlp__prompt_kernel_nb71:
    s_bitcmp1_b32 s55, s4
    s_cbranch_scc1 recurrent_scan__ssm_conv_h3__mixer_gmlp__prompt_kernel_nbo72
    buffer_load_dword v2, v17, s[48:51], 0 offen sc1
    s_waitcnt vmcnt(0)
    v_cmp_ne_u32 vcc, 0, v2
    s_mov_b32 s55, vcc_lo
    s_branch recurrent_scan__ssm_conv_h3__mixer_gmlp__prompt_kernel_nb71
recurrent_scan__ssm_conv_h3__mixer_gmlp__prompt_kernel_nbo72:
    s_lshl_b32 s37, s4, 2
    s_add_u32 s37, s37, s30
    s_mul_i32 s37, s37, 9216
    s_sub_u32 s58, s30, 1
    s_cmp_eq_u32 s30, 0
    s_cselect_b32 s58, 8, s58
    s_mul_i32 s58, s58, 9216
    s_add_u32 m0, s58, 0
    s_add_u32 s52, s37, 0
    buffer_load_dwordx4 v8, s[12:15], s52 offen offset:0 sc1 lds
    buffer_load_dwordx4 v8, s[12:15], s52 offen offset:1024 sc1 lds
    buffer_load_dwordx4 v8, s[12:15], s52 offen offset:2048 sc1 lds
    buffer_load_dwordx4 v8, s[12:15], s52 offen offset:3072 sc1 lds
    s_add_u32 m0, s58, 4096
    s_add_u32 s52, s37, 4096
    buffer_load_dwordx4 v8, s[12:15], s52 offen offset:0 sc1 lds
    buffer_load_dwordx4 v8, s[12:15], s52 offen offset:1024 sc1 lds
    buffer_load_dwordx4 v8, s[12:15], s52 offen offset:2048 sc1 lds
    buffer_load_dwordx4 v8, s[12:15], s52 offen offset:3072 sc1 lds
    s_add_u32 m0, s58, 8192
    s_add_u32 s52, s37, 8192
    buffer_load_dwordx4 v8, s[12:15], s52 offen offset:0 sc1 lds
    s_barrier
    s_add_u32 m0, s53, s36
    s_add_u32 s34, s53, 4096
    buffer_load_dwordx4 v9, s[16:19], s56 offen offset:0 lds
    buffer_load_dwordx4 v10, s[16:19], s56 offen offset:1024 lds
    buffer_load_dwordx4 v11, s[16:19], s56 offen offset:2048 lds
    buffer_load_dwordx4 v12, s[16:19], s56 offen offset:3072 lds
    s_add_u32 m0, s34, s36
    s_add_u32 s36, s36, 16384
    s_and_b32 s36, s36, 65535
    buffer_load_dwordx4 v13, s[16:19], s56 offen offset:0 lds
    buffer_load_dwordx4 v14, s[16:19], s56 offen offset:1024 lds
    buffer_load_dwordx4 v15, s[16:19], s56 offen offset:2048 lds
    buffer_load_dwordx4 v16, s[16:19], s56 offen offset:3072 lds
    s_add_u32 s56, s56, 128
    s_and_b32 s56, s56, 0xfff
    s_barrier
    s_add_u32 m0, s53, s36
    s_add_u32 s34, s53, 4096
    buffer_load_dwordx4 v9, s[16:19], s56 offen offset:0 lds
    buffer_load_dwordx4 v10, s[16:19], s56 offen offset:1024 lds
    buffer_load_dwordx4 v11, s[16:19], s56 offen offset:2048 lds
    buffer_load_dwordx4 v12, s[16:19], s56 offen offset:3072 lds
    s_add_u32 m0, s34, s36
    s_add_u32 s36, s36, 16384
    s_and_b32 s36, s36, 65535
    buffer_load_dwordx4 v13, s[16:19], s56 offen offset:0 lds
    buffer_load_dwordx4 v14, s[16:19], s56 offen offset:1024 lds
    buffer_load_dwordx4 v15, s[16:19], s56 offen offset:2048 lds
    buffer_load_dwordx4 v16, s[16:19], s56 offen offset:3072 lds
    s_add_u32 s56, s56, 128
    s_and_b32 s56, s56, 0xfff
    s_waitcnt vmcnt(16)
    s_barrier
    s_mov_b32 s12, s66
    s_mov_b32 s13, s67
    s_mov_b32 s14, 2359296
    s_mov_b32 s15, 0x20000
    s_mul_i32 s34, s2, 9216
    s_sub_u32 s62, s30, 2
    s_lshl_b32 s62, s62, 13
    s_add_u32 s34, s34, s62
    v_lshlrev_b32 v2, 7, v1
    buffer_load_dword v3, v2, s[12:15], s34 offen
    s_mov_b32 s33, 6
    s_add_u32 m0, s53, s36
    s_add_u32 s34, s53, 4096
    buffer_load_dwordx4 v9, s[16:19], s56 offen offset:0 lds
    buffer_load_dwordx4 v10, s[16:19], s56 offen offset:1024 lds
    buffer_load_dwordx4 v11, s[16:19], s56 offen offset:2048 lds
    buffer_load_dwordx4 v12, s[16:19], s56 offen offset:3072 lds
    s_add_u32 m0, s34, s36
    s_add_u32 s36, s36, 16384
    s_and_b32 s36, s36, 65535
    buffer_load_dwordx4 v13, s[16:19], s56 offen offset:0 lds
    buffer_load_dwordx4 v14, s[16:19], s56 offen offset:1024 lds
    buffer_load_dwordx4 v15, s[16:19], s56 offen offset:2048 lds
    buffer_load_dwordx4 v16, s[16:19], s56 offen offset:3072 lds
    s_add_u32 s56, s56, 128
    s_and_b32 s56, s56, 0xfff
    s_add_u32 s33, s33, 1
    s_and_b32 s58, s2, 3
    s_lshl_b32 s58, s58, 3
    s_bfe_u32 s59, s2, 0x30003
    s_add_u32 s59, s59, s58
    s_bfe_u32 s58, s2, 0x10002
    s_lshl_b32 s58, s58, 2
    s_lshr_b32 s60, s2, 6
    s_add_u32 s60, s60, s58
    s_lshl_b32 s59, s59, 2
    s_lshr_b32 s58, s60, 1
    s_add_u32 s59, s59, s58
    s_lshl_b32 s54, s59, 2
    s_add_u32 s54, s54, s30
    s_add_u32 s62, s59, 512
    s_cmp_lt_u32 s59, 64
    s_cselect_b32 s62, s62, 9999
    s_cmp_eq_u32 s30, 0
    s_cselect_b32 s62, s62, 9999
    s_bitcmp1_b32 s60, 0
    s_cselect_b32 s54, s54, s62
    s_lshl_b32 s58, s54, 12
    s_mov_b32 s3, s58
    s_mov_b32 s24, s66
    s_mov_b32 s25, s67
    s_mov_b32 s26, 2359296
    s_mov_b32 s27, 0x20000
    s_waitcnt vmcnt(16)
    s_barrier
    s_add_u32 m0, s53, s36
    s_add_u32 s34, s53, 4096
    buffer_load_dwordx4 v9, s[16:19], s56 offen offset:0 lds
    buffer_load_dwordx4 v10, s[16:19], s56 offen offset:1024 lds
    buffer_load_dwordx4 v11, s[16:19], s56 offen offset:2048 lds
    buffer_load_dwordx4 v12, s[16:19], s56 offen offset:3072 lds
    s_add_u32 m0, s34, s36
    s_add_u32 s36, s36, 16384
    s_and_b32 s36, s36, 65535
    buffer_load_dwordx4 v13, s[16:19], s56 offen offset:0 lds
    buffer_load_dwordx4 v14, s[16:19], s56 offen offset:1024 lds
    buffer_load_dwordx4 v15, s[16:19], s56 offen offset:2048 lds
    buffer_load_dwordx4 v16, s[16:19], s56 offen offset:3072 lds
    s_add_u32 s56, s56, 128
    s_and_b32 s56, s56, 0xfff
    s_add_u32 s33, s33, 1
    s_waitcnt vmcnt(16)
    s_barrier
recurrent_scan__ssm_conv_h3__mixer_gmlp__prompt_kernel_wo73:
    s_add_u32 m0, s53, s36
    s_add_u32 s34, s53, 4096
    buffer_load_dwordx4 v9, s[16:19], s56 offen offset:0 lds
    buffer_load_dwordx4 v10, s[16:19], s56 offen offset:1024 lds
    buffer_load_dwordx4 v11, s[16:19], s56 offen offset:2048 lds
    buffer_load_dwordx4 v12, s[16:19], s56 offen offset:3072 lds
    s_add_u32 m0, s34, s36
    s_add_u32 s36, s36, 16384
    s_and_b32 s36, s36, 65535
    buffer_load_dwordx4 v13, s[16:19], s56 offen offset:0 lds
    buffer_load_dwordx4 v14, s[16:19], s56 offen offset:1024 lds
    buffer_load_dwordx4 v15, s[16:19], s56 offen offset:2048 lds
    buffer_load_dwordx4 v16, s[16:19], s56 offen offset:3072 lds
    s_add_u32 s56, s56, 128
    s_and_b32 s56, s56, 0xfff
    s_add_u32 s33, s33, 1
    s_mul_i32 s58, s57, 21846
    s_lshr_b32 s58, s58, 16
    s_mul_i32 s59, s58, 3
    s_sub_u32 s59, s57, s59
    s_mul_i32 s60, s58, 7282
    s_lshr_b32 s60, s60, 16
    s_mul_i32 s61, s60, 9
    s_sub_u32 s61, s58, s61
    s_lshr_b32 s62, s61, 2
    s_lshl_b32 s63, s60, 1
    s_add_u32 s62, s62, s63
    s_mul_i32 s62, s62, 144
    s_and_b32 s64, s61, 3
    s_lshl_b32 s64, s64, 5
    s_add_u32 s62, s62, s64
    s_mul_i32 s63, s63, 144
    s_add_u32 s63, s63, 128
    s_cmp_eq_u32 s61, 8
    s_cselect_b32 s62, s63, s62
    s_cselect_b32 s63, 144, 16
    s_mul_i32 s64, s59, 384
    s_lshr_b32 s54, s30, 1
    s_mul_i32 s54, s54, s63
    s_add_u32 s62, s62, s54
    s_and_b32 s54, s30, 1
    s_lshl_b32 s54, s54, 3
    s_add_u32 s62, s62, s54
    s_mul_i32 s62, s62, 1152
    s_add_u32 s62, s62, s64
    v_add_u32 v40, 0, v1
    buffer_load_dwordx4 v[116:119], v7, s[24:27], s3 offen offset:0
    buffer_load_dwordx4 v[120:123], v7, s[24:27], s3 offen offset:1024
    s_waitcnt vmcnt(16)
    s_barrier
    s_add_u32 m0, s53, s36
    s_add_u32 s34, s53, 4096
    buffer_load_dwordx4 v9, s[16:19], s56 offen offset:0 lds
    buffer_load_dwordx4 v10, s[16:19], s56 offen offset:1024 lds
    buffer_load_dwordx4 v11, s[16:19], s56 offen offset:2048 lds
    buffer_load_dwordx4 v12, s[16:19], s56 offen offset:3072 lds
    s_add_u32 m0, s34, s36
    s_add_u32 s36, s36, 16384
    s_and_b32 s36, s36, 65535
    buffer_load_dwordx4 v13, s[16:19], s56 offen offset:0 lds
    buffer_load_dwordx4 v14, s[16:19], s56 offen offset:1024 lds
    buffer_load_dwordx4 v15, s[16:19], s56 offen offset:2048 lds
    buffer_load_dwordx4 v16, s[16:19], s56 offen offset:3072 lds
    s_add_u32 s56, s56, 128
    s_and_b32 s56, s56, 0xfff
    s_add_u32 s33, s33, 1
    v_mul_u32_u24 v41, 2731, v40
    v_lshrrev_b32 v41, 16, v41
    v_mul_u32_u24 v42, 24, v41
    v_sub_u32 v42, v40, v42
    v_mul_u32_u24 v41, 1152, v41
    v_lshl_add_u32 v41, v42, 4, v41
    buffer_load_dwordx4 v[44:47], v41, s[8:11], s62 offen
    v_add_u32 v40, 64, v1
    v_mul_u32_u24 v41, 2731, v40
    v_lshrrev_b32 v41, 16, v41
    v_mul_u32_u24 v42, 24, v41
    v_sub_u32 v42, v40, v42
    v_mul_u32_u24 v41, 1152, v41
    v_lshl_add_u32 v41, v42, 4, v41
    buffer_load_dwordx4 v[48:51], v41, s[8:11], s62 offen
    v_add_u32 v40, 128, v1
    v_mul_u32_u24 v41, 2731, v40
    v_lshrrev_b32 v41, 16, v41
    v_mul_u32_u24 v42, 24, v41
    v_sub_u32 v42, v40, v42
    v_mul_u32_u24 v41, 1152, v41
    v_lshl_add_u32 v41, v42, 4, v41
    buffer_load_dwordx4 v[52:55], v41, s[8:11], s62 offen
    buffer_load_dwordx4 v[124:127], v7, s[24:27], s3 offen offset:2048
    buffer_load_dwordx4 v[128:131], v7, s[24:27], s3 offen offset:3072
    s_waitcnt vmcnt(16)
    s_barrier
    s_add_u32 m0, s53, s36
    s_add_u32 s34, s53, 4096
    buffer_load_dwordx4 v9, s[16:19], s56 offen offset:0 lds
    buffer_load_dwordx4 v10, s[16:19], s56 offen offset:1024 lds
    buffer_load_dwordx4 v11, s[16:19], s56 offen offset:2048 lds
    buffer_load_dwordx4 v12, s[16:19], s56 offen offset:3072 lds
    s_add_u32 m0, s34, s36
    s_add_u32 s36, s36, 16384
    s_and_b32 s36, s36, 65535
    buffer_load_dwordx4 v13, s[16:19], s56 offen offset:0 lds
    buffer_load_dwordx4 v14, s[16:19], s56 offen offset:1024 lds
    buffer_load_dwordx4 v15, s[16:19], s56 offen offset:2048 lds
    buffer_load_dwordx4 v16, s[16:19], s56 offen offset:3072 lds
    s_add_u32 s56, s56, 128
    s_and_b32 s56, s56, 0xfff
    s_add_u32 s33, s33, 1
    buffer_load_dwordx4 v[132:135], v7, s[24:27], s3 offen offset:2
    buffer_load_dwordx4 v[144:147], v7, s[24:27], s3 offen offset:1026
    s_waitcnt vmcnt(25)
    s_barrier
    s_add_u32 m0, s53, s36
    s_add_u32 s34, s53, 4096
    buffer_load_dwordx4 v9, s[16:19], s56 offen offset:0 lds
    buffer_load_dwordx4 v10, s[16:19], s56 offen offset:1024 lds
    buffer_load_dwordx4 v11, s[16:19], s56 offen offset:2048 lds
    buffer_load_dwordx4 v12, s[16:19], s56 offen offset:3072 lds
    s_add_u32 m0, s34, s36
    s_add_u32 s36, s36, 16384
    s_and_b32 s36, s36, 65535
    buffer_load_dwordx4 v13, s[16:19], s56 offen offset:0 lds
    buffer_load_dwordx4 v14, s[16:19], s56 offen offset:1024 lds
    buffer_load_dwordx4 v15, s[16:19], s56 offen offset:2048 lds
    buffer_load_dwordx4 v16, s[16:19], s56 offen offset:3072 lds
    s_add_u32 s56, s56, 128
    s_and_b32 s56, s56, 0xfff
    s_add_u32 s33, s33, 1
    s_waitcnt vmcnt(20)
    s_mul_i32 s54, s30, 3072
    s_add_u32 s54, s54, 148480
    v_lshlrev_b32 v40, 4, v1
    v_add_u32 v40, s54, v40
    ds_write_b128 v40, v[44:47] offset:0
    ds_write_b128 v40, v[48:51] offset:1024
    ds_write_b128 v40, v[52:55] offset:2048
    s_waitcnt lgkmcnt(0)
    buffer_load_dwordx4 v[148:151], v7, s[24:27], s3 offen offset:2050
    buffer_load_dwordx4 v[152:155], v7, s[24:27], s3 offen offset:3074
    s_barrier
    s_add_u32 m0, s53, s36
    s_add_u32 s34, s53, 4096
    buffer_load_dwordx4 v9, s[16:19], s56 offen offset:0 lds
    buffer_load_dwordx4 v10, s[16:19], s56 offen offset:1024 lds
    buffer_load_dwordx4 v11, s[16:19], s56 offen offset:2048 lds
    buffer_load_dwordx4 v12, s[16:19], s56 offen offset:3072 lds
    s_add_u32 m0, s34, s36
    s_add_u32 s36, s36, 16384
    s_and_b32 s36, s36, 65535
    buffer_load_dwordx4 v13, s[16:19], s56 offen offset:0 lds
    buffer_load_dwordx4 v14, s[16:19], s56 offen offset:1024 lds
    buffer_load_dwordx4 v15, s[16:19], s56 offen offset:2048 lds
    buffer_load_dwordx4 v16, s[16:19], s56 offen offset:3072 lds
    s_add_u32 s56, s56, 128
    s_and_b32 s56, s56, 0xfff
    s_add_u32 s33, s33, 1
    v_lshrrev_b32 v40, 2, v5
    v_lshl_add_u32 v40, v6, 2, v40
    v_mul_u32_u24 v40, 384, v40
    v_and_b32 v41, 3, v5
    v_lshl_add_u32 v40, v41, 3, v40
    s_mul_i32 s54, s30, 96
    s_add_u32 s54, s54, 148480
    v_add_u32 v40, s54, v40
    ds_read_b64_tr_b16 v[44:45], v40 offset:0
    ds_read_b64_tr_b16 v[46:47], v40 offset:6144
    ds_read_b64_tr_b16 v[48:49], v40 offset:32
    ds_read_b64_tr_b16 v[50:51], v40 offset:6176
    ds_read_b64_tr_b16 v[52:53], v40 offset:64
    ds_read_b64_tr_b16 v[54:55], v40 offset:6208
    s_mul_i32 s54, s59, 12
    s_mul_i32 s60, s30, 3
    s_add_u32 s54, s54, s60
    s_mul_i32 s54, s54, 72
    s_add_u32 s54, s54, s58
    s_lshl_b32 s60, s54, 10
    s_add_u32 s61, s60, 73728
    s_add_u32 s62, s60, 147456
    v_lshlrev_b32 v42, 4, v1
    s_waitcnt lgkmcnt(0)
    buffer_store_dwordx4 v[44:47], v42, s[44:47], s60 offen sc1
    buffer_store_dwordx4 v[48:51], v42, s[44:47], s61 offen sc1
    buffer_store_dwordx4 v[52:55], v42, s[44:47], s62 offen sc1
    buffer_load_dwordx4 v[156:159], v7, s[24:27], s3 offen offset:4
    buffer_load_dwordx4 v[180:183], v7, s[24:27], s3 offen offset:1028
    s_waitcnt vmcnt(25)
    s_barrier
    s_add_u32 m0, s53, s36
    s_add_u32 s34, s53, 4096
    buffer_load_dwordx4 v9, s[16:19], s56 offen offset:0 lds
    buffer_load_dwordx4 v10, s[16:19], s56 offen offset:1024 lds
    buffer_load_dwordx4 v11, s[16:19], s56 offen offset:2048 lds
    buffer_load_dwordx4 v12, s[16:19], s56 offen offset:3072 lds
    s_add_u32 m0, s34, s36
    s_add_u32 s36, s36, 16384
    s_and_b32 s36, s36, 65535
    buffer_load_dwordx4 v13, s[16:19], s56 offen offset:0 lds
    buffer_load_dwordx4 v14, s[16:19], s56 offen offset:1024 lds
    buffer_load_dwordx4 v15, s[16:19], s56 offen offset:2048 lds
    buffer_load_dwordx4 v16, s[16:19], s56 offen offset:3072 lds
    s_add_u32 s56, s56, 128
    s_and_b32 s56, s56, 0xfff
    s_add_u32 s33, s33, 1
    buffer_load_dwordx4 v[184:187], v7, s[24:27], s3 offen offset:2052
    buffer_load_dwordx4 v[188:191], v7, s[24:27], s3 offen offset:3076
    s_waitcnt vmcnt(25)
    s_barrier
    s_add_u32 m0, s53, s36
    s_add_u32 s34, s53, 4096
    buffer_load_dwordx4 v9, s[16:19], s56 offen offset:0 lds
    buffer_load_dwordx4 v10, s[16:19], s56 offen offset:1024 lds
    buffer_load_dwordx4 v11, s[16:19], s56 offen offset:2048 lds
    buffer_load_dwordx4 v12, s[16:19], s56 offen offset:3072 lds
    s_add_u32 m0, s34, s36
    s_add_u32 s36, s36, 16384
    s_and_b32 s36, s36, 65535
    buffer_load_dwordx4 v13, s[16:19], s56 offen offset:0 lds
    buffer_load_dwordx4 v14, s[16:19], s56 offen offset:1024 lds
    buffer_load_dwordx4 v15, s[16:19], s56 offen offset:2048 lds
    buffer_load_dwordx4 v16, s[16:19], s56 offen offset:3072 lds
    s_add_u32 s56, s56, 128
    s_and_b32 s56, s56, 0xfff
    s_add_u32 s33, s33, 1
    buffer_load_dwordx4 v[192:195], v7, s[24:27], s3 offen offset:6
    buffer_load_dwordx4 v[196:199], v7, s[24:27], s3 offen offset:1030
    s_waitcnt vmcnt(25)
    s_barrier
    s_add_u32 m0, s53, s36
    s_add_u32 s34, s53, 4096
    buffer_load_dwordx4 v9, s[16:19], s56 offen offset:0 lds
    buffer_load_dwordx4 v10, s[16:19], s56 offen offset:1024 lds
    buffer_load_dwordx4 v11, s[16:19], s56 offen offset:2048 lds
    buffer_load_dwordx4 v12, s[16:19], s56 offen offset:3072 lds
    s_add_u32 m0, s34, s36
    s_add_u32 s36, s36, 16384
    s_and_b32 s36, s36, 65535
    buffer_load_dwordx4 v13, s[16:19], s56 offen offset:0 lds
    buffer_load_dwordx4 v14, s[16:19], s56 offen offset:1024 lds
    buffer_load_dwordx4 v15, s[16:19], s56 offen offset:2048 lds
    buffer_load_dwordx4 v16, s[16:19], s56 offen offset:3072 lds
    s_add_u32 s56, s56, 128
    s_and_b32 s56, s56, 0xfff
    s_add_u32 s33, s33, 1
    buffer_load_dwordx4 v[200:203], v7, s[24:27], s3 offen offset:2054
    buffer_load_dwordx4 v[204:207], v7, s[24:27], s3 offen offset:3078
    s_waitcnt vmcnt(22)
    s_barrier
    s_add_u32 m0, s53, s36
    s_add_u32 s34, s53, 4096
    buffer_load_dwordx4 v9, s[16:19], s56 offen offset:0 lds
    buffer_load_dwordx4 v10, s[16:19], s56 offen offset:1024 lds
    buffer_load_dwordx4 v11, s[16:19], s56 offen offset:2048 lds
    buffer_load_dwordx4 v12, s[16:19], s56 offen offset:3072 lds
    s_add_u32 m0, s34, s36
    s_add_u32 s36, s36, 16384
    s_and_b32 s36, s36, 65535
    buffer_load_dwordx4 v13, s[16:19], s56 offen offset:0 lds
    buffer_load_dwordx4 v14, s[16:19], s56 offen offset:1024 lds
    buffer_load_dwordx4 v15, s[16:19], s56 offen offset:2048 lds
    buffer_load_dwordx4 v16, s[16:19], s56 offen offset:3072 lds
    s_add_u32 s56, s56, 128
    s_and_b32 s56, s56, 0xfff
    s_add_u32 s33, s33, 1
    s_lshl_b32 s60, s59, 8
    s_add_u32 s60, s60, 1880064
    s_cmp_eq_u32 s30, 0
    s_cselect_b32 s60, s60, 2146435072
    s_cmp_lt_u32 s57, 216
    s_cselect_b32 s60, s60, 2146435072
    v_mov_b32 v2, s60
    v_mov_b32 v3, 1
    s_mov_b64 exec, 1
    buffer_atomic_add v3, v2, s[48:51], 0 offen sc1
    s_mov_b64 exec, -1
    s_waitcnt vmcnt(21)
    s_barrier
    s_add_u32 m0, s53, s36
    s_add_u32 s34, s53, 4096
    buffer_load_dwordx4 v9, s[16:19], s56 offen offset:0 lds
    buffer_load_dwordx4 v10, s[16:19], s56 offen offset:1024 lds
    buffer_load_dwordx4 v11, s[16:19], s56 offen offset:2048 lds
    buffer_load_dwordx4 v12, s[16:19], s56 offen offset:3072 lds
    s_add_u32 m0, s34, s36
    s_add_u32 s36, s36, 16384
    s_and_b32 s36, s36, 65535
    buffer_load_dwordx4 v13, s[16:19], s56 offen offset:0 lds
    buffer_load_dwordx4 v14, s[16:19], s56 offen offset:1024 lds
    buffer_load_dwordx4 v15, s[16:19], s56 offen offset:2048 lds
    buffer_load_dwordx4 v16, s[16:19], s56 offen offset:3072 lds
    s_add_u32 s56, s56, 128
    s_and_b32 s56, s56, 0xfff
    s_add_u32 s33, s33, 1
    s_and_b32 s58, s2, 3
    s_lshl_b32 s58, s58, 3
    s_bfe_u32 s59, s2, 0x30003
    s_add_u32 s59, s59, s58
    s_bfe_u32 s58, s2, 0x10002
    s_lshl_b32 s58, s58, 2
    s_lshr_b32 s60, s2, 6
    s_add_u32 s60, s60, s58
    s_lshl_b32 s59, s59, 2
    s_lshr_b32 s58, s60, 1
    s_add_u32 s59, s59, s58
    s_lshl_b32 s54, s59, 2
    s_add_u32 s54, s54, s30
    s_add_u32 s62, s59, 512
    s_cmp_lt_u32 s59, 64
    s_cselect_b32 s62, s62, 9999
    s_cmp_eq_u32 s30, 0
    s_cselect_b32 s62, s62, 9999
    s_bitcmp1_b32 s60, 0
    s_cselect_b32 s54, s54, s62
    s_lshl_b32 s58, s54, 12
    s_min_u32 s61, s54, 575
    s_mul_i32 s61, s61, 911
    s_lshr_b32 s61, s61, 16
    s_lshl_b32 s61, s61, 8
    s_add_u32 s61, s61, 1875968
    s_mov_b32 s8, s66
    s_mov_b32 s9, s67
    s_mov_b32 s10, 2359296
    s_mov_b32 s11, 0x20000
    s_add_u32 s44, s42, 54525952
    s_addc_u32 s45, s43, 0
    s_mov_b32 s46, 2359296
    s_mov_b32 s47, 0x20000
    v_mov_b32 v18, s61
    buffer_load_dword v19, v18, s[48:51], 0 offen sc1
    s_waitcnt vmcnt(20)
    s_barrier
    s_add_u32 m0, s53, s36
    s_add_u32 s34, s53, 4096
    buffer_load_dwordx4 v9, s[16:19], s56 offen offset:0 lds
    buffer_load_dwordx4 v10, s[16:19], s56 offen offset:1024 lds
    buffer_load_dwordx4 v11, s[16:19], s56 offen offset:2048 lds
    buffer_load_dwordx4 v12, s[16:19], s56 offen offset:3072 lds
    s_add_u32 m0, s34, s36
    s_add_u32 s36, s36, 16384
    s_and_b32 s36, s36, 65535
    buffer_load_dwordx4 v13, s[16:19], s56 offen offset:0 lds
    buffer_load_dwordx4 v14, s[16:19], s56 offen offset:1024 lds
    buffer_load_dwordx4 v15, s[16:19], s56 offen offset:2048 lds
    buffer_load_dwordx4 v16, s[16:19], s56 offen offset:3072 lds
    s_add_u32 s56, s56, 128
    s_and_b32 s56, s56, 0xfff
    s_add_u32 s33, s33, 1
    s_waitcnt vmcnt(18)
    s_barrier
    s_add_u32 m0, s53, s36
    s_add_u32 s34, s53, 4096
    buffer_load_dwordx4 v9, s[16:19], s56 offen offset:0 lds
    buffer_load_dwordx4 v10, s[16:19], s56 offen offset:1024 lds
    buffer_load_dwordx4 v11, s[16:19], s56 offen offset:2048 lds
    buffer_load_dwordx4 v12, s[16:19], s56 offen offset:3072 lds
    s_add_u32 m0, s34, s36
    s_add_u32 s36, s36, 16384
    s_and_b32 s36, s36, 65535
    buffer_load_dwordx4 v13, s[16:19], s56 offen offset:0 lds
    buffer_load_dwordx4 v14, s[16:19], s56 offen offset:1024 lds
    buffer_load_dwordx4 v15, s[16:19], s56 offen offset:2048 lds
    buffer_load_dwordx4 v16, s[16:19], s56 offen offset:3072 lds
    s_add_u32 s56, s56, 128
    s_and_b32 s56, s56, 0xfff
    s_add_u32 s33, s33, 1
    s_waitcnt vmcnt(16)
    v_readfirstlane_b32 s34, v19
    s_cmp_ge_u32 s34, 32
    s_cbranch_scc1 recurrent_scan__ssm_conv_h3__mixer_gmlp__prompt_kernel_ckok74
    v_mov_b32 v2, 2146435072
    v_mov_b32 v3, 0
    v_writelane_b32 v2, s61, 0
    s_mov_b32 s34, 32
    v_writelane_b32 v3, s34, 0
recurrent_scan__ssm_conv_h3__mixer_gmlp__prompt_kernel_pl75:
    buffer_load_dword v4, v2, s[48:51], 0 offen sc1
    s_waitcnt vmcnt(0)
    v_cmp_lt_u32 vcc, v4, v3
    s_cmp_eq_u64 vcc, 0
    s_cbranch_scc1 recurrent_scan__ssm_conv_h3__mixer_gmlp__prompt_kernel_plok76
    s_sleep 1
    s_branch recurrent_scan__ssm_conv_h3__mixer_gmlp__prompt_kernel_pl75
recurrent_scan__ssm_conv_h3__mixer_gmlp__prompt_kernel_plok76:
recurrent_scan__ssm_conv_h3__mixer_gmlp__prompt_kernel_ckok74:
    s_barrier
    s_add_u32 m0, s53, s36
    s_add_u32 s34, s53, 4096
    buffer_load_dwordx4 v9, s[16:19], s56 offen offset:0 lds
    buffer_load_dwordx4 v10, s[16:19], s56 offen offset:1024 lds
    buffer_load_dwordx4 v11, s[16:19], s56 offen offset:2048 lds
    buffer_load_dwordx4 v12, s[16:19], s56 offen offset:3072 lds
    s_add_u32 m0, s34, s36
    s_add_u32 s36, s36, 16384
    s_and_b32 s36, s36, 65535
    buffer_load_dwordx4 v13, s[16:19], s56 offen offset:0 lds
    buffer_load_dwordx4 v14, s[16:19], s56 offen offset:1024 lds
    buffer_load_dwordx4 v15, s[16:19], s56 offen offset:2048 lds
    buffer_load_dwordx4 v16, s[16:19], s56 offen offset:3072 lds
    s_add_u32 s56, s56, 128
    s_and_b32 s56, s56, 0xfff
    s_add_u32 s33, s33, 1
    buffer_load_dwordx4 v[100:103], v7, s[44:47], s58 offen offset:0 sc1
    buffer_load_dwordx4 v[104:107], v7, s[44:47], s58 offen offset:1024 sc1
    buffer_load_dwordx4 v[108:111], v7, s[44:47], s58 offen offset:2048 sc1
    buffer_load_dwordx4 v[112:115], v7, s[44:47], s58 offen offset:3072 sc1
    s_waitcnt vmcnt(20)
    s_barrier
    s_add_u32 m0, s53, s36
    s_add_u32 s34, s53, 4096
    buffer_load_dwordx4 v9, s[16:19], s56 offen offset:0 lds
    buffer_load_dwordx4 v10, s[16:19], s56 offen offset:1024 lds
    buffer_load_dwordx4 v11, s[16:19], s56 offen offset:2048 lds
    buffer_load_dwordx4 v12, s[16:19], s56 offen offset:3072 lds
    s_add_u32 m0, s34, s36
    s_add_u32 s36, s36, 16384
    s_and_b32 s36, s36, 65535
    buffer_load_dwordx4 v13, s[16:19], s56 offen offset:0 lds
    buffer_load_dwordx4 v14, s[16:19], s56 offen offset:1024 lds
    buffer_load_dwordx4 v15, s[16:19], s56 offen offset:2048 lds
    buffer_load_dwordx4 v16, s[16:19], s56 offen offset:3072 lds
    s_add_u32 s56, s56, 128
    s_and_b32 s56, s56, 0xfff
    s_add_u32 s33, s33, 1
    s_getpc_b64 s[60:61]
recurrent_scan__ssm_conv_h3__mixer_gmlp__prompt_kernel_pc77:
    s_mov_b32 s62, recurrent_scan__ssm_conv_h3__mixer_gmlp__prompt_kernel_end1-recurrent_scan__ssm_conv_h3__mixer_gmlp__prompt_kernel_pc77
    s_mov_b32 s63, 0x20000
    s_mul_i32 s58, s30, 8192
    s_add_u32 s58, s58, recurrent_scan__ssm_conv_h3__mixer_gmlp__prompt_kernel_epi221-recurrent_scan__ssm_conv_h3__mixer_gmlp__prompt_kernel_pc77
    v_lshlrev_b32 v18, 7, v1
    buffer_load_dword v19, v18, s[60:63], s58 offen
    s_waitcnt vmcnt(21)
    s_barrier
recurrent_scan__ssm_conv_h3__mixer_gmlp__prompt_kernel_lloop278:
    s_add_u32 m0, s53, s36
    s_add_u32 s34, s53, 4096
    buffer_load_dwordx4 v9, s[16:19], s56 offen offset:0 lds
    buffer_load_dwordx4 v10, s[16:19], s56 offen offset:1024 lds
    buffer_load_dwordx4 v11, s[16:19], s56 offen offset:2048 lds
    buffer_load_dwordx4 v12, s[16:19], s56 offen offset:3072 lds
    s_add_u32 m0, s34, s36
    s_add_u32 s36, s36, 16384
    s_and_b32 s36, s36, 65535
    buffer_load_dwordx4 v13, s[16:19], s56 offen offset:0 lds
    buffer_load_dwordx4 v14, s[16:19], s56 offen offset:1024 lds
    buffer_load_dwordx4 v15, s[16:19], s56 offen offset:2048 lds
    buffer_load_dwordx4 v16, s[16:19], s56 offen offset:3072 lds
    s_add_u32 s56, s56, 128
    s_and_b32 s56, s56, 0xfff
    s_add_u32 s33, s33, 1
    s_cmp_lt_u32 s33, 32
    s_waitcnt vmcnt(16)
    s_barrier
    s_cbranch_scc1 recurrent_scan__ssm_conv_h3__mixer_gmlp__prompt_kernel_lloop278
    s_waitcnt vmcnt(8)
    s_barrier
    s_waitcnt vmcnt(0)
    s_barrier
    s_and_b32 s34, s2, 3
    s_lshl_b32 s34, s34, 3
    s_bfe_u32 s52, s2, 0x30003
    s_add_u32 s52, s52, s34
    s_bfe_u32 s34, s2, 0x10002
    s_lshl_b32 s34, s34, 2
    s_lshr_b32 s53, s2, 6
    s_add_u32 s53, s53, s34
    s_lshr_b32 s34, s53, 1
    s_mul_i32 s36, s34, 9
    s_and_b32 s57, s53, 1
    s_mul_i32 s34, s57, 5
    s_add_u32 s36, s36, s34
    s_lshl_b32 s35, s36, 4
    s_lshl_b32 s37, s52, 6
    s_load_dwordx4 s[60:63], s[0:1], 32
    s_lshl_b32 s59, s52, 2
    s_lshr_b32 s34, s53, 1
    s_add_u32 s59, s59, s34
    s_lshl_b32 s54, s59, 2
    s_add_u32 s54, s54, s30
    s_add_u32 s55, s59, 512
    s_cmp_lt_u32 s59, 64
    s_cselect_b32 s55, s55, 9999
    s_cmp_eq_u32 s30, 0
    s_cselect_b32 s55, s55, 9999
    s_cmp_eq_u32 s57, 1
    s_cselect_b32 s54, s54, s55
    s_mul_i32 s55, s30, 21248
    s_waitcnt lgkmcnt(0)
    s_mov_b32 s8, s60
    s_mov_b32 s9, s61
    s_mov_b32 s10, 2359296
    s_mov_b32 s11, 0x20000
    s_add_u32 s12, s42, 54525952
    s_addc_u32 s13, s43, 0
    s_mov_b32 s14, 2359296
    s_mov_b32 s15, 0x20000
    s_mov_b32 s16, s62
    s_mov_b32 s17, s63
    s_mov_b32 s18, 1152
    s_mov_b32 s19, 0x20000
    s_waitcnt vmcnt(0)
    s_barrier
recurrent_scan__ssm_conv_h3__mixer_gmlp__prompt_kernel_ljoin224:
    s_lshl_b32 s34, s30, 13
    s_add_u32 s34, s34, 116736
    v_add_u32 v2, s34, v7
    s_mul_i32 s34, s30, 5120
    s_add_u32 s34, s34, 95232
    v_add_u32 v3, s34, v7
    s_barrier
    ds_write_b128 v3, v[160:163] offset:0
    ds_write_b128 v3, v[164:167] offset:1024
    ds_write_b128 v3, v[168:171] offset:2048
    ds_write_b128 v3, v[172:175] offset:3072
    ds_write_b128 v3, v[176:179] offset:4096
    s_waitcnt lgkmcnt(0)
    s_barrier
    ds_read_b128 v[8:11], v2 offset:0
    ds_read_b128 v[12:15], v2 offset:1024
    ds_read_b128 v[16:19], v2 offset:2048
    ds_read_b128 v[20:23], v2 offset:3072
    ds_read_b128 v[24:27], v2 offset:4096
    ds_read_b128 v[28:31], v2 offset:5120
    ds_read_b128 v[32:35], v2 offset:6144
    ds_read_b128 v[36:39], v2 offset:7168
    s_waitcnt lgkmcnt(0)
    v_lshlrev_b32 v96, 16, v140
    v_lshlrev_b32 v97, 16, v140
    v_lshlrev_b32 v98, 16, v141
    v_lshlrev_b32 v99, 16, v141
    v_pk_add_f32 v[8:9], v[8:9], v[96:97]
    v_lshlrev_b32 v80, 16, v236
    v_and_b32 v81, 0xffff0000, v236
    v_pk_add_f32 v[10:11], v[10:11], v[96:97]
    v_lshlrev_b32 v82, 16, v237
    v_and_b32 v83, 0xffff0000, v237
    v_pk_mul_f32 v[8:9], v[8:9], v[80:81]
    v_pk_mul_f32 v[10:11], v[10:11], v[82:83]
    v_cvt_pk_bf16_f32 v236, v8, v9
    v_cvt_pk_bf16_f32 v237, v10, v11
    v_pk_add_f32 v[16:17], v[16:17], v[96:97]
    v_lshlrev_b32 v88, 16, v238
    v_and_b32 v89, 0xffff0000, v238
    v_pk_add_f32 v[18:19], v[18:19], v[96:97]
    v_lshlrev_b32 v90, 16, v239
    v_and_b32 v91, 0xffff0000, v239
    v_pk_mul_f32 v[16:17], v[16:17], v[88:89]
    v_pk_mul_f32 v[18:19], v[18:19], v[90:91]
    v_cvt_pk_bf16_f32 v238, v16, v17
    v_cvt_pk_bf16_f32 v239, v18, v19
    buffer_store_dwordx4 v[236:239], v136, s[20:23], 0 offen offset:0 sc1
    v_pk_add_f32 v[24:25], v[24:25], v[96:97]
    v_lshlrev_b32 v80, 16, v240
    v_and_b32 v81, 0xffff0000, v240
    v_pk_add_f32 v[26:27], v[26:27], v[96:97]
    v_lshlrev_b32 v82, 16, v241
    v_and_b32 v83, 0xffff0000, v241
    v_pk_mul_f32 v[24:25], v[24:25], v[80:81]
    v_pk_mul_f32 v[26:27], v[26:27], v[82:83]
    v_cvt_pk_bf16_f32 v240, v24, v25
    v_cvt_pk_bf16_f32 v241, v26, v27
    v_pk_add_f32 v[32:33], v[32:33], v[96:97]
    v_lshlrev_b32 v88, 16, v242
    v_and_b32 v89, 0xffff0000, v242
    v_pk_add_f32 v[34:35], v[34:35], v[96:97]
    v_lshlrev_b32 v90, 16, v243
    v_and_b32 v91, 0xffff0000, v243
    v_pk_mul_f32 v[32:33], v[32:33], v[88:89]
    v_pk_mul_f32 v[34:35], v[34:35], v[90:91]
    v_cvt_pk_bf16_f32 v242, v32, v33
    v_cvt_pk_bf16_f32 v243, v34, v35
    buffer_store_dwordx4 v[240:243], v136, s[20:23], 0 offen offset:1024 sc1
    v_pk_add_f32 v[12:13], v[12:13], v[98:99]
    v_lshlrev_b32 v80, 16, v244
    v_and_b32 v81, 0xffff0000, v244
    v_pk_add_f32 v[14:15], v[14:15], v[98:99]
    v_lshlrev_b32 v82, 16, v245
    v_and_b32 v83, 0xffff0000, v245
    v_pk_mul_f32 v[12:13], v[12:13], v[80:81]
    v_pk_mul_f32 v[14:15], v[14:15], v[82:83]
    v_cvt_pk_bf16_f32 v244, v12, v13
    v_cvt_pk_bf16_f32 v245, v14, v15
    v_pk_add_f32 v[20:21], v[20:21], v[98:99]
    v_lshlrev_b32 v88, 16, v246
    v_and_b32 v89, 0xffff0000, v246
    v_pk_add_f32 v[22:23], v[22:23], v[98:99]
    v_lshlrev_b32 v90, 16, v247
    v_and_b32 v91, 0xffff0000, v247
    v_pk_mul_f32 v[20:21], v[20:21], v[88:89]
    v_pk_mul_f32 v[22:23], v[22:23], v[90:91]
    v_cvt_pk_bf16_f32 v246, v20, v21
    v_cvt_pk_bf16_f32 v247, v22, v23
    buffer_store_dwordx4 v[244:247], v136, s[20:23], s65 offen offset:0 sc1
    v_pk_add_f32 v[28:29], v[28:29], v[98:99]
    v_lshlrev_b32 v80, 16, v248
    v_and_b32 v81, 0xffff0000, v248
    v_pk_add_f32 v[30:31], v[30:31], v[98:99]
    v_lshlrev_b32 v82, 16, v249
    v_and_b32 v83, 0xffff0000, v249
    v_pk_mul_f32 v[28:29], v[28:29], v[80:81]
    v_pk_mul_f32 v[30:31], v[30:31], v[82:83]
    v_cvt_pk_bf16_f32 v248, v28, v29
    v_cvt_pk_bf16_f32 v249, v30, v31
    v_pk_add_f32 v[36:37], v[36:37], v[98:99]
    v_lshlrev_b32 v88, 16, v250
    v_and_b32 v89, 0xffff0000, v250
    v_pk_add_f32 v[38:39], v[38:39], v[98:99]
    v_lshlrev_b32 v90, 16, v251
    v_and_b32 v91, 0xffff0000, v251
    v_pk_mul_f32 v[36:37], v[36:37], v[88:89]
    v_pk_mul_f32 v[38:39], v[38:39], v[90:91]
    v_cvt_pk_bf16_f32 v250, v36, v37
    v_cvt_pk_bf16_f32 v251, v38, v39
    buffer_store_dwordx4 v[248:251], v136, s[20:23], s65 offen offset:1024 sc1
    s_barrier
recurrent_scan__ssm_conv_h3__mixer_gmlp__prompt_kernel_epi221:
    s_load_dwordx2 s[4:5], s[0:1], 0
    s_load_dwordx2 s[6:7], s[0:1], 88
    s_lshl_b32 s60, s39, 8
    s_add_u32 s60, s60, 1871872
    s_lshl_b32 s34, s32, 2
    s_add_u32 s60, s60, s34
    s_and_b32 s34, s2, 3
    s_lshl_b32 s34, s34, 3
    s_bfe_u32 s52, s2, 0x30003
    s_add_u32 s52, s52, s34
    s_bfe_u32 s34, s2, 0x10002
    s_lshl_b32 s34, s34, 2
    s_lshr_b32 s53, s2, 6
    s_add_u32 s53, s53, s34
    s_lshr_b32 s34, s53, 1
    s_mul_i32 s36, s34, 9
    s_and_b32 s57, s53, 1
    s_mul_i32 s34, s57, 5
    s_add_u32 s36, s36, s34
    s_lshl_b32 s35, s36, 4
    s_lshl_b32 s37, s52, 6
    s_add_u32 s20, s42, 58720256
    s_addc_u32 s21, s43, 0
    s_mov_b32 s22, 2359296
    s_mov_b32 s23, 0x20000
    s_waitcnt lgkmcnt(0)
    s_cmp_ge_u32 s28, 4
    s_cbranch_scc1 recurrent_scan__ssm_conv_h3__mixer_gmlp__prompt_kernel_conv79
    s_waitcnt vmcnt(0)
    v_mov_b32 v2, 160772
    v_mov_b32 v3, 1
    s_mov_b64 exec, 1
    ds_add_rtn_u32 v2, v2, v3
    s_waitcnt lgkmcnt(0)
    v_readfirstlane_b32 s34, v2
    s_cmp_eq_u32 s34, 7
    s_cselect_b32 s34, 0, 2146435072
    s_mov_b64 exec, 1
    v_mov_b32 v3, 1
    v_mov_b32 v2, s60
    buffer_atomic_add v3, v2, s[48:51], s34 offen sc1
    s_mov_b64 exec, -1
    s_add_u32 s8, s42, 33554432
    s_addc_u32 s9, s43, 0
    s_mov_b32 s10, 9437184
    s_mov_b32 s11, 0x20000
    s_add_u32 s12, s42, 62914560
    s_addc_u32 s13, s43, 0
    s_mov_b32 s14, 2654208
    s_mov_b32 s15, 0x20000
    s_mov_b32 s16, s4
    s_mov_b32 s17, s5
    s_mov_b32 s18, 2359296
    s_mov_b32 s19, 0x20000
    s_mov_b32 s24, s6
    s_mov_b32 s25, s7
    s_mov_b32 s26, 2359296
    s_mov_b32 s27, 0x20000
    s_lshr_b32 s56, s28, 1
    s_lshl_b32 s56, s56, 5
    s_and_b32 s34, s28, 1
    s_lshl_b32 s34, s34, 2
    s_add_u32 s56, s56, s34
    s_add_u32 s56, s56, s37
    s_mul_i32 s38, s28, 18432
    s_mul_i32 s34, s52, 294912
    v_add_u32 v8, s34, v7
    s_add_u32 s34, s34, 73728
    v_add_u32 v9, s34, v7
    s_add_u32 s34, s34, 73728
    v_add_u32 v10, s34, v7
    s_add_u32 s34, s34, 73728
    v_add_u32 v11, s34, v7
    s_mul_i32 s34, s36, 73728
    v_add_u32 v12, s34, v7
    s_add_u32 s34, s34, 73728
    v_add_u32 v13, s34, v7
    s_add_u32 s34, s34, 73728
    v_add_u32 v14, s34, v7
    s_add_u32 s34, s34, 73728
    v_add_u32 v15, s34, v7
    s_add_u32 s34, s34, 73728
    v_add_u32 v16, s34, v7
    s_mov_b32 s60, 1880064
    s_mov_b32 s58, 1880320
    s_mov_b32 s59, 1880576
    s_lshr_b32 s61, s52, 1
    s_lshl_b32 s61, s61, 8
    s_add_u32 s62, s61, 1871872
    s_add_u32 s61, s61, 1835008
    v_mov_b32 v2, 2146435072
    v_mov_b32 v3, 0
    v_writelane_b32 v2, s60, 0
    s_mov_b32 s34, 72
    v_writelane_b32 v3, s34, 0
    v_writelane_b32 v2, s58, 1
    s_mov_b32 s34, 72
    v_writelane_b32 v3, s34, 1
    v_writelane_b32 v2, s59, 2
    s_mov_b32 s34, 72
    v_writelane_b32 v3, s34, 2
    v_writelane_b32 v2, s61, 3
    s_mov_b32 s34, 64
    v_writelane_b32 v3, s34, 3
recurrent_scan__ssm_conv_h3__mixer_gmlp__prompt_kernel_pl81:
    buffer_load_dword v4, v2, s[48:51], 0 offen sc1
    s_waitcnt vmcnt(0)
    v_cmp_lt_u32 vcc, v4, v3
    s_cmp_eq_u64 vcc, 0
    s_cbranch_scc1 recurrent_scan__ssm_conv_h3__mixer_gmlp__prompt_kernel_plok82
    s_sleep 1
    s_branch recurrent_scan__ssm_conv_h3__mixer_gmlp__prompt_kernel_pl81
recurrent_scan__ssm_conv_h3__mixer_gmlp__prompt_kernel_plok82:
    s_cmp_eq_u32 s57, 1
    s_cbranch_scc1 recurrent_scan__ssm_conv_h3__mixer_gmlp__prompt_kernel_nt480
    buffer_load_dwordx4 v[120:123], v12, s[12:15], s38 offen offset:0 sc1
    buffer_load_dwordx4 v[124:127], v13, s[12:15], s38 offen offset:0 sc1
    buffer_load_dwordx4 v[128:131], v14, s[12:15], s38 offen offset:0 sc1
    buffer_load_dwordx4 v[132:135], v15, s[12:15], s38 offen offset:0 sc1
    buffer_load_dwordx4 v[136:139], v16, s[12:15], s38 offen offset:0 sc1
    buffer_load_dwordx4 v[156:159], v12, s[12:15], s38 offen offset:1024 sc1
    buffer_load_dwordx4 v[160:163], v13, s[12:15], s38 offen offset:1024 sc1
    buffer_load_dwordx4 v[164:167], v14, s[12:15], s38 offen offset:1024 sc1
    buffer_load_dwordx4 v[168:171], v15, s[12:15], s38 offen offset:1024 sc1
    buffer_load_dwordx4 v[172:175], v16, s[12:15], s38 offen offset:1024 sc1
    buffer_load_dwordx4 v[192:195], v12, s[12:15], s38 offen offset:2048 sc1
    buffer_load_dwordx4 v[196:199], v13, s[12:15], s38 offen offset:2048 sc1
    buffer_load_dwordx4 v[200:203], v14, s[12:15], s38 offen offset:2048 sc1
    buffer_load_dwordx4 v[204:207], v15, s[12:15], s38 offen offset:2048 sc1
    buffer_load_dwordx4 v[208:211], v16, s[12:15], s38 offen offset:2048 sc1
    buffer_load_dwordx4 v[228:231], v12, s[12:15], s38 offen offset:3072 sc1
    buffer_load_dwordx4 v[232:235], v13, s[12:15], s38 offen offset:3072 sc1
    buffer_load_dwordx4 v[236:239], v14, s[12:15], s38 offen offset:3072 sc1
    buffer_load_dwordx4 v[240:243], v15, s[12:15], s38 offen offset:3072 sc1
    buffer_load_dwordx4 v[244:247], v16, s[12:15], s38 offen offset:3072 sc1
    s_add_u32 s58, s38, 4096
    s_add_u32 s59, s38, 8192
    s_mul_i32 s54, s28, 10240
    s_mul_i32 s55, s28, 15360
    v_add_u32 v20, s54, v7
    v_add_u32 v20, 115712, v20
    v_add_u32 v248, s55, v7
    v_add_u32 v248, 21248, v248
    s_add_u32 m0, s54, 115712
    s_nop 0
    buffer_load_dwordx4 v12, s[12:15], s58 offen offset:0 sc1 lds
    s_add_u32 m0, s54, 116736
    s_nop 0
    buffer_load_dwordx4 v13, s[12:15], s58 offen offset:0 sc1 lds
    s_add_u32 m0, s54, 117760
    s_nop 0
    buffer_load_dwordx4 v14, s[12:15], s58 offen offset:0 sc1 lds
    s_add_u32 m0, s54, 118784
    s_nop 0
    buffer_load_dwordx4 v15, s[12:15], s58 offen offset:0 sc1 lds
    s_add_u32 m0, s54, 119808
    s_nop 0
    buffer_load_dwordx4 v16, s[12:15], s58 offen offset:0 sc1 lds
    s_add_u32 m0, s54, 119808
    s_nop 0
    buffer_load_dwordx4 v12, s[12:15], s58 offen offset:1024 sc1 lds
    s_add_u32 m0, s54, 120832
    s_nop 0
    buffer_load_dwordx4 v13, s[12:15], s58 offen offset:1024 sc1 lds
    s_add_u32 m0, s54, 121856
    s_nop 0
    buffer_load_dwordx4 v14, s[12:15], s58 offen offset:1024 sc1 lds
    s_add_u32 m0, s54, 122880
    s_nop 0
    buffer_load_dwordx4 v15, s[12:15], s58 offen offset:1024 sc1 lds
    s_add_u32 m0, s54, 123904
    s_nop 0
    buffer_load_dwordx4 v16, s[12:15], s58 offen offset:1024 sc1 lds
    s_add_u32 m0, s55, 19200
    s_nop 0
    buffer_load_dwordx4 v12, s[12:15], s58 offen offset:2048 sc1 lds
    s_add_u32 m0, s55, 20224
    s_nop 0
    buffer_load_dwordx4 v13, s[12:15], s58 offen offset:2048 sc1 lds
    s_add_u32 m0, s55, 21248
    s_nop 0
    buffer_load_dwordx4 v14, s[12:15], s58 offen offset:2048 sc1 lds
    s_add_u32 m0, s55, 22272
    s_nop 0
    buffer_load_dwordx4 v15, s[12:15], s58 offen offset:2048 sc1 lds
    s_add_u32 m0, s55, 23296
    s_nop 0
    buffer_load_dwordx4 v16, s[12:15], s58 offen offset:2048 sc1 lds
    s_add_u32 m0, s55, 23296
    s_nop 0
    buffer_load_dwordx4 v12, s[12:15], s58 offen offset:3072 sc1 lds
    s_add_u32 m0, s55, 24320
    s_nop 0
    buffer_load_dwordx4 v13, s[12:15], s58 offen offset:3072 sc1 lds
    s_add_u32 m0, s55, 25344
    s_nop 0
    buffer_load_dwordx4 v14, s[12:15], s58 offen offset:3072 sc1 lds
    s_add_u32 m0, s55, 26368
    s_nop 0
    buffer_load_dwordx4 v15, s[12:15], s58 offen offset:3072 sc1 lds
    s_add_u32 m0, s55, 27392
    s_nop 0
    buffer_load_dwordx4 v16, s[12:15], s58 offen offset:3072 sc1 lds
    s_add_u32 m0, s55, 31488
    s_nop 0
    buffer_load_dwordx4 v12, s[12:15], s59 offen offset:0 sc1 lds
    s_add_u32 m0, s55, 32512
    s_nop 0
    buffer_load_dwordx4 v13, s[12:15], s59 offen offset:0 sc1 lds
    s_add_u32 m0, s55, 33536
    s_nop 0
    buffer_load_dwordx4 v14, s[12:15], s59 offen offset:0 sc1 lds
    s_add_u32 m0, s55, 34560
    s_nop 0
    buffer_load_dwordx4 v15, s[12:15], s59 offen offset:0 sc1 lds
    s_add_u32 m0, s55, 35584
    s_nop 0
    buffer_load_dwordx4 v16, s[12:15], s59 offen offset:0 sc1 lds
    s_mov_b32 s54, 6554
    v_add_u32 v2, 0, v1
    v_mul_lo_u32 v3, v2, s54
    v_lshrrev_b32 v3, 16, v3
    v_mul_u32_u24 v24, 10, v3
    v_sub_u32 v24, v2, v24
    v_and_b32 v25, 12, v3
    v_add_u32 v3, v3, v25
    v_mul_u32_u24 v3, 1152, v3
    v_lshl_add_u32 v3, v24, 4, v3
    v_cmp_gt_u32 vcc, 10, v24
    v_mov_b32 v25, 2146435072
    s_nop 0
    v_cndmask_b32 v3, v25, v3, vcc
    s_mul_i32 s34, s56, 1152
    s_lshl_b32 s55, s35, 1
    s_add_u32 s34, s34, s55
    s_mul_i32 s55, s28, 2560
    s_add_u32 m0, s55, 84992
    s_nop 0
    buffer_load_dwordx4 v3, s[16:19], s34 offen lds
    v_add_u32 v2, 64, v1
    v_mul_lo_u32 v3, v2, s54
    v_lshrrev_b32 v3, 16, v3
    v_mul_u32_u24 v24, 10, v3
    v_sub_u32 v24, v2, v24
    v_and_b32 v25, 12, v3
    v_add_u32 v3, v3, v25
    v_mul_u32_u24 v3, 1152, v3
    v_lshl_add_u32 v3, v24, 4, v3
    v_cmp_gt_u32 vcc, 10, v24
    v_mov_b32 v25, 2146435072
    s_nop 0
    v_cndmask_b32 v3, v25, v3, vcc
    s_mul_i32 s34, s56, 1152
    s_lshl_b32 s55, s35, 1
    s_add_u32 s34, s34, s55
    s_mul_i32 s55, s28, 2560
    s_add_u32 m0, s55, 86016
    s_nop 0
    buffer_load_dwordx4 v3, s[16:19], s34 offen lds
    v_add_u32 v2, 128, v1
    v_mul_lo_u32 v3, v2, s54
    v_lshrrev_b32 v3, 16, v3
    v_mul_u32_u24 v24, 10, v3
    v_sub_u32 v24, v2, v24
    v_and_b32 v25, 12, v3
    v_add_u32 v3, v3, v25
    v_mul_u32_u24 v3, 1152, v3
    v_lshl_add_u32 v3, v24, 4, v3
    v_cmp_gt_u32 vcc, 10, v24
    v_mov_b32 v25, 2146435072
    s_nop 0
    v_cndmask_b32 v3, v25, v3, vcc
    s_mul_i32 s34, s56, 1152
    s_lshl_b32 s55, s35, 1
    s_add_u32 s34, s34, s55
    s_mul_i32 s55, s28, 2560
    s_add_u32 m0, s55, 87040
    s_mov_b32 exec_hi, 0
    buffer_load_dwordx4 v3, s[16:19], s34 offen lds
    s_mov_b32 exec_hi, -1
    s_lshl_b32 s34, s56, 3
    s_add_u32 s34, s34, 1048576
    v_and_b32 v2, 12, v5
    v_add_u32 v2, v2, v5
    v_lshlrev_b32 v2, 3, v2
    buffer_load_dwordx2 v[18:19], v2, s[48:51], s34 offen sc1
    v_mov_b32 v24, 0
    v_mov_b32 v25, 0
    v_mov_b32 v26, 0
    v_mov_b32 v27, 0
    v_mov_b32 v28, 0
    v_mov_b32 v29, 0
    v_mov_b32 v30, 0
    v_mov_b32 v31, 0
    v_mov_b32 v32, 0
    v_mov_b32 v33, 0
    v_mov_b32 v34, 0
    v_mov_b32 v35, 0
    v_mov_b32 v36, 0
    v_mov_b32 v37, 0
    v_mov_b32 v38, 0
    v_mov_b32 v39, 0
    v_mov_b32 v40, 0
    v_mov_b32 v41, 0
    v_mov_b32 v42, 0
    v_mov_b32 v43, 0
    v_mov_b32 v44, 0
    v_mov_b32 v45, 0
    v_mov_b32 v46, 0
    v_mov_b32 v47, 0
    v_mov_b32 v48, 0
    v_mov_b32 v49, 0
    v_mov_b32 v50, 0
    v_mov_b32 v51, 0
    v_mov_b32 v52, 0
    v_mov_b32 v53, 0
    v_mov_b32 v54, 0
    v_mov_b32 v55, 0
    v_mov_b32 v56, 0
    v_mov_b32 v57, 0
    v_mov_b32 v58, 0
    v_mov_b32 v59, 0
    v_mov_b32 v60, 0
    v_mov_b32 v61, 0
    v_mov_b32 v62, 0
    v_mov_b32 v63, 0
    v_mov_b32 v64, 0
    v_mov_b32 v65, 0
    v_mov_b32 v66, 0
    v_mov_b32 v67, 0
    v_mov_b32 v68, 0
    v_mov_b32 v69, 0
    v_mov_b32 v70, 0
    v_mov_b32 v71, 0
    v_mov_b32 v72, 0
    v_mov_b32 v73, 0
    v_mov_b32 v74, 0
    v_mov_b32 v75, 0
    v_mov_b32 v76, 0
    v_mov_b32 v77, 0
    v_mov_b32 v78, 0
    v_mov_b32 v79, 0
    v_mov_b32 v80, 0
    v_mov_b32 v81, 0
    v_mov_b32 v82, 0
    v_mov_b32 v83, 0
    v_mov_b32 v84, 0
    v_mov_b32 v85, 0
    v_mov_b32 v86, 0
    v_mov_b32 v87, 0
    v_mov_b32 v88, 0
    v_mov_b32 v89, 0
    v_mov_b32 v90, 0
    v_mov_b32 v91, 0
    v_mov_b32 v92, 0
    v_mov_b32 v93, 0
    v_mov_b32 v94, 0
    v_mov_b32 v95, 0
    v_mov_b32 v96, 0
    v_mov_b32 v97, 0
    v_mov_b32 v98, 0
    v_mov_b32 v99, 0
    v_mov_b32 v100, 0
    v_mov_b32 v101, 0
    v_mov_b32 v102, 0
    v_mov_b32 v103, 0
    s_mov_b32 s33, 0
    s_lshl_b32 s34, s28, 4
    s_add_u32 s62, s62, s34
    s_add_u32 s63, s62, 4
    s_add_u32 s60, s62, 8
    s_add_u32 s61, s62, 12
    v_mov_b32 v2, 2146435072
    v_mov_b32 v3, 0
    v_writelane_b32 v2, s62, 0
    s_mov_b32 s34, 1
    v_writelane_b32 v3, s34, 0
    v_writelane_b32 v2, s63, 1
    s_mov_b32 s34, 1
    v_writelane_b32 v3, s34, 1
    v_writelane_b32 v2, s60, 2
    s_mov_b32 s34, 1
    v_writelane_b32 v3, s34, 2
    v_writelane_b32 v2, s61, 3
    s_mov_b32 s34, 1
    v_writelane_b32 v3, s34, 3
recurrent_scan__ssm_conv_h3__mixer_gmlp__prompt_kernel_pl83:
    buffer_load_dword v4, v2, s[48:51], 0 offen sc1
    s_waitcnt vmcnt(0)
    v_cmp_lt_u32 vcc, v4, v3
    s_cmp_eq_u64 vcc, 0
    s_cbranch_scc1 recurrent_scan__ssm_conv_h3__mixer_gmlp__prompt_kernel_plok84
    s_sleep 1
    s_branch recurrent_scan__ssm_conv_h3__mixer_gmlp__prompt_kernel_pl83
recurrent_scan__ssm_conv_h3__mixer_gmlp__prompt_kernel_plok84:
    buffer_load_dwordx4 v[104:107], v8, s[8:11], s38 offen offset:0 sc1
    buffer_load_dwordx4 v[108:111], v9, s[8:11], s38 offen offset:0 sc1
    buffer_load_dwordx4 v[112:115], v10, s[8:11], s38 offen offset:0 sc1
    buffer_load_dwordx4 v[116:119], v11, s[8:11], s38 offen offset:0 sc1
    buffer_load_dwordx4 v[140:143], v8, s[8:11], s38 offen offset:1024 sc1
    buffer_load_dwordx4 v[144:147], v9, s[8:11], s38 offen offset:1024 sc1
    buffer_load_dwordx4 v[148:151], v10, s[8:11], s38 offen offset:1024 sc1
    buffer_load_dwordx4 v[152:155], v11, s[8:11], s38 offen offset:1024 sc1
    buffer_load_dwordx4 v[176:179], v8, s[8:11], s38 offen offset:2048 sc1
    buffer_load_dwordx4 v[180:183], v9, s[8:11], s38 offen offset:2048 sc1
    buffer_load_dwordx4 v[184:187], v10, s[8:11], s38 offen offset:2048 sc1
    buffer_load_dwordx4 v[188:191], v11, s[8:11], s38 offen offset:2048 sc1
    s_waitcnt vmcnt(8)
    buffer_load_dwordx4 v[212:215], v8, s[8:11], s38 offen offset:3072 sc1
    v_mfma_f32_16x16x32_bf16 v[24:27], v[120:123], v[104:107], v[24:27]
    buffer_load_dwordx4 v[216:219], v9, s[8:11], s38 offen offset:3072 sc1
    v_mfma_f32_16x16x32_bf16 v[44:47], v[120:123], v[108:111], v[44:47]
    buffer_load_dwordx4 v[220:223], v10, s[8:11], s38 offen offset:3072 sc1
    v_mfma_f32_16x16x32_bf16 v[64:67], v[120:123], v[112:115], v[64:67]
    buffer_load_dwordx4 v[224:227], v11, s[8:11], s38 offen offset:3072 sc1
    v_mfma_f32_16x16x32_bf16 v[84:87], v[120:123], v[116:119], v[84:87]
    v_mfma_f32_16x16x32_bf16 v[28:31], v[124:127], v[104:107], v[28:31]
    v_mfma_f32_16x16x32_bf16 v[48:51], v[124:127], v[108:111], v[48:51]
    v_mfma_f32_16x16x32_bf16 v[68:71], v[124:127], v[112:115], v[68:71]
    v_mfma_f32_16x16x32_bf16 v[88:91], v[124:127], v[116:119], v[88:91]
    v_mfma_f32_16x16x32_bf16 v[32:35], v[128:131], v[104:107], v[32:35]
    v_mfma_f32_16x16x32_bf16 v[52:55], v[128:131], v[108:111], v[52:55]
    v_mfma_f32_16x16x32_bf16 v[72:75], v[128:131], v[112:115], v[72:75]
    v_mfma_f32_16x16x32_bf16 v[92:95], v[128:131], v[116:119], v[92:95]
    v_mfma_f32_16x16x32_bf16 v[36:39], v[132:135], v[104:107], v[36:39]
    v_mfma_f32_16x16x32_bf16 v[56:59], v[132:135], v[108:111], v[56:59]
    v_mfma_f32_16x16x32_bf16 v[76:79], v[132:135], v[112:115], v[76:79]
    v_mfma_f32_16x16x32_bf16 v[96:99], v[132:135], v[116:119], v[96:99]
    v_mfma_f32_16x16x32_bf16 v[40:43], v[136:139], v[104:107], v[40:43]
    v_mfma_f32_16x16x32_bf16 v[60:63], v[136:139], v[108:111], v[60:63]
    v_mfma_f32_16x16x32_bf16 v[80:83], v[136:139], v[112:115], v[80:83]
    v_mfma_f32_16x16x32_bf16 v[100:103], v[136:139], v[116:119], v[100:103]
    s_waitcnt vmcnt(8)
    s_add_u32 s38, s38, 4096
    buffer_load_dwordx4 v[104:107], v8, s[8:11], s38 offen offset:0 sc1
    v_mfma_f32_16x16x32_bf16 v[24:27], v[156:159], v[140:143], v[24:27]
    buffer_load_dwordx4 v[108:111], v9, s[8:11], s38 offen offset:0 sc1
    v_mfma_f32_16x16x32_bf16 v[44:47], v[156:159], v[144:147], v[44:47]
    buffer_load_dwordx4 v[112:115], v10, s[8:11], s38 offen offset:0 sc1
    v_mfma_f32_16x16x32_bf16 v[64:67], v[156:159], v[148:151], v[64:67]
    buffer_load_dwordx4 v[116:119], v11, s[8:11], s38 offen offset:0 sc1
    v_mfma_f32_16x16x32_bf16 v[84:87], v[156:159], v[152:155], v[84:87]
    ds_read_b128 v[120:123], v20 offset:0
    v_mfma_f32_16x16x32_bf16 v[28:31], v[160:163], v[140:143], v[28:31]
    ds_read_b128 v[124:127], v20 offset:1024
    v_mfma_f32_16x16x32_bf16 v[48:51], v[160:163], v[144:147], v[48:51]
    ds_read_b128 v[128:131], v20 offset:2048
    v_mfma_f32_16x16x32_bf16 v[68:71], v[160:163], v[148:151], v[68:71]
    ds_read_b128 v[132:135], v20 offset:3072
    v_mfma_f32_16x16x32_bf16 v[88:91], v[160:163], v[152:155], v[88:91]
    ds_read_b128 v[136:139], v20 offset:4096
    v_mfma_f32_16x16x32_bf16 v[32:35], v[164:167], v[140:143], v[32:35]
    v_mfma_f32_16x16x32_bf16 v[52:55], v[164:167], v[144:147], v[52:55]
    v_mfma_f32_16x16x32_bf16 v[72:75], v[164:167], v[148:151], v[72:75]
    v_mfma_f32_16x16x32_bf16 v[92:95], v[164:167], v[152:155], v[92:95]
    v_mfma_f32_16x16x32_bf16 v[36:39], v[168:171], v[140:143], v[36:39]
    v_mfma_f32_16x16x32_bf16 v[56:59], v[168:171], v[144:147], v[56:59]
    v_mfma_f32_16x16x32_bf16 v[76:79], v[168:171], v[148:151], v[76:79]
    v_mfma_f32_16x16x32_bf16 v[96:99], v[168:171], v[152:155], v[96:99]
    v_mfma_f32_16x16x32_bf16 v[40:43], v[172:175], v[140:143], v[40:43]
    v_mfma_f32_16x16x32_bf16 v[60:63], v[172:175], v[144:147], v[60:63]
    v_mfma_f32_16x16x32_bf16 v[80:83], v[172:175], v[148:151], v[80:83]
    v_mfma_f32_16x16x32_bf16 v[100:103], v[172:175], v[152:155], v[100:103]
    s_waitcnt vmcnt(8)
    buffer_load_dwordx4 v[140:143], v8, s[8:11], s38 offen offset:1024 sc1
    v_mfma_f32_16x16x32_bf16 v[24:27], v[192:195], v[176:179], v[24:27]
    buffer_load_dwordx4 v[144:147], v9, s[8:11], s38 offen offset:1024 sc1
    v_mfma_f32_16x16x32_bf16 v[44:47], v[192:195], v[180:183], v[44:47]
    buffer_load_dwordx4 v[148:151], v10, s[8:11], s38 offen offset:1024 sc1
    v_mfma_f32_16x16x32_bf16 v[64:67], v[192:195], v[184:187], v[64:67]
    buffer_load_dwordx4 v[152:155], v11, s[8:11], s38 offen offset:1024 sc1
    v_mfma_f32_16x16x32_bf16 v[84:87], v[192:195], v[188:191], v[84:87]
    ds_read_b128 v[156:159], v20 offset:5120
    v_mfma_f32_16x16x32_bf16 v[28:31], v[196:199], v[176:179], v[28:31]
    ds_read_b128 v[160:163], v20 offset:6144
    v_mfma_f32_16x16x32_bf16 v[48:51], v[196:199], v[180:183], v[48:51]
    ds_read_b128 v[164:167], v20 offset:7168
    v_mfma_f32_16x16x32_bf16 v[68:71], v[196:199], v[184:187], v[68:71]
    ds_read_b128 v[168:171], v20 offset:8192
    v_mfma_f32_16x16x32_bf16 v[88:91], v[196:199], v[188:191], v[88:91]
    ds_read_b128 v[172:175], v20 offset:9216
    v_mfma_f32_16x16x32_bf16 v[32:35], v[200:203], v[176:179], v[32:35]
    v_mfma_f32_16x16x32_bf16 v[52:55], v[200:203], v[180:183], v[52:55]
    v_mfma_f32_16x16x32_bf16 v[72:75], v[200:203], v[184:187], v[72:75]
    v_mfma_f32_16x16x32_bf16 v[92:95], v[200:203], v[188:191], v[92:95]
    v_mfma_f32_16x16x32_bf16 v[36:39], v[204:207], v[176:179], v[36:39]
    v_mfma_f32_16x16x32_bf16 v[56:59], v[204:207], v[180:183], v[56:59]
    v_mfma_f32_16x16x32_bf16 v[76:79], v[204:207], v[184:187], v[76:79]
    v_mfma_f32_16x16x32_bf16 v[96:99], v[204:207], v[188:191], v[96:99]
    v_mfma_f32_16x16x32_bf16 v[40:43], v[208:211], v[176:179], v[40:43]
    v_mfma_f32_16x16x32_bf16 v[60:63], v[208:211], v[180:183], v[60:63]
    v_mfma_f32_16x16x32_bf16 v[80:83], v[208:211], v[184:187], v[80:83]
    v_mfma_f32_16x16x32_bf16 v[100:103], v[208:211], v[188:191], v[100:103]
    s_waitcnt vmcnt(8)
    buffer_load_dwordx4 v[176:179], v8, s[8:11], s38 offen offset:2048 sc1
    v_mfma_f32_16x16x32_bf16 v[24:27], v[228:231], v[212:215], v[24:27]
    buffer_load_dwordx4 v[180:183], v9, s[8:11], s38 offen offset:2048 sc1
    v_mfma_f32_16x16x32_bf16 v[44:47], v[228:231], v[216:219], v[44:47]
    buffer_load_dwordx4 v[184:187], v10, s[8:11], s38 offen offset:2048 sc1
    v_mfma_f32_16x16x32_bf16 v[64:67], v[228:231], v[220:223], v[64:67]
    buffer_load_dwordx4 v[188:191], v11, s[8:11], s38 offen offset:2048 sc1
    v_mfma_f32_16x16x32_bf16 v[84:87], v[228:231], v[224:227], v[84:87]
    ds_read_b128 v[192:195], v248 offset:0
    v_mfma_f32_16x16x32_bf16 v[28:31], v[232:235], v[212:215], v[28:31]
    ds_read_b128 v[196:199], v248 offset:1024
    v_mfma_f32_16x16x32_bf16 v[48:51], v[232:235], v[216:219], v[48:51]
    ds_read_b128 v[200:203], v248 offset:2048
    v_mfma_f32_16x16x32_bf16 v[68:71], v[232:235], v[220:223], v[68:71]
    ds_read_b128 v[204:207], v248 offset:3072
    v_mfma_f32_16x16x32_bf16 v[88:91], v[232:235], v[224:227], v[88:91]
    ds_read_b128 v[208:211], v248 offset:4096
    v_mfma_f32_16x16x32_bf16 v[32:35], v[236:239], v[212:215], v[32:35]
    v_mfma_f32_16x16x32_bf16 v[52:55], v[236:239], v[216:219], v[52:55]
    v_mfma_f32_16x16x32_bf16 v[72:75], v[236:239], v[220:223], v[72:75]
    v_mfma_f32_16x16x32_bf16 v[92:95], v[236:239], v[224:227], v[92:95]
    v_mfma_f32_16x16x32_bf16 v[36:39], v[240:243], v[212:215], v[36:39]
    v_mfma_f32_16x16x32_bf16 v[56:59], v[240:243], v[216:219], v[56:59]
    v_mfma_f32_16x16x32_bf16 v[76:79], v[240:243], v[220:223], v[76:79]
    v_mfma_f32_16x16x32_bf16 v[96:99], v[240:243], v[224:227], v[96:99]
    v_mfma_f32_16x16x32_bf16 v[40:43], v[244:247], v[212:215], v[40:43]
    v_mfma_f32_16x16x32_bf16 v[60:63], v[244:247], v[216:219], v[60:63]
    v_mfma_f32_16x16x32_bf16 v[80:83], v[244:247], v[220:223], v[80:83]
    v_mfma_f32_16x16x32_bf16 v[100:103], v[244:247], v[224:227], v[100:103]
    s_waitcnt vmcnt(8)
    s_waitcnt lgkmcnt(0)
    buffer_load_dwordx4 v[212:215], v8, s[8:11], s38 offen offset:3072 sc1
    v_mfma_f32_16x16x32_bf16 v[24:27], v[120:123], v[104:107], v[24:27]
    buffer_load_dwordx4 v[216:219], v9, s[8:11], s38 offen offset:3072 sc1
    v_mfma_f32_16x16x32_bf16 v[44:47], v[120:123], v[108:111], v[44:47]
    buffer_load_dwordx4 v[220:223], v10, s[8:11], s38 offen offset:3072 sc1
    v_mfma_f32_16x16x32_bf16 v[64:67], v[120:123], v[112:115], v[64:67]
    buffer_load_dwordx4 v[224:227], v11, s[8:11], s38 offen offset:3072 sc1
    v_mfma_f32_16x16x32_bf16 v[84:87], v[120:123], v[116:119], v[84:87]
    ds_read_b128 v[228:231], v248 offset:5120
    v_mfma_f32_16x16x32_bf16 v[28:31], v[124:127], v[104:107], v[28:31]
    ds_read_b128 v[232:235], v248 offset:6144
    v_mfma_f32_16x16x32_bf16 v[48:51], v[124:127], v[108:111], v[48:51]
    ds_read_b128 v[236:239], v248 offset:7168
    v_mfma_f32_16x16x32_bf16 v[68:71], v[124:127], v[112:115], v[68:71]
    ds_read_b128 v[240:243], v248 offset:8192
    v_mfma_f32_16x16x32_bf16 v[88:91], v[124:127], v[116:119], v[88:91]
    ds_read_b128 v[244:247], v248 offset:9216
    v_mfma_f32_16x16x32_bf16 v[32:35], v[128:131], v[104:107], v[32:35]
    v_mfma_f32_16x16x32_bf16 v[52:55], v[128:131], v[108:111], v[52:55]
    v_mfma_f32_16x16x32_bf16 v[72:75], v[128:131], v[112:115], v[72:75]
    v_mfma_f32_16x16x32_bf16 v[92:95], v[128:131], v[116:119], v[92:95]
    v_mfma_f32_16x16x32_bf16 v[36:39], v[132:135], v[104:107], v[36:39]
    v_mfma_f32_16x16x32_bf16 v[56:59], v[132:135], v[108:111], v[56:59]
    v_mfma_f32_16x16x32_bf16 v[76:79], v[132:135], v[112:115], v[76:79]
    v_mfma_f32_16x16x32_bf16 v[96:99], v[132:135], v[116:119], v[96:99]
    v_mfma_f32_16x16x32_bf16 v[40:43], v[136:139], v[104:107], v[40:43]
    v_mfma_f32_16x16x32_bf16 v[60:63], v[136:139], v[108:111], v[60:63]
    v_mfma_f32_16x16x32_bf16 v[80:83], v[136:139], v[112:115], v[80:83]
    v_mfma_f32_16x16x32_bf16 v[100:103], v[136:139], v[116:119], v[100:103]
    s_waitcnt vmcnt(8)
    s_waitcnt lgkmcnt(0)
    s_add_u32 s38, s38, 4096
    buffer_load_dwordx4 v[104:107], v8, s[8:11], s38 offen offset:0 sc1
    v_mfma_f32_16x16x32_bf16 v[24:27], v[156:159], v[140:143], v[24:27]
    buffer_load_dwordx4 v[108:111], v9, s[8:11], s38 offen offset:0 sc1
    v_mfma_f32_16x16x32_bf16 v[44:47], v[156:159], v[144:147], v[44:47]
    buffer_load_dwordx4 v[112:115], v10, s[8:11], s38 offen offset:0 sc1
    v_mfma_f32_16x16x32_bf16 v[64:67], v[156:159], v[148:151], v[64:67]
    buffer_load_dwordx4 v[116:119], v11, s[8:11], s38 offen offset:0 sc1
    v_mfma_f32_16x16x32_bf16 v[84:87], v[156:159], v[152:155], v[84:87]
    ds_read_b128 v[120:123], v248 offset:10240
    v_mfma_f32_16x16x32_bf16 v[28:31], v[160:163], v[140:143], v[28:31]
    ds_read_b128 v[124:127], v248 offset:11264
    v_mfma_f32_16x16x32_bf16 v[48:51], v[160:163], v[144:147], v[48:51]
    ds_read_b128 v[128:131], v248 offset:12288
    v_mfma_f32_16x16x32_bf16 v[68:71], v[160:163], v[148:151], v[68:71]
    ds_read_b128 v[132:135], v248 offset:13312
    v_mfma_f32_16x16x32_bf16 v[88:91], v[160:163], v[152:155], v[88:91]
    ds_read_b128 v[136:139], v248 offset:14336
    v_mfma_f32_16x16x32_bf16 v[32:35], v[164:167], v[140:143], v[32:35]
    v_mfma_f32_16x16x32_bf16 v[52:55], v[164:167], v[144:147], v[52:55]
    v_mfma_f32_16x16x32_bf16 v[72:75], v[164:167], v[148:151], v[72:75]
    v_mfma_f32_16x16x32_bf16 v[92:95], v[164:167], v[152:155], v[92:95]
    v_mfma_f32_16x16x32_bf16 v[36:39], v[168:171], v[140:143], v[36:39]
    v_mfma_f32_16x16x32_bf16 v[56:59], v[168:171], v[144:147], v[56:59]
    v_mfma_f32_16x16x32_bf16 v[76:79], v[168:171], v[148:151], v[76:79]
    v_mfma_f32_16x16x32_bf16 v[96:99], v[168:171], v[152:155], v[96:99]
    v_mfma_f32_16x16x32_bf16 v[40:43], v[172:175], v[140:143], v[40:43]
    v_mfma_f32_16x16x32_bf16 v[60:63], v[172:175], v[144:147], v[60:63]
    v_mfma_f32_16x16x32_bf16 v[80:83], v[172:175], v[148:151], v[80:83]
    v_mfma_f32_16x16x32_bf16 v[100:103], v[172:175], v[152:155], v[100:103]
    s_waitcnt vmcnt(8)
    s_waitcnt lgkmcnt(0)
    buffer_load_dwordx4 v[156:159], v12, s[12:15], s38 offen offset:1024 sc1
    v_mfma_f32_16x16x32_bf16 v[24:27], v[192:195], v[176:179], v[24:27]
    buffer_load_dwordx4 v[140:143], v8, s[8:11], s38 offen offset:1024 sc1
    v_mfma_f32_16x16x32_bf16 v[44:47], v[192:195], v[180:183], v[44:47]
    buffer_load_dwordx4 v[160:163], v13, s[12:15], s38 offen offset:1024 sc1
    v_mfma_f32_16x16x32_bf16 v[64:67], v[192:195], v[184:187], v[64:67]
    buffer_load_dwordx4 v[144:147], v9, s[8:11], s38 offen offset:1024 sc1
    v_mfma_f32_16x16x32_bf16 v[84:87], v[192:195], v[188:191], v[84:87]
    buffer_load_dwordx4 v[164:167], v14, s[12:15], s38 offen offset:1024 sc1
    v_mfma_f32_16x16x32_bf16 v[28:31], v[196:199], v[176:179], v[28:31]
    buffer_load_dwordx4 v[148:151], v10, s[8:11], s38 offen offset:1024 sc1
    v_mfma_f32_16x16x32_bf16 v[48:51], v[196:199], v[180:183], v[48:51]
    buffer_load_dwordx4 v[168:171], v15, s[12:15], s38 offen offset:1024 sc1
    v_mfma_f32_16x16x32_bf16 v[68:71], v[196:199], v[184:187], v[68:71]
    buffer_load_dwordx4 v[152:155], v11, s[8:11], s38 offen offset:1024 sc1
    v_mfma_f32_16x16x32_bf16 v[88:91], v[196:199], v[188:191], v[88:91]
    buffer_load_dwordx4 v[172:175], v16, s[12:15], s38 offen offset:1024 sc1
    v_mfma_f32_16x16x32_bf16 v[32:35], v[200:203], v[176:179], v[32:35]
    v_mfma_f32_16x16x32_bf16 v[52:55], v[200:203], v[180:183], v[52:55]
    v_mfma_f32_16x16x32_bf16 v[72:75], v[200:203], v[184:187], v[72:75]
    v_mfma_f32_16x16x32_bf16 v[92:95], v[200:203], v[188:191], v[92:95]
    v_mfma_f32_16x16x32_bf16 v[36:39], v[204:207], v[176:179], v[36:39]
    v_mfma_f32_16x16x32_bf16 v[56:59], v[204:207], v[180:183], v[56:59]
    v_mfma_f32_16x16x32_bf16 v[76:79], v[204:207], v[184:187], v[76:79]
    v_mfma_f32_16x16x32_bf16 v[96:99], v[204:207], v[188:191], v[96:99]
    v_mfma_f32_16x16x32_bf16 v[40:43], v[208:211], v[176:179], v[40:43]
    v_mfma_f32_16x16x32_bf16 v[60:63], v[208:211], v[180:183], v[60:63]
    v_mfma_f32_16x16x32_bf16 v[80:83], v[208:211], v[184:187], v[80:83]
    v_mfma_f32_16x16x32_bf16 v[100:103], v[208:211], v[188:191], v[100:103]
    s_waitcnt vmcnt(13)
    s_waitcnt lgkmcnt(0)
    buffer_load_dwordx4 v[192:195], v12, s[12:15], s38 offen offset:2048 sc1
    v_mfma_f32_16x16x32_bf16 v[24:27], v[228:231], v[212:215], v[24:27]
    buffer_load_dwordx4 v[176:179], v8, s[8:11], s38 offen offset:2048 sc1
    v_mfma_f32_16x16x32_bf16 v[44:47], v[228:231], v[216:219], v[44:47]
    buffer_load_dwordx4 v[196:199], v13, s[12:15], s38 offen offset:2048 sc1
    v_mfma_f32_16x16x32_bf16 v[64:67], v[228:231], v[220:223], v[64:67]
    buffer_load_dwordx4 v[180:183], v9, s[8:11], s38 offen offset:2048 sc1
    v_mfma_f32_16x16x32_bf16 v[84:87], v[228:231], v[224:227], v[84:87]
    buffer_load_dwordx4 v[200:203], v14, s[12:15], s38 offen offset:2048 sc1
    v_mfma_f32_16x16x32_bf16 v[28:31], v[232:235], v[212:215], v[28:31]
    buffer_load_dwordx4 v[184:187], v10, s[8:11], s38 offen offset:2048 sc1
    v_mfma_f32_16x16x32_bf16 v[48:51], v[232:235], v[216:219], v[48:51]
    buffer_load_dwordx4 v[204:207], v15, s[12:15], s38 offen offset:2048 sc1
    v_mfma_f32_16x16x32_bf16 v[68:71], v[232:235], v[220:223], v[68:71]
    buffer_load_dwordx4 v[188:191], v11, s[8:11], s38 offen offset:2048 sc1
    v_mfma_f32_16x16x32_bf16 v[88:91], v[232:235], v[224:227], v[88:91]
    buffer_load_dwordx4 v[208:211], v16, s[12:15], s38 offen offset:2048 sc1
    v_mfma_f32_16x16x32_bf16 v[32:35], v[236:239], v[212:215], v[32:35]
    v_mfma_f32_16x16x32_bf16 v[52:55], v[236:239], v[216:219], v[52:55]
    v_mfma_f32_16x16x32_bf16 v[72:75], v[236:239], v[220:223], v[72:75]
    v_mfma_f32_16x16x32_bf16 v[92:95], v[236:239], v[224:227], v[92:95]
    v_mfma_f32_16x16x32_bf16 v[36:39], v[240:243], v[212:215], v[36:39]
    v_mfma_f32_16x16x32_bf16 v[56:59], v[240:243], v[216:219], v[56:59]
    v_mfma_f32_16x16x32_bf16 v[76:79], v[240:243], v[220:223], v[76:79]
    v_mfma_f32_16x16x32_bf16 v[96:99], v[240:243], v[224:227], v[96:99]
    v_mfma_f32_16x16x32_bf16 v[40:43], v[244:247], v[212:215], v[40:43]
    v_mfma_f32_16x16x32_bf16 v[60:63], v[244:247], v[216:219], v[60:63]
    v_mfma_f32_16x16x32_bf16 v[80:83], v[244:247], v[220:223], v[80:83]
    v_mfma_f32_16x16x32_bf16 v[100:103], v[244:247], v[224:227], v[100:103]
    s_waitcnt vmcnt(18)
    s_waitcnt lgkmcnt(0)
    buffer_load_dwordx4 v[228:231], v12, s[12:15], s38 offen offset:3072 sc1
    v_mfma_f32_16x16x32_bf16 v[24:27], v[120:123], v[104:107], v[24:27]
    buffer_load_dwordx4 v[212:215], v8, s[8:11], s38 offen offset:3072 sc1
    v_mfma_f32_16x16x32_bf16 v[44:47], v[120:123], v[108:111], v[44:47]
    buffer_load_dwordx4 v[232:235], v13, s[12:15], s38 offen offset:3072 sc1
    v_mfma_f32_16x16x32_bf16 v[64:67], v[120:123], v[112:115], v[64:67]
    buffer_load_dwordx4 v[216:219], v9, s[8:11], s38 offen offset:3072 sc1
    v_mfma_f32_16x16x32_bf16 v[84:87], v[120:123], v[116:119], v[84:87]
    buffer_load_dwordx4 v[236:239], v14, s[12:15], s38 offen offset:3072 sc1
    v_mfma_f32_16x16x32_bf16 v[28:31], v[124:127], v[104:107], v[28:31]
    buffer_load_dwordx4 v[220:223], v10, s[8:11], s38 offen offset:3072 sc1
    v_mfma_f32_16x16x32_bf16 v[48:51], v[124:127], v[108:111], v[48:51]
    buffer_load_dwordx4 v[240:243], v15, s[12:15], s38 offen offset:3072 sc1
    v_mfma_f32_16x16x32_bf16 v[68:71], v[124:127], v[112:115], v[68:71]
    buffer_load_dwordx4 v[224:227], v11, s[8:11], s38 offen offset:3072 sc1
    v_mfma_f32_16x16x32_bf16 v[88:91], v[124:127], v[116:119], v[88:91]
    buffer_load_dwordx4 v[244:247], v16, s[12:15], s38 offen offset:3072 sc1
    v_mfma_f32_16x16x32_bf16 v[32:35], v[128:131], v[104:107], v[32:35]
    v_mfma_f32_16x16x32_bf16 v[52:55], v[128:131], v[108:111], v[52:55]
    v_mfma_f32_16x16x32_bf16 v[72:75], v[128:131], v[112:115], v[72:75]
    v_mfma_f32_16x16x32_bf16 v[92:95], v[128:131], v[116:119], v[92:95]
    v_mfma_f32_16x16x32_bf16 v[36:39], v[132:135], v[104:107], v[36:39]
    v_mfma_f32_16x16x32_bf16 v[56:59], v[132:135], v[108:111], v[56:59]
    v_mfma_f32_16x16x32_bf16 v[76:79], v[132:135], v[112:115], v[76:79]
    v_mfma_f32_16x16x32_bf16 v[96:99], v[132:135], v[116:119], v[96:99]
    v_mfma_f32_16x16x32_bf16 v[40:43], v[136:139], v[104:107], v[40:43]
    v_mfma_f32_16x16x32_bf16 v[60:63], v[136:139], v[108:111], v[60:63]
    v_mfma_f32_16x16x32_bf16 v[80:83], v[136:139], v[112:115], v[80:83]
    v_mfma_f32_16x16x32_bf16 v[100:103], v[136:139], v[116:119], v[100:103]
    s_waitcnt vmcnt(18)
    s_add_u32 s38, s38, 4096
    buffer_load_dwordx4 v[120:123], v12, s[12:15], s38 offen offset:0 sc1
    v_mfma_f32_16x16x32_bf16 v[24:27], v[156:159], v[140:143], v[24:27]
    buffer_load_dwordx4 v[104:107], v8, s[8:11], s38 offen offset:0 sc1
    v_mfma_f32_16x16x32_bf16 v[44:47], v[156:159], v[144:147], v[44:47]
    buffer_load_dwordx4 v[124:127], v13, s[12:15], s38 offen offset:0 sc1
    v_mfma_f32_16x16x32_bf16 v[64:67], v[156:159], v[148:151], v[64:67]
    buffer_load_dwordx4 v[108:111], v9, s[8:11], s38 offen offset:0 sc1
    v_mfma_f32_16x16x32_bf16 v[84:87], v[156:159], v[152:155], v[84:87]
    buffer_load_dwordx4 v[128:131], v14, s[12:15], s38 offen offset:0 sc1
    v_mfma_f32_16x16x32_bf16 v[28:31], v[160:163], v[140:143], v[28:31]
    buffer_load_dwordx4 v[112:115], v10, s[8:11], s38 offen offset:0 sc1
    v_mfma_f32_16x16x32_bf16 v[48:51], v[160:163], v[144:147], v[48:51]
    buffer_load_dwordx4 v[132:135], v15, s[12:15], s38 offen offset:0 sc1
    v_mfma_f32_16x16x32_bf16 v[68:71], v[160:163], v[148:151], v[68:71]
    buffer_load_dwordx4 v[116:119], v11, s[8:11], s38 offen offset:0 sc1
    v_mfma_f32_16x16x32_bf16 v[88:91], v[160:163], v[152:155], v[88:91]
    buffer_load_dwordx4 v[136:139], v16, s[12:15], s38 offen offset:0 sc1
    v_mfma_f32_16x16x32_bf16 v[32:35], v[164:167], v[140:143], v[32:35]
    v_mfma_f32_16x16x32_bf16 v[52:55], v[164:167], v[144:147], v[52:55]
    v_mfma_f32_16x16x32_bf16 v[72:75], v[164:167], v[148:151], v[72:75]
    v_mfma_f32_16x16x32_bf16 v[92:95], v[164:167], v[152:155], v[92:95]
    v_mfma_f32_16x16x32_bf16 v[36:39], v[168:171], v[140:143], v[36:39]
    v_mfma_f32_16x16x32_bf16 v[56:59], v[168:171], v[144:147], v[56:59]
    v_mfma_f32_16x16x32_bf16 v[76:79], v[168:171], v[148:151], v[76:79]
    v_mfma_f32_16x16x32_bf16 v[96:99], v[168:171], v[152:155], v[96:99]
    v_mfma_f32_16x16x32_bf16 v[40:43], v[172:175], v[140:143], v[40:43]
    v_mfma_f32_16x16x32_bf16 v[60:63], v[172:175], v[144:147], v[60:63]
    v_mfma_f32_16x16x32_bf16 v[80:83], v[172:175], v[148:151], v[80:83]
    v_mfma_f32_16x16x32_bf16 v[100:103], v[172:175], v[152:155], v[100:103]
    s_waitcnt vmcnt(18)
    buffer_load_dwordx4 v[156:159], v12, s[12:15], s38 offen offset:1024 sc1
    v_mfma_f32_16x16x32_bf16 v[24:27], v[192:195], v[176:179], v[24:27]
    buffer_load_dwordx4 v[140:143], v8, s[8:11], s38 offen offset:1024 sc1
    v_mfma_f32_16x16x32_bf16 v[44:47], v[192:195], v[180:183], v[44:47]
    buffer_load_dwordx4 v[160:163], v13, s[12:15], s38 offen offset:1024 sc1
    v_mfma_f32_16x16x32_bf16 v[64:67], v[192:195], v[184:187], v[64:67]
    buffer_load_dwordx4 v[144:147], v9, s[8:11], s38 offen offset:1024 sc1
    v_mfma_f32_16x16x32_bf16 v[84:87], v[192:195], v[188:191], v[84:87]
    buffer_load_dwordx4 v[164:167], v14, s[12:15], s38 offen offset:1024 sc1
    v_mfma_f32_16x16x32_bf16 v[28:31], v[196:199], v[176:179], v[28:31]
    buffer_load_dwordx4 v[148:151], v10, s[8:11], s38 offen offset:1024 sc1
    v_mfma_f32_16x16x32_bf16 v[48:51], v[196:199], v[180:183], v[48:51]
    buffer_load_dwordx4 v[168:171], v15, s[12:15], s38 offen offset:1024 sc1
    v_mfma_f32_16x16x32_bf16 v[68:71], v[196:199], v[184:187], v[68:71]
    buffer_load_dwordx4 v[152:155], v11, s[8:11], s38 offen offset:1024 sc1
    v_mfma_f32_16x16x32_bf16 v[88:91], v[196:199], v[188:191], v[88:91]
    buffer_load_dwordx4 v[172:175], v16, s[12:15], s38 offen offset:1024 sc1
    v_mfma_f32_16x16x32_bf16 v[32:35], v[200:203], v[176:179], v[32:35]
    v_mfma_f32_16x16x32_bf16 v[52:55], v[200:203], v[180:183], v[52:55]
    v_mfma_f32_16x16x32_bf16 v[72:75], v[200:203], v[184:187], v[72:75]
    v_mfma_f32_16x16x32_bf16 v[92:95], v[200:203], v[188:191], v[92:95]
    v_mfma_f32_16x16x32_bf16 v[36:39], v[204:207], v[176:179], v[36:39]
    v_mfma_f32_16x16x32_bf16 v[56:59], v[204:207], v[180:183], v[56:59]
    v_mfma_f32_16x16x32_bf16 v[76:79], v[204:207], v[184:187], v[76:79]
    v_mfma_f32_16x16x32_bf16 v[96:99], v[204:207], v[188:191], v[96:99]
    v_mfma_f32_16x16x32_bf16 v[40:43], v[208:211], v[176:179], v[40:43]
    v_mfma_f32_16x16x32_bf16 v[60:63], v[208:211], v[180:183], v[60:63]
    v_mfma_f32_16x16x32_bf16 v[80:83], v[208:211], v[184:187], v[80:83]
    v_mfma_f32_16x16x32_bf16 v[100:103], v[208:211], v[188:191], v[100:103]
    s_waitcnt vmcnt(18)
    buffer_load_dwordx4 v[192:195], v12, s[12:15], s38 offen offset:2048 sc1
    v_mfma_f32_16x16x32_bf16 v[24:27], v[228:231], v[212:215], v[24:27]
    buffer_load_dwordx4 v[176:179], v8, s[8:11], s38 offen offset:2048 sc1
    v_mfma_f32_16x16x32_bf16 v[44:47], v[228:231], v[216:219], v[44:47]
    buffer_load_dwordx4 v[196:199], v13, s[12:15], s38 offen offset:2048 sc1
    v_mfma_f32_16x16x32_bf16 v[64:67], v[228:231], v[220:223], v[64:67]
    buffer_load_dwordx4 v[180:183], v9, s[8:11], s38 offen offset:2048 sc1
    v_mfma_f32_16x16x32_bf16 v[84:87], v[228:231], v[224:227], v[84:87]
    buffer_load_dwordx4 v[200:203], v14, s[12:15], s38 offen offset:2048 sc1
    v_mfma_f32_16x16x32_bf16 v[28:31], v[232:235], v[212:215], v[28:31]
    buffer_load_dwordx4 v[184:187], v10, s[8:11], s38 offen offset:2048 sc1
    v_mfma_f32_16x16x32_bf16 v[48:51], v[232:235], v[216:219], v[48:51]
    buffer_load_dwordx4 v[204:207], v15, s[12:15], s38 offen offset:2048 sc1
    v_mfma_f32_16x16x32_bf16 v[68:71], v[232:235], v[220:223], v[68:71]
    buffer_load_dwordx4 v[188:191], v11, s[8:11], s38 offen offset:2048 sc1
    v_mfma_f32_16x16x32_bf16 v[88:91], v[232:235], v[224:227], v[88:91]
    buffer_load_dwordx4 v[208:211], v16, s[12:15], s38 offen offset:2048 sc1
    v_mfma_f32_16x16x32_bf16 v[32:35], v[236:239], v[212:215], v[32:35]
    v_mfma_f32_16x16x32_bf16 v[52:55], v[236:239], v[216:219], v[52:55]
    v_mfma_f32_16x16x32_bf16 v[72:75], v[236:239], v[220:223], v[72:75]
    v_mfma_f32_16x16x32_bf16 v[92:95], v[236:239], v[224:227], v[92:95]
    v_mfma_f32_16x16x32_bf16 v[36:39], v[240:243], v[212:215], v[36:39]
    v_mfma_f32_16x16x32_bf16 v[56:59], v[240:243], v[216:219], v[56:59]
    v_mfma_f32_16x16x32_bf16 v[76:79], v[240:243], v[220:223], v[76:79]
    v_mfma_f32_16x16x32_bf16 v[96:99], v[240:243], v[224:227], v[96:99]
    v_mfma_f32_16x16x32_bf16 v[40:43], v[244:247], v[212:215], v[40:43]
    v_mfma_f32_16x16x32_bf16 v[60:63], v[244:247], v[216:219], v[60:63]
    v_mfma_f32_16x16x32_bf16 v[80:83], v[244:247], v[220:223], v[80:83]
    v_mfma_f32_16x16x32_bf16 v[100:103], v[244:247], v[224:227], v[100:103]
    s_waitcnt vmcnt(18)
    buffer_load_dwordx4 v[228:231], v12, s[12:15], s38 offen offset:3072 sc1
    v_mfma_f32_16x16x32_bf16 v[24:27], v[120:123], v[104:107], v[24:27]
    buffer_load_dwordx4 v[212:215], v8, s[8:11], s38 offen offset:3072 sc1
    v_mfma_f32_16x16x32_bf16 v[44:47], v[120:123], v[108:111], v[44:47]
    buffer_load_dwordx4 v[232:235], v13, s[12:15], s38 offen offset:3072 sc1
    v_mfma_f32_16x16x32_bf16 v[64:67], v[120:123], v[112:115], v[64:67]
    buffer_load_dwordx4 v[216:219], v9, s[8:11], s38 offen offset:3072 sc1
    v_mfma_f32_16x16x32_bf16 v[84:87], v[120:123], v[116:119], v[84:87]
    buffer_load_dwordx4 v[236:239], v14, s[12:15], s38 offen offset:3072 sc1
    v_mfma_f32_16x16x32_bf16 v[28:31], v[124:127], v[104:107], v[28:31]
    buffer_load_dwordx4 v[220:223], v10, s[8:11], s38 offen offset:3072 sc1
    v_mfma_f32_16x16x32_bf16 v[48:51], v[124:127], v[108:111], v[48:51]
    buffer_load_dwordx4 v[240:243], v15, s[12:15], s38 offen offset:3072 sc1
    v_mfma_f32_16x16x32_bf16 v[68:71], v[124:127], v[112:115], v[68:71]
    buffer_load_dwordx4 v[224:227], v11, s[8:11], s38 offen offset:3072 sc1
    v_mfma_f32_16x16x32_bf16 v[88:91], v[124:127], v[116:119], v[88:91]
    buffer_load_dwordx4 v[244:247], v16, s[12:15], s38 offen offset:3072 sc1
    v_mfma_f32_16x16x32_bf16 v[32:35], v[128:131], v[104:107], v[32:35]
    v_mfma_f32_16x16x32_bf16 v[52:55], v[128:131], v[108:111], v[52:55]
    v_mfma_f32_16x16x32_bf16 v[72:75], v[128:131], v[112:115], v[72:75]
    v_mfma_f32_16x16x32_bf16 v[92:95], v[128:131], v[116:119], v[92:95]
    v_mfma_f32_16x16x32_bf16 v[36:39], v[132:135], v[104:107], v[36:39]
    v_mfma_f32_16x16x32_bf16 v[56:59], v[132:135], v[108:111], v[56:59]
    v_mfma_f32_16x16x32_bf16 v[76:79], v[132:135], v[112:115], v[76:79]
    v_mfma_f32_16x16x32_bf16 v[96:99], v[132:135], v[116:119], v[96:99]
    v_mfma_f32_16x16x32_bf16 v[40:43], v[136:139], v[104:107], v[40:43]
    v_mfma_f32_16x16x32_bf16 v[60:63], v[136:139], v[108:111], v[60:63]
    v_mfma_f32_16x16x32_bf16 v[80:83], v[136:139], v[112:115], v[80:83]
    v_mfma_f32_16x16x32_bf16 v[100:103], v[136:139], v[116:119], v[100:103]
    s_waitcnt vmcnt(18)
    s_add_u32 s38, s38, 4096
    buffer_load_dwordx4 v[120:123], v12, s[12:15], s38 offen offset:0 sc1
    v_mfma_f32_16x16x32_bf16 v[24:27], v[156:159], v[140:143], v[24:27]
    buffer_load_dwordx4 v[104:107], v8, s[8:11], s38 offen offset:0 sc1
    v_mfma_f32_16x16x32_bf16 v[44:47], v[156:159], v[144:147], v[44:47]
    buffer_load_dwordx4 v[124:127], v13, s[12:15], s38 offen offset:0 sc1
    v_mfma_f32_16x16x32_bf16 v[64:67], v[156:159], v[148:151], v[64:67]
    buffer_load_dwordx4 v[108:111], v9, s[8:11], s38 offen offset:0 sc1
    v_mfma_f32_16x16x32_bf16 v[84:87], v[156:159], v[152:155], v[84:87]
    buffer_load_dwordx4 v[128:131], v14, s[12:15], s38 offen offset:0 sc1
    v_mfma_f32_16x16x32_bf16 v[28:31], v[160:163], v[140:143], v[28:31]
    buffer_load_dwordx4 v[112:115], v10, s[8:11], s38 offen offset:0 sc1
    v_mfma_f32_16x16x32_bf16 v[48:51], v[160:163], v[144:147], v[48:51]
    buffer_load_dwordx4 v[132:135], v15, s[12:15], s38 offen offset:0 sc1
    v_mfma_f32_16x16x32_bf16 v[68:71], v[160:163], v[148:151], v[68:71]
    buffer_load_dwordx4 v[116:119], v11, s[8:11], s38 offen offset:0 sc1
    v_mfma_f32_16x16x32_bf16 v[88:91], v[160:163], v[152:155], v[88:91]
    buffer_load_dwordx4 v[136:139], v16, s[12:15], s38 offen offset:0 sc1
    v_mfma_f32_16x16x32_bf16 v[32:35], v[164:167], v[140:143], v[32:35]
    v_mfma_f32_16x16x32_bf16 v[52:55], v[164:167], v[144:147], v[52:55]
    v_mfma_f32_16x16x32_bf16 v[72:75], v[164:167], v[148:151], v[72:75]
    v_mfma_f32_16x16x32_bf16 v[92:95], v[164:167], v[152:155], v[92:95]
    v_mfma_f32_16x16x32_bf16 v[36:39], v[168:171], v[140:143], v[36:39]
    v_mfma_f32_16x16x32_bf16 v[56:59], v[168:171], v[144:147], v[56:59]
    v_mfma_f32_16x16x32_bf16 v[76:79], v[168:171], v[148:151], v[76:79]
    v_mfma_f32_16x16x32_bf16 v[96:99], v[168:171], v[152:155], v[96:99]
    v_mfma_f32_16x16x32_bf16 v[40:43], v[172:175], v[140:143], v[40:43]
    v_mfma_f32_16x16x32_bf16 v[60:63], v[172:175], v[144:147], v[60:63]
    v_mfma_f32_16x16x32_bf16 v[80:83], v[172:175], v[148:151], v[80:83]
    v_mfma_f32_16x16x32_bf16 v[100:103], v[172:175], v[152:155], v[100:103]
    s_waitcnt vmcnt(18)
    buffer_load_dwordx4 v[156:159], v12, s[12:15], s38 offen offset:1024 sc1
    v_mfma_f32_16x16x32_bf16 v[24:27], v[192:195], v[176:179], v[24:27]
    buffer_load_dwordx4 v[140:143], v8, s[8:11], s38 offen offset:1024 sc1
    v_mfma_f32_16x16x32_bf16 v[44:47], v[192:195], v[180:183], v[44:47]
    buffer_load_dwordx4 v[160:163], v13, s[12:15], s38 offen offset:1024 sc1
    v_mfma_f32_16x16x32_bf16 v[64:67], v[192:195], v[184:187], v[64:67]
    buffer_load_dwordx4 v[144:147], v9, s[8:11], s38 offen offset:1024 sc1
    v_mfma_f32_16x16x32_bf16 v[84:87], v[192:195], v[188:191], v[84:87]
    buffer_load_dwordx4 v[164:167], v14, s[12:15], s38 offen offset:1024 sc1
    v_mfma_f32_16x16x32_bf16 v[28:31], v[196:199], v[176:179], v[28:31]
    buffer_load_dwordx4 v[148:151], v10, s[8:11], s38 offen offset:1024 sc1
    v_mfma_f32_16x16x32_bf16 v[48:51], v[196:199], v[180:183], v[48:51]
    buffer_load_dwordx4 v[168:171], v15, s[12:15], s38 offen offset:1024 sc1
    v_mfma_f32_16x16x32_bf16 v[68:71], v[196:199], v[184:187], v[68:71]
    buffer_load_dwordx4 v[152:155], v11, s[8:11], s38 offen offset:1024 sc1
    v_mfma_f32_16x16x32_bf16 v[88:91], v[196:199], v[188:191], v[88:91]
    buffer_load_dwordx4 v[172:175], v16, s[12:15], s38 offen offset:1024 sc1
    v_mfma_f32_16x16x32_bf16 v[32:35], v[200:203], v[176:179], v[32:35]
    v_mfma_f32_16x16x32_bf16 v[52:55], v[200:203], v[180:183], v[52:55]
    v_mfma_f32_16x16x32_bf16 v[72:75], v[200:203], v[184:187], v[72:75]
    v_mfma_f32_16x16x32_bf16 v[92:95], v[200:203], v[188:191], v[92:95]
    v_mfma_f32_16x16x32_bf16 v[36:39], v[204:207], v[176:179], v[36:39]
    v_mfma_f32_16x16x32_bf16 v[56:59], v[204:207], v[180:183], v[56:59]
    v_mfma_f32_16x16x32_bf16 v[76:79], v[204:207], v[184:187], v[76:79]
    v_mfma_f32_16x16x32_bf16 v[96:99], v[204:207], v[188:191], v[96:99]
    v_mfma_f32_16x16x32_bf16 v[40:43], v[208:211], v[176:179], v[40:43]
    v_mfma_f32_16x16x32_bf16 v[60:63], v[208:211], v[180:183], v[60:63]
    v_mfma_f32_16x16x32_bf16 v[80:83], v[208:211], v[184:187], v[80:83]
    v_mfma_f32_16x16x32_bf16 v[100:103], v[208:211], v[188:191], v[100:103]
    s_lshl_b32 s34, s36, 8
    s_add_u32 s34, s34, 1851392
    v_lshlrev_b32 v3, 8, v1
    v_mov_b32 v2, 2146435072
    v_cmp_gt_u32 vcc, 5, v1
    s_nop 1
    v_cndmask_b32 v3, v2, v3, vcc
    s_waitcnt vmcnt(18)
    v_mfma_f32_16x16x32_bf16 v[24:27], v[228:231], v[212:215], v[24:27]
    v_mfma_f32_16x16x32_bf16 v[44:47], v[228:231], v[216:219], v[44:47]
    v_mfma_f32_16x16x32_bf16 v[64:67], v[228:231], v[220:223], v[64:67]
    v_mfma_f32_16x16x32_bf16 v[84:87], v[228:231], v[224:227], v[84:87]
    v_mfma_f32_16x16x32_bf16 v[28:31], v[232:235], v[212:215], v[28:31]
    v_mfma_f32_16x16x32_bf16 v[48:51], v[232:235], v[216:219], v[48:51]
    v_mfma_f32_16x16x32_bf16 v[68:71], v[232:235], v[220:223], v[68:71]
    v_mfma_f32_16x16x32_bf16 v[88:91], v[232:235], v[224:227], v[88:91]
    v_mfma_f32_16x16x32_bf16 v[32:35], v[236:239], v[212:215], v[32:35]
    v_mfma_f32_16x16x32_bf16 v[52:55], v[236:239], v[216:219], v[52:55]
    v_mfma_f32_16x16x32_bf16 v[72:75], v[236:239], v[220:223], v[72:75]
    v_mfma_f32_16x16x32_bf16 v[92:95], v[236:239], v[224:227], v[92:95]
    v_mfma_f32_16x16x32_bf16 v[36:39], v[240:243], v[212:215], v[36:39]
    v_mfma_f32_16x16x32_bf16 v[56:59], v[240:243], v[216:219], v[56:59]
    v_mfma_f32_16x16x32_bf16 v[76:79], v[240:243], v[220:223], v[76:79]
    v_mfma_f32_16x16x32_bf16 v[96:99], v[240:243], v[224:227], v[96:99]
    v_mfma_f32_16x16x32_bf16 v[40:43], v[244:247], v[212:215], v[40:43]
    v_mfma_f32_16x16x32_bf16 v[60:63], v[244:247], v[216:219], v[60:63]
    v_mfma_f32_16x16x32_bf16 v[80:83], v[244:247], v[220:223], v[80:83]
    v_mfma_f32_16x16x32_bf16 v[100:103], v[244:247], v[224:227], v[100:103]
recurrent_scan__ssm_conv_h3__mixer_gmlp__prompt_kernel_poll85:
    buffer_load_dword v2, v3, s[48:51], s34 offen sc1
    s_waitcnt vmcnt(0)
    v_cmp_gt_u32 vcc, 16, v2
    s_and_b32 s55, vcc_lo, 31
    s_cmp_lg_u32 s55, 0
    s_cbranch_scc1 recurrent_scan__ssm_conv_h3__mixer_gmlp__prompt_kernel_poll85
    v_lshrrev_b32 v3, 2, v1
    v_lshlrev_b32 v2, 12, v3
    v_and_b32 v3, 3, v1
    v_lshl_add_u32 v2, v3, 4, v2
    s_lshl_b32 s34, s35, 12
    s_lshr_b32 s55, s28, 1
    s_lshl_b32 s55, s55, 6
    s_add_u32 s34, s34, s55
    s_lshl_b32 s55, s37, 1
    s_add_u32 s34, s34, s55
    buffer_load_dwordx4 v[176:179], v2, s[20:23], s34 offen sc1
    s_add_u32 s34, s34, 65536
    buffer_load_dwordx4 v[180:183], v2, s[20:23], s34 offen sc1
    s_add_u32 s34, s34, 65536
    buffer_load_dwordx4 v[184:187], v2, s[20:23], s34 offen sc1
    s_add_u32 s34, s34, 65536
    buffer_load_dwordx4 v[188:191], v2, s[20:23], s34 offen sc1
    s_add_u32 s34, s34, 65536
    buffer_load_dwordx4 v[192:195], v2, s[20:23], s34 offen sc1
    s_waitcnt vmcnt(5)
    v_mfma_f32_16x16x32_bf16 v[24:27], v[120:123], v[104:107], v[24:27]
    v_mfma_f32_16x16x32_bf16 v[44:47], v[120:123], v[108:111], v[44:47]
    v_mfma_f32_16x16x32_bf16 v[64:67], v[120:123], v[112:115], v[64:67]
    v_mfma_f32_16x16x32_bf16 v[84:87], v[120:123], v[116:119], v[84:87]
    v_mfma_f32_16x16x32_bf16 v[28:31], v[124:127], v[104:107], v[28:31]
    v_mfma_f32_16x16x32_bf16 v[48:51], v[124:127], v[108:111], v[48:51]
    v_mfma_f32_16x16x32_bf16 v[68:71], v[124:127], v[112:115], v[68:71]
    v_mfma_f32_16x16x32_bf16 v[88:91], v[124:127], v[116:119], v[88:91]
    v_mfma_f32_16x16x32_bf16 v[32:35], v[128:131], v[104:107], v[32:35]
    v_mfma_f32_16x16x32_bf16 v[52:55], v[128:131], v[108:111], v[52:55]
    v_mfma_f32_16x16x32_bf16 v[72:75], v[128:131], v[112:115], v[72:75]
    v_mfma_f32_16x16x32_bf16 v[92:95], v[128:131], v[116:119], v[92:95]
    v_mfma_f32_16x16x32_bf16 v[36:39], v[132:135], v[104:107], v[36:39]
    v_mfma_f32_16x16x32_bf16 v[56:59], v[132:135], v[108:111], v[56:59]
    v_mfma_f32_16x16x32_bf16 v[76:79], v[132:135], v[112:115], v[76:79]
    v_mfma_f32_16x16x32_bf16 v[96:99], v[132:135], v[116:119], v[96:99]
    v_mfma_f32_16x16x32_bf16 v[40:43], v[136:139], v[104:107], v[40:43]
    v_mfma_f32_16x16x32_bf16 v[60:63], v[136:139], v[108:111], v[60:63]
    v_mfma_f32_16x16x32_bf16 v[80:83], v[136:139], v[112:115], v[80:83]
    v_mfma_f32_16x16x32_bf16 v[100:103], v[136:139], v[116:119], v[100:103]
    s_waitcnt vmcnt(5)
    v_mfma_f32_16x16x32_bf16 v[24:27], v[156:159], v[140:143], v[24:27]
    v_mfma_f32_16x16x32_bf16 v[44:47], v[156:159], v[144:147], v[44:47]
    v_mfma_f32_16x16x32_bf16 v[64:67], v[156:159], v[148:151], v[64:67]
    v_mfma_f32_16x16x32_bf16 v[84:87], v[156:159], v[152:155], v[84:87]
    v_mfma_f32_16x16x32_bf16 v[28:31], v[160:163], v[140:143], v[28:31]
    v_mfma_f32_16x16x32_bf16 v[48:51], v[160:163], v[144:147], v[48:51]
    v_mfma_f32_16x16x32_bf16 v[68:71], v[160:163], v[148:151], v[68:71]
    v_mfma_f32_16x16x32_bf16 v[88:91], v[160:163], v[152:155], v[88:91]
    v_mfma_f32_16x16x32_bf16 v[32:35], v[164:167], v[140:143], v[32:35]
    v_mfma_f32_16x16x32_bf16 v[52:55], v[164:167], v[144:147], v[52:55]
    v_mfma_f32_16x16x32_bf16 v[72:75], v[164:167], v[148:151], v[72:75]
    v_mfma_f32_16x16x32_bf16 v[92:95], v[164:167], v[152:155], v[92:95]
    v_mfma_f32_16x16x32_bf16 v[36:39], v[168:171], v[140:143], v[36:39]
    v_mfma_f32_16x16x32_bf16 v[56:59], v[168:171], v[144:147], v[56:59]
    v_mfma_f32_16x16x32_bf16 v[76:79], v[168:171], v[148:151], v[76:79]
    v_mfma_f32_16x16x32_bf16 v[96:99], v[168:171], v[152:155], v[96:99]
    v_mfma_f32_16x16x32_bf16 v[40:43], v[172:175], v[140:143], v[40:43]
    v_mfma_f32_16x16x32_bf16 v[60:63], v[172:175], v[144:147], v[60:63]
    v_mfma_f32_16x16x32_bf16 v[80:83], v[172:175], v[148:151], v[80:83]
    v_mfma_f32_16x16x32_bf16 v[100:103], v[172:175], v[152:155], v[100:103]
    s_mul_i32 s54, s28, 5120
    s_mul_i32 s55, s28, 2560
    v_add_u32 v3, s54, v7
    v_add_u32 v3, 95232, v3
    s_waitcnt vmcnt(4)
    ds_write_b128 v3, v[176:179] offset:0
    s_waitcnt vmcnt(3)
    ds_write_b128 v3, v[180:183] offset:1024
    s_waitcnt vmcnt(2)
    ds_write_b128 v3, v[184:187] offset:2048
    s_waitcnt vmcnt(1)
    ds_write_b128 v3, v[188:191] offset:3072
    s_waitcnt vmcnt(0)
    ds_write_b128 v3, v[192:195] offset:4096
    s_mul_i32 s34, s28, 20480
    v_add_u32 v2, s34, v7
    s_waitcnt lgkmcnt(0)
    s_barrier
    ds_write_b128 v2, v[24:27] offset:0
    ds_write_b128 v2, v[28:31] offset:1024
    ds_write_b128 v2, v[32:35] offset:2048
    ds_write_b128 v2, v[36:39] offset:3072
    ds_write_b128 v2, v[40:43] offset:4096
    ds_write_b128 v2, v[44:47] offset:5120
    ds_write_b128 v2, v[48:51] offset:6144
    ds_write_b128 v2, v[52:55] offset:7168
    ds_write_b128 v2, v[56:59] offset:8192
    ds_write_b128 v2, v[60:63] offset:9216
    ds_write_b128 v2, v[64:67] offset:10240
    ds_write_b128 v2, v[68:71] offset:11264
    ds_write_b128 v2, v[72:75] offset:12288
    ds_write_b128 v2, v[76:79] offset:13312
    s_waitcnt lgkmcnt(6)
    ds_write_b128 v2, v[80:83] offset:14336
    ds_write_b128 v2, v[84:87] offset:15360
    ds_write_b128 v2, v[88:91] offset:16384
    ds_write_b128 v2, v[92:95] offset:17408
    ds_write_b128 v2, v[96:99] offset:18432
    ds_write_b128 v2, v[100:103] offset:19456
    s_waitcnt lgkmcnt(0)
    s_barrier
    s_mul_i32 s34, s28, 5120
    v_add_u32 v2, s34, v7
    v_add_u32 v9, 61440, v2
    v_lshrrev_b32 v3, 2, v5
    v_lshl_add_u32 v3, v6, 2, v3
    v_lshlrev_b32 v3, 6, v3
    v_and_b32 v116, 3, v5
    v_lshl_add_u32 v3, v116, 4, v3
    s_and_b32 s58, s28, 1
    s_lshl_b32 s58, s58, 3
    s_add_u32 s54, s54, s58
    v_add_u32 v3, s54, v3
    v_add_u32 v13, 95232, v3
    v_mul_u32_u24 v14, 160, v5
    v_lshl_add_u32 v14, v6, 3, v14
    v_add_u32 v14, s55, v14
    v_add_u32 v14, 84992, v14
    v_mov_b32 v168, 0xbfb8aa3b
    v_mov_b32 v169, 0xbfb8aa3b
    v_mov_b32 v170, 1.0
    v_mov_b32 v171, 1.0
    v_mov_b32 v172, v18
    v_mov_b32 v173, v18
    v_mov_b32 v174, v19
    v_mov_b32 v175, v19
    ds_read_b128 v[24:27], v2 offset:0
    ds_read_b128 v[28:31], v2 offset:20480
    ds_read_b128 v[32:35], v2 offset:40960
    ds_read_b128 v[36:39], v9 offset:0
    ds_read_b64_tr_b16 v[40:41], v13 offset:0
    ds_read_b64 v[42:43], v14 offset:0
    ds_read_b128 v[44:47], v2 offset:1024
    ds_read_b128 v[48:51], v2 offset:21504
    ds_read_b128 v[52:55], v2 offset:41984
    ds_read_b128 v[56:59], v9 offset:1024
    ds_read_b64_tr_b16 v[60:61], v13 offset:1024
    ds_read_b64 v[62:63], v14 offset:32
    s_waitcnt lgkmcnt(6)
    v_pk_add_f32 v[112:113], v[24:25], v[28:29]
    v_pk_add_f32 v[114:115], v[26:27], v[30:31]
    v_pk_add_f32 v[116:117], v[32:33], v[36:37]
    v_pk_add_f32 v[118:119], v[34:35], v[38:39]
    v_lshlrev_b32 v108, 16, v40
    v_and_b32 v109, 0xffff0000, v40
    v_lshlrev_b32 v110, 16, v41
    v_and_b32 v111, 0xffff0000, v41
    v_pk_add_f32 v[112:113], v[112:113], v[116:117]
    v_pk_add_f32 v[114:115], v[114:115], v[118:119]
    v_lshlrev_b32 v104, 16, v42
    v_and_b32 v105, 0xffff0000, v42
    v_lshlrev_b32 v106, 16, v43
    v_and_b32 v107, 0xffff0000, v43
    v_pk_mul_f32 v[116:117], v[112:113], v[168:169]
    v_pk_mul_f32 v[118:119], v[114:115], v[168:169]
    v_pk_add_f32 v[120:121], v[104:105], v[172:173] neg_lo:[0,1] neg_hi:[0,1]
    v_pk_add_f32 v[122:123], v[106:107], v[172:173] neg_lo:[0,1] neg_hi:[0,1]
    v_exp_f32 v116, v116
    v_exp_f32 v117, v117
    v_exp_f32 v118, v118
    v_exp_f32 v119, v119
    v_pk_mul_f32 v[108:109], v[108:109], v[174:175]
    v_pk_mul_f32 v[110:111], v[110:111], v[174:175]
    v_pk_mul_f32 v[120:121], v[120:121], v[112:113]
    v_pk_mul_f32 v[122:123], v[122:123], v[114:115]
    v_pk_add_f32 v[116:117], v[116:117], v[170:171]
    v_pk_add_f32 v[118:119], v[118:119], v[170:171]
    v_pk_mul_f32 v[120:121], v[120:121], v[108:109]
    v_pk_mul_f32 v[122:123], v[122:123], v[110:111]
    v_rcp_f32 v116, v116
    v_rcp_f32 v117, v117
    v_rcp_f32 v118, v118
    v_rcp_f32 v119, v119
    v_pk_fma_f32 v[104:105], v[120:121], v[116:117], v[104:105]
    v_pk_fma_f32 v[106:107], v[122:123], v[118:119], v[106:107]
    v_cvt_pk_bf16_f32 v124, v104, v105
    v_cvt_pk_bf16_f32 v125, v106, v107
    ds_write_b64 v14, v[124:125] offset:0
    ds_read_b128 v[24:27], v2 offset:2048
    ds_read_b128 v[28:31], v2 offset:22528
    ds_read_b128 v[32:35], v2 offset:43008
    ds_read_b128 v[36:39], v9 offset:2048
    ds_read_b64_tr_b16 v[40:41], v13 offset:2048
    ds_read_b64 v[42:43], v14 offset:64
    s_waitcnt lgkmcnt(6)
    v_pk_add_f32 v[112:113], v[44:45], v[48:49]
    v_pk_add_f32 v[114:115], v[46:47], v[50:51]
    v_pk_add_f32 v[116:117], v[52:53], v[56:57]
    v_pk_add_f32 v[118:119], v[54:55], v[58:59]
    v_lshlrev_b32 v108, 16, v60
    v_and_b32 v109, 0xffff0000, v60
    v_lshlrev_b32 v110, 16, v61
    v_and_b32 v111, 0xffff0000, v61
    v_pk_add_f32 v[112:113], v[112:113], v[116:117]
    v_pk_add_f32 v[114:115], v[114:115], v[118:119]
    v_lshlrev_b32 v104, 16, v62
    v_and_b32 v105, 0xffff0000, v62
    v_lshlrev_b32 v106, 16, v63
    v_and_b32 v107, 0xffff0000, v63
    v_pk_mul_f32 v[116:117], v[112:113], v[168:169]
    v_pk_mul_f32 v[118:119], v[114:115], v[168:169]
    v_pk_add_f32 v[120:121], v[104:105], v[172:173] neg_lo:[0,1] neg_hi:[0,1]
    v_pk_add_f32 v[122:123], v[106:107], v[172:173] neg_lo:[0,1] neg_hi:[0,1]
    v_exp_f32 v116, v116
    v_exp_f32 v117, v117
    v_exp_f32 v118, v118
    v_exp_f32 v119, v119
    v_pk_mul_f32 v[108:109], v[108:109], v[174:175]
    v_pk_mul_f32 v[110:111], v[110:111], v[174:175]
    v_pk_mul_f32 v[120:121], v[120:121], v[112:113]
    v_pk_mul_f32 v[122:123], v[122:123], v[114:115]
    v_pk_add_f32 v[116:117], v[116:117], v[170:171]
    v_pk_add_f32 v[118:119], v[118:119], v[170:171]
    v_pk_mul_f32 v[120:121], v[120:121], v[108:109]
    v_pk_mul_f32 v[122:123], v[122:123], v[110:111]
    v_rcp_f32 v116, v116
    v_rcp_f32 v117, v117
    v_rcp_f32 v118, v118
    v_rcp_f32 v119, v119
    v_pk_fma_f32 v[104:105], v[120:121], v[116:117], v[104:105]
    v_pk_fma_f32 v[106:107], v[122:123], v[118:119], v[106:107]
    v_cvt_pk_bf16_f32 v124, v104, v105
    v_cvt_pk_bf16_f32 v125, v106, v107
    ds_write_b64 v14, v[124:125] offset:32
    ds_read_b128 v[44:47], v2 offset:3072
    ds_read_b128 v[48:51], v2 offset:23552
    ds_read_b128 v[52:55], v2 offset:44032
    ds_read_b128 v[56:59], v9 offset:3072
    ds_read_b64_tr_b16 v[60:61], v13 offset:3072
    ds_read_b64 v[62:63], v14 offset:96
    s_waitcnt lgkmcnt(6)
    v_pk_add_f32 v[112:113], v[24:25], v[28:29]
    v_pk_add_f32 v[114:115], v[26:27], v[30:31]
    v_pk_add_f32 v[116:117], v[32:33], v[36:37]
    v_pk_add_f32 v[118:119], v[34:35], v[38:39]
    v_lshlrev_b32 v108, 16, v40
    v_and_b32 v109, 0xffff0000, v40
    v_lshlrev_b32 v110, 16, v41
    v_and_b32 v111, 0xffff0000, v41
    v_pk_add_f32 v[112:113], v[112:113], v[116:117]
    v_pk_add_f32 v[114:115], v[114:115], v[118:119]
    v_lshlrev_b32 v104, 16, v42
    v_and_b32 v105, 0xffff0000, v42
    v_lshlrev_b32 v106, 16, v43
    v_and_b32 v107, 0xffff0000, v43
    v_pk_mul_f32 v[116:117], v[112:113], v[168:169]
    v_pk_mul_f32 v[118:119], v[114:115], v[168:169]
    v_pk_add_f32 v[120:121], v[104:105], v[172:173] neg_lo:[0,1] neg_hi:[0,1]
    v_pk_add_f32 v[122:123], v[106:107], v[172:173] neg_lo:[0,1] neg_hi:[0,1]
    v_exp_f32 v116, v116
    v_exp_f32 v117, v117
    v_exp_f32 v118, v118
    v_exp_f32 v119, v119
    v_pk_mul_f32 v[108:109], v[108:109], v[174:175]
    v_pk_mul_f32 v[110:111], v[110:111], v[174:175]
    v_pk_mul_f32 v[120:121], v[120:121], v[112:113]
    v_pk_mul_f32 v[122:123], v[122:123], v[114:115]
    v_pk_add_f32 v[116:117], v[116:117], v[170:171]
    v_pk_add_f32 v[118:119], v[118:119], v[170:171]
    v_pk_mul_f32 v[120:121], v[120:121], v[108:109]
    v_pk_mul_f32 v[122:123], v[122:123], v[110:111]
    v_rcp_f32 v116, v116
    v_rcp_f32 v117, v117
    v_rcp_f32 v118, v118
    v_rcp_f32 v119, v119
    v_pk_fma_f32 v[104:105], v[120:121], v[116:117], v[104:105]
    v_pk_fma_f32 v[106:107], v[122:123], v[118:119], v[106:107]
    v_cvt_pk_bf16_f32 v124, v104, v105
    v_cvt_pk_bf16_f32 v125, v106, v107
    ds_write_b64 v14, v[124:125] offset:64
    ds_read_b128 v[24:27], v2 offset:4096
    ds_read_b128 v[28:31], v2 offset:24576
    ds_read_b128 v[32:35], v2 offset:45056
    ds_read_b128 v[36:39], v9 offset:4096
    ds_read_b64_tr_b16 v[40:41], v13 offset:4096
    ds_read_b64 v[42:43], v14 offset:128
    s_waitcnt lgkmcnt(6)
    v_pk_add_f32 v[112:113], v[44:45], v[48:49]
    v_pk_add_f32 v[114:115], v[46:47], v[50:51]
    v_pk_add_f32 v[116:117], v[52:53], v[56:57]
    v_pk_add_f32 v[118:119], v[54:55], v[58:59]
    v_lshlrev_b32 v108, 16, v60
    v_and_b32 v109, 0xffff0000, v60
    v_lshlrev_b32 v110, 16, v61
    v_and_b32 v111, 0xffff0000, v61
    v_pk_add_f32 v[112:113], v[112:113], v[116:117]
    v_pk_add_f32 v[114:115], v[114:115], v[118:119]
    v_lshlrev_b32 v104, 16, v62
    v_and_b32 v105, 0xffff0000, v62
    v_lshlrev_b32 v106, 16, v63
    v_and_b32 v107, 0xffff0000, v63
    v_pk_mul_f32 v[116:117], v[112:113], v[168:169]
    v_pk_mul_f32 v[118:119], v[114:115], v[168:169]
    v_pk_add_f32 v[120:121], v[104:105], v[172:173] neg_lo:[0,1] neg_hi:[0,1]
    v_pk_add_f32 v[122:123], v[106:107], v[172:173] neg_lo:[0,1] neg_hi:[0,1]
    v_exp_f32 v116, v116
    v_exp_f32 v117, v117
    v_exp_f32 v118, v118
    v_exp_f32 v119, v119
    v_pk_mul_f32 v[108:109], v[108:109], v[174:175]
    v_pk_mul_f32 v[110:111], v[110:111], v[174:175]
    v_pk_mul_f32 v[120:121], v[120:121], v[112:113]
    v_pk_mul_f32 v[122:123], v[122:123], v[114:115]
    v_pk_add_f32 v[116:117], v[116:117], v[170:171]
    v_pk_add_f32 v[118:119], v[118:119], v[170:171]
    v_pk_mul_f32 v[120:121], v[120:121], v[108:109]
    v_pk_mul_f32 v[122:123], v[122:123], v[110:111]
    v_rcp_f32 v116, v116
    v_rcp_f32 v117, v117
    v_rcp_f32 v118, v118
    v_rcp_f32 v119, v119
    v_pk_fma_f32 v[104:105], v[120:121], v[116:117], v[104:105]
    v_pk_fma_f32 v[106:107], v[122:123], v[118:119], v[106:107]
    v_cvt_pk_bf16_f32 v124, v104, v105
    v_cvt_pk_bf16_f32 v125, v106, v107
    ds_write_b64 v14, v[124:125] offset:96
    s_waitcnt lgkmcnt(0)
    v_pk_add_f32 v[112:113], v[24:25], v[28:29]
    v_pk_add_f32 v[114:115], v[26:27], v[30:31]
    v_pk_add_f32 v[116:117], v[32:33], v[36:37]
    v_pk_add_f32 v[118:119], v[34:35], v[38:39]
    v_lshlrev_b32 v108, 16, v40
    v_and_b32 v109, 0xffff0000, v40
    v_lshlrev_b32 v110, 16, v41
    v_and_b32 v111, 0xffff0000, v41
    v_pk_add_f32 v[112:113], v[112:113], v[116:117]
    v_pk_add_f32 v[114:115], v[114:115], v[118:119]
    v_lshlrev_b32 v104, 16, v42
    v_and_b32 v105, 0xffff0000, v42
    v_lshlrev_b32 v106, 16, v43
    v_and_b32 v107, 0xffff0000, v43
    v_pk_mul_f32 v[116:117], v[112:113], v[168:169]
    v_pk_mul_f32 v[118:119], v[114:115], v[168:169]
    v_pk_add_f32 v[120:121], v[104:105], v[172:173] neg_lo:[0,1] neg_hi:[0,1]
    v_pk_add_f32 v[122:123], v[106:107], v[172:173] neg_lo:[0,1] neg_hi:[0,1]
    v_exp_f32 v116, v116
    v_exp_f32 v117, v117
    v_exp_f32 v118, v118
    v_exp_f32 v119, v119
    v_pk_mul_f32 v[108:109], v[108:109], v[174:175]
    v_pk_mul_f32 v[110:111], v[110:111], v[174:175]
    v_pk_mul_f32 v[120:121], v[120:121], v[112:113]
    v_pk_mul_f32 v[122:123], v[122:123], v[114:115]
    v_pk_add_f32 v[116:117], v[116:117], v[170:171]
    v_pk_add_f32 v[118:119], v[118:119], v[170:171]
    v_pk_mul_f32 v[120:121], v[120:121], v[108:109]
    v_pk_mul_f32 v[122:123], v[122:123], v[110:111]
    v_rcp_f32 v116, v116
    v_rcp_f32 v117, v117
    v_rcp_f32 v118, v118
    v_rcp_f32 v119, v119
    v_pk_fma_f32 v[104:105], v[120:121], v[116:117], v[104:105]
    v_pk_fma_f32 v[106:107], v[122:123], v[118:119], v[106:107]
    v_cvt_pk_bf16_f32 v124, v104, v105
    v_cvt_pk_bf16_f32 v125, v106, v107
    ds_write_b64 v14, v[124:125] offset:128
    s_waitcnt lgkmcnt(0)
    s_mov_b32 s54, 6554
    s_mul_i32 s34, s56, 1152
    s_lshl_b32 s38, s35, 1
    s_add_u32 s34, s34, s38
    v_add_u32 v15, s55, v7
    v_add_u32 v15, 84992, v15
    ds_read_b128 v[128:131], v15 offset:0
    ds_read_b128 v[132:135], v15 offset:1024
    ds_read_b128 v[136:139], v15 offset:2048
    v_add_u32 v2, 0, v1
    v_mul_lo_u32 v3, v2, s54
    v_lshrrev_b32 v3, 16, v3
    v_mul_u32_u24 v116, 10, v3
    v_sub_u32 v116, v2, v116
    v_and_b32 v117, 12, v3
    v_add_u32 v3, v3, v117
    v_mul_u32_u24 v3, 1152, v3
    v_lshl_add_u32 v3, v116, 4, v3
    v_cmp_gt_u32 vcc, 10, v116
    v_mov_b32 v117, 2146435072
    s_nop 0
    v_cndmask_b32 v3, v117, v3, vcc
    s_waitcnt lgkmcnt(2)
    buffer_store_dwordx4 v[128:131], v3, s[24:27], s34 offen
    v_add_u32 v2, 64, v1
    v_mul_lo_u32 v3, v2, s54
    v_lshrrev_b32 v3, 16, v3
    v_mul_u32_u24 v116, 10, v3
    v_sub_u32 v116, v2, v116
    v_and_b32 v117, 12, v3
    v_add_u32 v3, v3, v117
    v_mul_u32_u24 v3, 1152, v3
    v_lshl_add_u32 v3, v116, 4, v3
    v_cmp_gt_u32 vcc, 10, v116
    v_mov_b32 v117, 2146435072
    s_nop 0
    v_cndmask_b32 v3, v117, v3, vcc
    s_waitcnt lgkmcnt(1)
    buffer_store_dwordx4 v[132:135], v3, s[24:27], s34 offen
    v_add_u32 v2, 128, v1
    v_mul_lo_u32 v3, v2, s54
    v_lshrrev_b32 v3, 16, v3
    v_mul_u32_u24 v116, 10, v3
    v_sub_u32 v116, v2, v116
    v_and_b32 v117, 12, v3
    v_add_u32 v3, v3, v117
    v_mul_u32_u24 v3, 1152, v3
    v_lshl_add_u32 v3, v116, 4, v3
    v_cmp_gt_u32 vcc, 10, v116
    v_mov_b32 v117, 2146435072
    s_nop 0
    v_cndmask_b32 v3, v117, v3, vcc
    v_cmp_gt_u32 vcc, 32, v1
    s_nop 1
    v_cndmask_b32 v3, v117, v3, vcc
    s_waitcnt lgkmcnt(0)
    buffer_store_dwordx4 v[136:139], v3, s[24:27], s34 offen
    s_endpgm
recurrent_scan__ssm_conv_h3__mixer_gmlp__prompt_kernel_nt480:
    buffer_load_dwordx4 v[120:123], v12, s[12:15], s38 offen offset:0 sc1
    buffer_load_dwordx4 v[124:127], v13, s[12:15], s38 offen offset:0 sc1
    buffer_load_dwordx4 v[128:131], v14, s[12:15], s38 offen offset:0 sc1
    buffer_load_dwordx4 v[132:135], v15, s[12:15], s38 offen offset:0 sc1
    buffer_load_dwordx4 v[156:159], v12, s[12:15], s38 offen offset:1024 sc1
    buffer_load_dwordx4 v[160:163], v13, s[12:15], s38 offen offset:1024 sc1
    buffer_load_dwordx4 v[164:167], v14, s[12:15], s38 offen offset:1024 sc1
    buffer_load_dwordx4 v[168:171], v15, s[12:15], s38 offen offset:1024 sc1
    buffer_load_dwordx4 v[192:195], v12, s[12:15], s38 offen offset:2048 sc1
    buffer_load_dwordx4 v[196:199], v13, s[12:15], s38 offen offset:2048 sc1
    buffer_load_dwordx4 v[200:203], v14, s[12:15], s38 offen offset:2048 sc1
    buffer_load_dwordx4 v[204:207], v15, s[12:15], s38 offen offset:2048 sc1
    buffer_load_dwordx4 v[228:231], v12, s[12:15], s38 offen offset:3072 sc1
    buffer_load_dwordx4 v[232:235], v13, s[12:15], s38 offen offset:3072 sc1
    buffer_load_dwordx4 v[236:239], v14, s[12:15], s38 offen offset:3072 sc1
    buffer_load_dwordx4 v[240:243], v15, s[12:15], s38 offen offset:3072 sc1
    s_add_u32 s58, s38, 4096
    s_add_u32 s59, s38, 8192
    s_mul_i32 s54, s28, 8192
    s_mul_i32 s55, s28, 12288
    v_add_u32 v20, s54, v7
    v_add_u32 v20, 115712, v20
    v_add_u32 v248, s55, v7
    v_add_u32 v248, 21248, v248
    s_add_u32 m0, s54, 115712
    s_nop 0
    buffer_load_dwordx4 v12, s[12:15], s58 offen offset:0 sc1 lds
    s_add_u32 m0, s54, 116736
    s_nop 0
    buffer_load_dwordx4 v13, s[12:15], s58 offen offset:0 sc1 lds
    s_add_u32 m0, s54, 117760
    s_nop 0
    buffer_load_dwordx4 v14, s[12:15], s58 offen offset:0 sc1 lds
    s_add_u32 m0, s54, 118784
    s_nop 0
    buffer_load_dwordx4 v15, s[12:15], s58 offen offset:0 sc1 lds
    s_add_u32 m0, s54, 118784
    s_nop 0
    buffer_load_dwordx4 v12, s[12:15], s58 offen offset:1024 sc1 lds
    s_add_u32 m0, s54, 119808
    s_nop 0
    buffer_load_dwordx4 v13, s[12:15], s58 offen offset:1024 sc1 lds
    s_add_u32 m0, s54, 120832
    s_nop 0
    buffer_load_dwordx4 v14, s[12:15], s58 offen offset:1024 sc1 lds
    s_add_u32 m0, s54, 121856
    s_nop 0
    buffer_load_dwordx4 v15, s[12:15], s58 offen offset:1024 sc1 lds
    s_mov_b32 s54, 6554
    v_add_u32 v2, 0, v1
    v_mul_lo_u32 v3, v2, s54
    v_lshrrev_b32 v3, 16, v3
    v_mul_u32_u24 v24, 10, v3
    v_sub_u32 v24, v2, v24
    v_and_b32 v25, 12, v3
    v_add_u32 v3, v3, v25
    v_mul_u32_u24 v3, 1152, v3
    v_lshl_add_u32 v3, v24, 4, v3
    v_cmp_gt_u32 vcc, 8, v24
    v_mov_b32 v25, 2146435072
    s_nop 0
    v_cndmask_b32 v3, v25, v3, vcc
    s_mul_i32 s34, s56, 1152
    s_lshl_b32 s55, s35, 1
    s_add_u32 s34, s34, s55
    s_mul_i32 s55, s28, 2560
    s_add_u32 m0, s55, 84992
    s_nop 0
    buffer_load_dwordx4 v3, s[16:19], s34 offen lds
    v_add_u32 v2, 64, v1
    v_mul_lo_u32 v3, v2, s54
    v_lshrrev_b32 v3, 16, v3
    v_mul_u32_u24 v24, 10, v3
    v_sub_u32 v24, v2, v24
    v_and_b32 v25, 12, v3
    v_add_u32 v3, v3, v25
    v_mul_u32_u24 v3, 1152, v3
    v_lshl_add_u32 v3, v24, 4, v3
    v_cmp_gt_u32 vcc, 8, v24
    v_mov_b32 v25, 2146435072
    s_nop 0
    v_cndmask_b32 v3, v25, v3, vcc
    s_mul_i32 s34, s56, 1152
    s_lshl_b32 s55, s35, 1
    s_add_u32 s34, s34, s55
    s_mul_i32 s55, s28, 2560
    s_add_u32 m0, s55, 86016
    s_nop 0
    buffer_load_dwordx4 v3, s[16:19], s34 offen lds
    v_add_u32 v2, 128, v1
    v_mul_lo_u32 v3, v2, s54
    v_lshrrev_b32 v3, 16, v3
    v_mul_u32_u24 v24, 10, v3
    v_sub_u32 v24, v2, v24
    v_and_b32 v25, 12, v3
    v_add_u32 v3, v3, v25
    v_mul_u32_u24 v3, 1152, v3
    v_lshl_add_u32 v3, v24, 4, v3
    v_cmp_gt_u32 vcc, 8, v24
    v_mov_b32 v25, 2146435072
    s_nop 0
    v_cndmask_b32 v3, v25, v3, vcc
    s_mul_i32 s34, s56, 1152
    s_lshl_b32 s55, s35, 1
    s_add_u32 s34, s34, s55
    s_mul_i32 s55, s28, 2560
    s_add_u32 m0, s55, 87040
    s_mov_b32 exec_hi, 0
    buffer_load_dwordx4 v3, s[16:19], s34 offen lds
    s_mov_b32 exec_hi, -1
    s_lshl_b32 s34, s56, 3
    s_add_u32 s34, s34, 1048576
    v_and_b32 v2, 12, v5
    v_add_u32 v2, v2, v5
    v_lshlrev_b32 v2, 3, v2
    buffer_load_dwordx2 v[18:19], v2, s[48:51], s34 offen sc1
    v_mov_b32 v24, 0
    v_mov_b32 v25, 0
    v_mov_b32 v26, 0
    v_mov_b32 v27, 0
    v_mov_b32 v28, 0
    v_mov_b32 v29, 0
    v_mov_b32 v30, 0
    v_mov_b32 v31, 0
    v_mov_b32 v32, 0
    v_mov_b32 v33, 0
    v_mov_b32 v34, 0
    v_mov_b32 v35, 0
    v_mov_b32 v36, 0
    v_mov_b32 v37, 0
    v_mov_b32 v38, 0
    v_mov_b32 v39, 0
    v_mov_b32 v40, 0
    v_mov_b32 v41, 0
    v_mov_b32 v42, 0
    v_mov_b32 v43, 0
    v_mov_b32 v44, 0
    v_mov_b32 v45, 0
    v_mov_b32 v46, 0
    v_mov_b32 v47, 0
    v_mov_b32 v48, 0
    v_mov_b32 v49, 0
    v_mov_b32 v50, 0
    v_mov_b32 v51, 0
    v_mov_b32 v52, 0
    v_mov_b32 v53, 0
    v_mov_b32 v54, 0
    v_mov_b32 v55, 0
    v_mov_b32 v56, 0
    v_mov_b32 v57, 0
    v_mov_b32 v58, 0
    v_mov_b32 v59, 0
    v_mov_b32 v60, 0
    v_mov_b32 v61, 0
    v_mov_b32 v62, 0
    v_mov_b32 v63, 0
    v_mov_b32 v64, 0
    v_mov_b32 v65, 0
    v_mov_b32 v66, 0
    v_mov_b32 v67, 0
    v_mov_b32 v68, 0
    v_mov_b32 v69, 0
    v_mov_b32 v70, 0
    v_mov_b32 v71, 0
    v_mov_b32 v72, 0
    v_mov_b32 v73, 0
    v_mov_b32 v74, 0
    v_mov_b32 v75, 0
    v_mov_b32 v76, 0
    v_mov_b32 v77, 0
    v_mov_b32 v78, 0
    v_mov_b32 v79, 0
    v_mov_b32 v80, 0
    v_mov_b32 v81, 0
    v_mov_b32 v82, 0
    v_mov_b32 v83, 0
    v_mov_b32 v84, 0
    v_mov_b32 v85, 0
    v_mov_b32 v86, 0
    v_mov_b32 v87, 0
    s_mov_b32 s33, 0
    s_lshl_b32 s34, s28, 4
    s_add_u32 s62, s62, s34
    s_add_u32 s63, s62, 4
    s_add_u32 s60, s62, 8
    s_add_u32 s61, s62, 12
    v_mov_b32 v2, 2146435072
    v_mov_b32 v3, 0
    v_writelane_b32 v2, s62, 0
    s_mov_b32 s34, 1
    v_writelane_b32 v3, s34, 0
    v_writelane_b32 v2, s63, 1
    s_mov_b32 s34, 1
    v_writelane_b32 v3, s34, 1
    v_writelane_b32 v2, s60, 2
    s_mov_b32 s34, 1
    v_writelane_b32 v3, s34, 2
    v_writelane_b32 v2, s61, 3
    s_mov_b32 s34, 1
    v_writelane_b32 v3, s34, 3
recurrent_scan__ssm_conv_h3__mixer_gmlp__prompt_kernel_pl86:
    buffer_load_dword v4, v2, s[48:51], 0 offen sc1
    s_waitcnt vmcnt(0)
    v_cmp_lt_u32 vcc, v4, v3
    s_cmp_eq_u64 vcc, 0
    s_cbranch_scc1 recurrent_scan__ssm_conv_h3__mixer_gmlp__prompt_kernel_plok87
    s_sleep 1
    s_branch recurrent_scan__ssm_conv_h3__mixer_gmlp__prompt_kernel_pl86
recurrent_scan__ssm_conv_h3__mixer_gmlp__prompt_kernel_plok87:
    buffer_load_dwordx4 v[104:107], v8, s[8:11], s38 offen offset:0 sc1
    buffer_load_dwordx4 v[108:111], v9, s[8:11], s38 offen offset:0 sc1
    buffer_load_dwordx4 v[112:115], v10, s[8:11], s38 offen offset:0 sc1
    buffer_load_dwordx4 v[116:119], v11, s[8:11], s38 offen offset:0 sc1
    buffer_load_dwordx4 v[140:143], v8, s[8:11], s38 offen offset:1024 sc1
    buffer_load_dwordx4 v[144:147], v9, s[8:11], s38 offen offset:1024 sc1
    buffer_load_dwordx4 v[148:151], v10, s[8:11], s38 offen offset:1024 sc1
    buffer_load_dwordx4 v[152:155], v11, s[8:11], s38 offen offset:1024 sc1
    buffer_load_dwordx4 v[176:179], v8, s[8:11], s38 offen offset:2048 sc1
    buffer_load_dwordx4 v[180:183], v9, s[8:11], s38 offen offset:2048 sc1
    buffer_load_dwordx4 v[184:187], v10, s[8:11], s38 offen offset:2048 sc1
    buffer_load_dwordx4 v[188:191], v11, s[8:11], s38 offen offset:2048 sc1
    s_waitcnt vmcnt(8)
    buffer_load_dwordx4 v[212:215], v8, s[8:11], s38 offen offset:3072 sc1
    v_mfma_f32_16x16x32_bf16 v[24:27], v[120:123], v[104:107], v[24:27]
    buffer_load_dwordx4 v[216:219], v9, s[8:11], s38 offen offset:3072 sc1
    v_mfma_f32_16x16x32_bf16 v[40:43], v[120:123], v[108:111], v[40:43]
    buffer_load_dwordx4 v[220:223], v10, s[8:11], s38 offen offset:3072 sc1
    v_mfma_f32_16x16x32_bf16 v[56:59], v[120:123], v[112:115], v[56:59]
    buffer_load_dwordx4 v[224:227], v11, s[8:11], s38 offen offset:3072 sc1
    v_mfma_f32_16x16x32_bf16 v[72:75], v[120:123], v[116:119], v[72:75]
    v_mfma_f32_16x16x32_bf16 v[28:31], v[124:127], v[104:107], v[28:31]
    v_mfma_f32_16x16x32_bf16 v[44:47], v[124:127], v[108:111], v[44:47]
    v_mfma_f32_16x16x32_bf16 v[60:63], v[124:127], v[112:115], v[60:63]
    v_mfma_f32_16x16x32_bf16 v[76:79], v[124:127], v[116:119], v[76:79]
    v_mfma_f32_16x16x32_bf16 v[32:35], v[128:131], v[104:107], v[32:35]
    v_mfma_f32_16x16x32_bf16 v[48:51], v[128:131], v[108:111], v[48:51]
    v_mfma_f32_16x16x32_bf16 v[64:67], v[128:131], v[112:115], v[64:67]
    v_mfma_f32_16x16x32_bf16 v[80:83], v[128:131], v[116:119], v[80:83]
    v_mfma_f32_16x16x32_bf16 v[36:39], v[132:135], v[104:107], v[36:39]
    v_mfma_f32_16x16x32_bf16 v[52:55], v[132:135], v[108:111], v[52:55]
    v_mfma_f32_16x16x32_bf16 v[68:71], v[132:135], v[112:115], v[68:71]
    v_mfma_f32_16x16x32_bf16 v[84:87], v[132:135], v[116:119], v[84:87]
    s_waitcnt vmcnt(8)
    s_add_u32 s38, s38, 4096
    buffer_load_dwordx4 v[104:107], v8, s[8:11], s38 offen offset:0 sc1
    v_mfma_f32_16x16x32_bf16 v[24:27], v[156:159], v[140:143], v[24:27]
    buffer_load_dwordx4 v[108:111], v9, s[8:11], s38 offen offset:0 sc1
    v_mfma_f32_16x16x32_bf16 v[40:43], v[156:159], v[144:147], v[40:43]
    buffer_load_dwordx4 v[112:115], v10, s[8:11], s38 offen offset:0 sc1
    v_mfma_f32_16x16x32_bf16 v[56:59], v[156:159], v[148:151], v[56:59]
    buffer_load_dwordx4 v[116:119], v11, s[8:11], s38 offen offset:0 sc1
    v_mfma_f32_16x16x32_bf16 v[72:75], v[156:159], v[152:155], v[72:75]
    ds_read_b128 v[120:123], v20 offset:0
    v_mfma_f32_16x16x32_bf16 v[28:31], v[160:163], v[140:143], v[28:31]
    ds_read_b128 v[124:127], v20 offset:1024
    v_mfma_f32_16x16x32_bf16 v[44:47], v[160:163], v[144:147], v[44:47]
    ds_read_b128 v[128:131], v20 offset:2048
    v_mfma_f32_16x16x32_bf16 v[60:63], v[160:163], v[148:151], v[60:63]
    ds_read_b128 v[132:135], v20 offset:3072
    v_mfma_f32_16x16x32_bf16 v[76:79], v[160:163], v[152:155], v[76:79]
    v_mfma_f32_16x16x32_bf16 v[32:35], v[164:167], v[140:143], v[32:35]
    v_mfma_f32_16x16x32_bf16 v[48:51], v[164:167], v[144:147], v[48:51]
    v_mfma_f32_16x16x32_bf16 v[64:67], v[164:167], v[148:151], v[64:67]
    v_mfma_f32_16x16x32_bf16 v[80:83], v[164:167], v[152:155], v[80:83]
    v_mfma_f32_16x16x32_bf16 v[36:39], v[168:171], v[140:143], v[36:39]
    v_mfma_f32_16x16x32_bf16 v[52:55], v[168:171], v[144:147], v[52:55]
    v_mfma_f32_16x16x32_bf16 v[68:71], v[168:171], v[148:151], v[68:71]
    v_mfma_f32_16x16x32_bf16 v[84:87], v[168:171], v[152:155], v[84:87]
    s_waitcnt vmcnt(8)
    buffer_load_dwordx4 v[140:143], v8, s[8:11], s38 offen offset:1024 sc1
    v_mfma_f32_16x16x32_bf16 v[24:27], v[192:195], v[176:179], v[24:27]
    buffer_load_dwordx4 v[144:147], v9, s[8:11], s38 offen offset:1024 sc1
    v_mfma_f32_16x16x32_bf16 v[40:43], v[192:195], v[180:183], v[40:43]
    buffer_load_dwordx4 v[148:151], v10, s[8:11], s38 offen offset:1024 sc1
    v_mfma_f32_16x16x32_bf16 v[56:59], v[192:195], v[184:187], v[56:59]
    buffer_load_dwordx4 v[152:155], v11, s[8:11], s38 offen offset:1024 sc1
    v_mfma_f32_16x16x32_bf16 v[72:75], v[192:195], v[188:191], v[72:75]
    ds_read_b128 v[156:159], v20 offset:4096
    v_mfma_f32_16x16x32_bf16 v[28:31], v[196:199], v[176:179], v[28:31]
    ds_read_b128 v[160:163], v20 offset:5120
    v_mfma_f32_16x16x32_bf16 v[44:47], v[196:199], v[180:183], v[44:47]
    ds_read_b128 v[164:167], v20 offset:6144
    v_mfma_f32_16x16x32_bf16 v[60:63], v[196:199], v[184:187], v[60:63]
    ds_read_b128 v[168:171], v20 offset:7168
    v_mfma_f32_16x16x32_bf16 v[76:79], v[196:199], v[188:191], v[76:79]
    v_mfma_f32_16x16x32_bf16 v[32:35], v[200:203], v[176:179], v[32:35]
    v_mfma_f32_16x16x32_bf16 v[48:51], v[200:203], v[180:183], v[48:51]
    v_mfma_f32_16x16x32_bf16 v[64:67], v[200:203], v[184:187], v[64:67]
    v_mfma_f32_16x16x32_bf16 v[80:83], v[200:203], v[188:191], v[80:83]
    v_mfma_f32_16x16x32_bf16 v[36:39], v[204:207], v[176:179], v[36:39]
    v_mfma_f32_16x16x32_bf16 v[52:55], v[204:207], v[180:183], v[52:55]
    v_mfma_f32_16x16x32_bf16 v[68:71], v[204:207], v[184:187], v[68:71]
    v_mfma_f32_16x16x32_bf16 v[84:87], v[204:207], v[188:191], v[84:87]
    s_waitcnt vmcnt(8)
    buffer_load_dwordx4 v[192:195], v12, s[12:15], s38 offen offset:2048 sc1
    v_mfma_f32_16x16x32_bf16 v[24:27], v[228:231], v[212:215], v[24:27]
    buffer_load_dwordx4 v[176:179], v8, s[8:11], s38 offen offset:2048 sc1
    v_mfma_f32_16x16x32_bf16 v[40:43], v[228:231], v[216:219], v[40:43]
    buffer_load_dwordx4 v[196:199], v13, s[12:15], s38 offen offset:2048 sc1
    v_mfma_f32_16x16x32_bf16 v[56:59], v[228:231], v[220:223], v[56:59]
    buffer_load_dwordx4 v[180:183], v9, s[8:11], s38 offen offset:2048 sc1
    v_mfma_f32_16x16x32_bf16 v[72:75], v[228:231], v[224:227], v[72:75]
    buffer_load_dwordx4 v[200:203], v14, s[12:15], s38 offen offset:2048 sc1
    v_mfma_f32_16x16x32_bf16 v[28:31], v[232:235], v[212:215], v[28:31]
    buffer_load_dwordx4 v[184:187], v10, s[8:11], s38 offen offset:2048 sc1
    v_mfma_f32_16x16x32_bf16 v[44:47], v[232:235], v[216:219], v[44:47]
    buffer_load_dwordx4 v[204:207], v15, s[12:15], s38 offen offset:2048 sc1
    v_mfma_f32_16x16x32_bf16 v[60:63], v[232:235], v[220:223], v[60:63]
    buffer_load_dwordx4 v[188:191], v11, s[8:11], s38 offen offset:2048 sc1
    v_mfma_f32_16x16x32_bf16 v[76:79], v[232:235], v[224:227], v[76:79]
    v_mfma_f32_16x16x32_bf16 v[32:35], v[236:239], v[212:215], v[32:35]
    v_mfma_f32_16x16x32_bf16 v[48:51], v[236:239], v[216:219], v[48:51]
    v_mfma_f32_16x16x32_bf16 v[64:67], v[236:239], v[220:223], v[64:67]
    v_mfma_f32_16x16x32_bf16 v[80:83], v[236:239], v[224:227], v[80:83]
    v_mfma_f32_16x16x32_bf16 v[36:39], v[240:243], v[212:215], v[36:39]
    v_mfma_f32_16x16x32_bf16 v[52:55], v[240:243], v[216:219], v[52:55]
    v_mfma_f32_16x16x32_bf16 v[68:71], v[240:243], v[220:223], v[68:71]
    v_mfma_f32_16x16x32_bf16 v[84:87], v[240:243], v[224:227], v[84:87]
    s_waitcnt vmcnt(12)
    s_waitcnt lgkmcnt(0)
    buffer_load_dwordx4 v[228:231], v12, s[12:15], s38 offen offset:3072 sc1
    v_mfma_f32_16x16x32_bf16 v[24:27], v[120:123], v[104:107], v[24:27]
    buffer_load_dwordx4 v[212:215], v8, s[8:11], s38 offen offset:3072 sc1
    v_mfma_f32_16x16x32_bf16 v[40:43], v[120:123], v[108:111], v[40:43]
    buffer_load_dwordx4 v[232:235], v13, s[12:15], s38 offen offset:3072 sc1
    v_mfma_f32_16x16x32_bf16 v[56:59], v[120:123], v[112:115], v[56:59]
    buffer_load_dwordx4 v[216:219], v9, s[8:11], s38 offen offset:3072 sc1
    v_mfma_f32_16x16x32_bf16 v[72:75], v[120:123], v[116:119], v[72:75]
    buffer_load_dwordx4 v[236:239], v14, s[12:15], s38 offen offset:3072 sc1
    v_mfma_f32_16x16x32_bf16 v[28:31], v[124:127], v[104:107], v[28:31]
    buffer_load_dwordx4 v[220:223], v10, s[8:11], s38 offen offset:3072 sc1
    v_mfma_f32_16x16x32_bf16 v[44:47], v[124:127], v[108:111], v[44:47]
    buffer_load_dwordx4 v[240:243], v15, s[12:15], s38 offen offset:3072 sc1
    v_mfma_f32_16x16x32_bf16 v[60:63], v[124:127], v[112:115], v[60:63]
    buffer_load_dwordx4 v[224:227], v11, s[8:11], s38 offen offset:3072 sc1
    v_mfma_f32_16x16x32_bf16 v[76:79], v[124:127], v[116:119], v[76:79]
    v_mfma_f32_16x16x32_bf16 v[32:35], v[128:131], v[104:107], v[32:35]
    v_mfma_f32_16x16x32_bf16 v[48:51], v[128:131], v[108:111], v[48:51]
    v_mfma_f32_16x16x32_bf16 v[64:67], v[128:131], v[112:115], v[64:67]
    v_mfma_f32_16x16x32_bf16 v[80:83], v[128:131], v[116:119], v[80:83]
    v_mfma_f32_16x16x32_bf16 v[36:39], v[132:135], v[104:107], v[36:39]
    v_mfma_f32_16x16x32_bf16 v[52:55], v[132:135], v[108:111], v[52:55]
    v_mfma_f32_16x16x32_bf16 v[68:71], v[132:135], v[112:115], v[68:71]
    v_mfma_f32_16x16x32_bf16 v[84:87], v[132:135], v[116:119], v[84:87]
    s_waitcnt vmcnt(16)
    s_waitcnt lgkmcnt(0)
    s_add_u32 s38, s38, 4096
    buffer_load_dwordx4 v[120:123], v12, s[12:15], s38 offen offset:0 sc1
    v_mfma_f32_16x16x32_bf16 v[24:27], v[156:159], v[140:143], v[24:27]
    buffer_load_dwordx4 v[104:107], v8, s[8:11], s38 offen offset:0 sc1
    v_mfma_f32_16x16x32_bf16 v[40:43], v[156:159], v[144:147], v[40:43]
    buffer_load_dwordx4 v[124:127], v13, s[12:15], s38 offen offset:0 sc1
    v_mfma_f32_16x16x32_bf16 v[56:59], v[156:159], v[148:151], v[56:59]
    buffer_load_dwordx4 v[108:111], v9, s[8:11], s38 offen offset:0 sc1
    v_mfma_f32_16x16x32_bf16 v[72:75], v[156:159], v[152:155], v[72:75]
    buffer_load_dwordx4 v[128:131], v14, s[12:15], s38 offen offset:0 sc1
    v_mfma_f32_16x16x32_bf16 v[28:31], v[160:163], v[140:143], v[28:31]
    buffer_load_dwordx4 v[112:115], v10, s[8:11], s38 offen offset:0 sc1
    v_mfma_f32_16x16x32_bf16 v[44:47], v[160:163], v[144:147], v[44:47]
    buffer_load_dwordx4 v[132:135], v15, s[12:15], s38 offen offset:0 sc1
    v_mfma_f32_16x16x32_bf16 v[60:63], v[160:163], v[148:151], v[60:63]
    buffer_load_dwordx4 v[116:119], v11, s[8:11], s38 offen offset:0 sc1
    v_mfma_f32_16x16x32_bf16 v[76:79], v[160:163], v[152:155], v[76:79]
    v_mfma_f32_16x16x32_bf16 v[32:35], v[164:167], v[140:143], v[32:35]
    v_mfma_f32_16x16x32_bf16 v[48:51], v[164:167], v[144:147], v[48:51]
    v_mfma_f32_16x16x32_bf16 v[64:67], v[164:167], v[148:151], v[64:67]
    v_mfma_f32_16x16x32_bf16 v[80:83], v[164:167], v[152:155], v[80:83]
    v_mfma_f32_16x16x32_bf16 v[36:39], v[168:171], v[140:143], v[36:39]
    v_mfma_f32_16x16x32_bf16 v[52:55], v[168:171], v[144:147], v[52:55]
    v_mfma_f32_16x16x32_bf16 v[68:71], v[168:171], v[148:151], v[68:71]
    v_mfma_f32_16x16x32_bf16 v[84:87], v[168:171], v[152:155], v[84:87]
    s_waitcnt vmcnt(16)
    buffer_load_dwordx4 v[156:159], v12, s[12:15], s38 offen offset:1024 sc1
    v_mfma_f32_16x16x32_bf16 v[24:27], v[192:195], v[176:179], v[24:27]
    buffer_load_dwordx4 v[140:143], v8, s[8:11], s38 offen offset:1024 sc1
    v_mfma_f32_16x16x32_bf16 v[40:43], v[192:195], v[180:183], v[40:43]
    buffer_load_dwordx4 v[160:163], v13, s[12:15], s38 offen offset:1024 sc1
    v_mfma_f32_16x16x32_bf16 v[56:59], v[192:195], v[184:187], v[56:59]
    buffer_load_dwordx4 v[144:147], v9, s[8:11], s38 offen offset:1024 sc1
    v_mfma_f32_16x16x32_bf16 v[72:75], v[192:195], v[188:191], v[72:75]
    buffer_load_dwordx4 v[164:167], v14, s[12:15], s38 offen offset:1024 sc1
    v_mfma_f32_16x16x32_bf16 v[28:31], v[196:199], v[176:179], v[28:31]
    buffer_load_dwordx4 v[148:151], v10, s[8:11], s38 offen offset:1024 sc1
    v_mfma_f32_16x16x32_bf16 v[44:47], v[196:199], v[180:183], v[44:47]
    buffer_load_dwordx4 v[168:171], v15, s[12:15], s38 offen offset:1024 sc1
    v_mfma_f32_16x16x32_bf16 v[60:63], v[196:199], v[184:187], v[60:63]
    buffer_load_dwordx4 v[152:155], v11, s[8:11], s38 offen offset:1024 sc1
    v_mfma_f32_16x16x32_bf16 v[76:79], v[196:199], v[188:191], v[76:79]
    v_mfma_f32_16x16x32_bf16 v[32:35], v[200:203], v[176:179], v[32:35]
    v_mfma_f32_16x16x32_bf16 v[48:51], v[200:203], v[180:183], v[48:51]
    v_mfma_f32_16x16x32_bf16 v[64:67], v[200:203], v[184:187], v[64:67]
    v_mfma_f32_16x16x32_bf16 v[80:83], v[200:203], v[188:191], v[80:83]
    v_mfma_f32_16x16x32_bf16 v[36:39], v[204:207], v[176:179], v[36:39]
    v_mfma_f32_16x16x32_bf16 v[52:55], v[204:207], v[180:183], v[52:55]
    v_mfma_f32_16x16x32_bf16 v[68:71], v[204:207], v[184:187], v[68:71]
    v_mfma_f32_16x16x32_bf16 v[84:87], v[204:207], v[188:191], v[84:87]
    s_waitcnt vmcnt(16)
    buffer_load_dwordx4 v[192:195], v12, s[12:15], s38 offen offset:2048 sc1
    v_mfma_f32_16x16x32_bf16 v[24:27], v[228:231], v[212:215], v[24:27]
    buffer_load_dwordx4 v[176:179], v8, s[8:11], s38 offen offset:2048 sc1
    v_mfma_f32_16x16x32_bf16 v[40:43], v[228:231], v[216:219], v[40:43]
    buffer_load_dwordx4 v[196:199], v13, s[12:15], s38 offen offset:2048 sc1
    v_mfma_f32_16x16x32_bf16 v[56:59], v[228:231], v[220:223], v[56:59]
    buffer_load_dwordx4 v[180:183], v9, s[8:11], s38 offen offset:2048 sc1
    v_mfma_f32_16x16x32_bf16 v[72:75], v[228:231], v[224:227], v[72:75]
    buffer_load_dwordx4 v[200:203], v14, s[12:15], s38 offen offset:2048 sc1
    v_mfma_f32_16x16x32_bf16 v[28:31], v[232:235], v[212:215], v[28:31]
    buffer_load_dwordx4 v[184:187], v10, s[8:11], s38 offen offset:2048 sc1
    v_mfma_f32_16x16x32_bf16 v[44:47], v[232:235], v[216:219], v[44:47]
    buffer_load_dwordx4 v[204:207], v15, s[12:15], s38 offen offset:2048 sc1
    v_mfma_f32_16x16x32_bf16 v[60:63], v[232:235], v[220:223], v[60:63]
    buffer_load_dwordx4 v[188:191], v11, s[8:11], s38 offen offset:2048 sc1
    v_mfma_f32_16x16x32_bf16 v[76:79], v[232:235], v[224:227], v[76:79]
    v_mfma_f32_16x16x32_bf16 v[32:35], v[236:239], v[212:215], v[32:35]
    v_mfma_f32_16x16x32_bf16 v[48:51], v[236:239], v[216:219], v[48:51]
    v_mfma_f32_16x16x32_bf16 v[64:67], v[236:239], v[220:223], v[64:67]
    v_mfma_f32_16x16x32_bf16 v[80:83], v[236:239], v[224:227], v[80:83]
    v_mfma_f32_16x16x32_bf16 v[36:39], v[240:243], v[212:215], v[36:39]
    v_mfma_f32_16x16x32_bf16 v[52:55], v[240:243], v[216:219], v[52:55]
    v_mfma_f32_16x16x32_bf16 v[68:71], v[240:243], v[220:223], v[68:71]
    v_mfma_f32_16x16x32_bf16 v[84:87], v[240:243], v[224:227], v[84:87]
    s_waitcnt vmcnt(16)
    buffer_load_dwordx4 v[228:231], v12, s[12:15], s38 offen offset:3072 sc1
    v_mfma_f32_16x16x32_bf16 v[24:27], v[120:123], v[104:107], v[24:27]
    buffer_load_dwordx4 v[212:215], v8, s[8:11], s38 offen offset:3072 sc1
    v_mfma_f32_16x16x32_bf16 v[40:43], v[120:123], v[108:111], v[40:43]
    buffer_load_dwordx4 v[232:235], v13, s[12:15], s38 offen offset:3072 sc1
    v_mfma_f32_16x16x32_bf16 v[56:59], v[120:123], v[112:115], v[56:59]
    buffer_load_dwordx4 v[216:219], v9, s[8:11], s38 offen offset:3072 sc1
    v_mfma_f32_16x16x32_bf16 v[72:75], v[120:123], v[116:119], v[72:75]
    buffer_load_dwordx4 v[236:239], v14, s[12:15], s38 offen offset:3072 sc1
    v_mfma_f32_16x16x32_bf16 v[28:31], v[124:127], v[104:107], v[28:31]
    buffer_load_dwordx4 v[220:223], v10, s[8:11], s38 offen offset:3072 sc1
    v_mfma_f32_16x16x32_bf16 v[44:47], v[124:127], v[108:111], v[44:47]
    buffer_load_dwordx4 v[240:243], v15, s[12:15], s38 offen offset:3072 sc1
    v_mfma_f32_16x16x32_bf16 v[60:63], v[124:127], v[112:115], v[60:63]
    buffer_load_dwordx4 v[224:227], v11, s[8:11], s38 offen offset:3072 sc1
    v_mfma_f32_16x16x32_bf16 v[76:79], v[124:127], v[116:119], v[76:79]
    v_mfma_f32_16x16x32_bf16 v[32:35], v[128:131], v[104:107], v[32:35]
    v_mfma_f32_16x16x32_bf16 v[48:51], v[128:131], v[108:111], v[48:51]
    v_mfma_f32_16x16x32_bf16 v[64:67], v[128:131], v[112:115], v[64:67]
    v_mfma_f32_16x16x32_bf16 v[80:83], v[128:131], v[116:119], v[80:83]
    v_mfma_f32_16x16x32_bf16 v[36:39], v[132:135], v[104:107], v[36:39]
    v_mfma_f32_16x16x32_bf16 v[52:55], v[132:135], v[108:111], v[52:55]
    v_mfma_f32_16x16x32_bf16 v[68:71], v[132:135], v[112:115], v[68:71]
    v_mfma_f32_16x16x32_bf16 v[84:87], v[132:135], v[116:119], v[84:87]
    s_waitcnt vmcnt(16)
    s_add_u32 s38, s38, 4096
    buffer_load_dwordx4 v[120:123], v12, s[12:15], s38 offen offset:0 sc1
    v_mfma_f32_16x16x32_bf16 v[24:27], v[156:159], v[140:143], v[24:27]
    buffer_load_dwordx4 v[104:107], v8, s[8:11], s38 offen offset:0 sc1
    v_mfma_f32_16x16x32_bf16 v[40:43], v[156:159], v[144:147], v[40:43]
    buffer_load_dwordx4 v[124:127], v13, s[12:15], s38 offen offset:0 sc1
    v_mfma_f32_16x16x32_bf16 v[56:59], v[156:159], v[148:151], v[56:59]
    buffer_load_dwordx4 v[108:111], v9, s[8:11], s38 offen offset:0 sc1
    v_mfma_f32_16x16x32_bf16 v[72:75], v[156:159], v[152:155], v[72:75]
    buffer_load_dwordx4 v[128:131], v14, s[12:15], s38 offen offset:0 sc1
    v_mfma_f32_16x16x32_bf16 v[28:31], v[160:163], v[140:143], v[28:31]
    buffer_load_dwordx4 v[112:115], v10, s[8:11], s38 offen offset:0 sc1
    v_mfma_f32_16x16x32_bf16 v[44:47], v[160:163], v[144:147], v[44:47]
    buffer_load_dwordx4 v[132:135], v15, s[12:15], s38 offen offset:0 sc1
    v_mfma_f32_16x16x32_bf16 v[60:63], v[160:163], v[148:151], v[60:63]
    buffer_load_dwordx4 v[116:119], v11, s[8:11], s38 offen offset:0 sc1
    v_mfma_f32_16x16x32_bf16 v[76:79], v[160:163], v[152:155], v[76:79]
    v_mfma_f32_16x16x32_bf16 v[32:35], v[164:167], v[140:143], v[32:35]
    v_mfma_f32_16x16x32_bf16 v[48:51], v[164:167], v[144:147], v[48:51]
    v_mfma_f32_16x16x32_bf16 v[64:67], v[164:167], v[148:151], v[64:67]
    v_mfma_f32_16x16x32_bf16 v[80:83], v[164:167], v[152:155], v[80:83]
    v_mfma_f32_16x16x32_bf16 v[36:39], v[168:171], v[140:143], v[36:39]
    v_mfma_f32_16x16x32_bf16 v[52:55], v[168:171], v[144:147], v[52:55]
    v_mfma_f32_16x16x32_bf16 v[68:71], v[168:171], v[148:151], v[68:71]
    v_mfma_f32_16x16x32_bf16 v[84:87], v[168:171], v[152:155], v[84:87]
    s_waitcnt vmcnt(16)
    buffer_load_dwordx4 v[156:159], v12, s[12:15], s38 offen offset:1024 sc1
    v_mfma_f32_16x16x32_bf16 v[24:27], v[192:195], v[176:179], v[24:27]
    buffer_load_dwordx4 v[140:143], v8, s[8:11], s38 offen offset:1024 sc1
    v_mfma_f32_16x16x32_bf16 v[40:43], v[192:195], v[180:183], v[40:43]
    buffer_load_dwordx4 v[160:163], v13, s[12:15], s38 offen offset:1024 sc1
    v_mfma_f32_16x16x32_bf16 v[56:59], v[192:195], v[184:187], v[56:59]
    buffer_load_dwordx4 v[144:147], v9, s[8:11], s38 offen offset:1024 sc1
    v_mfma_f32_16x16x32_bf16 v[72:75], v[192:195], v[188:191], v[72:75]
    buffer_load_dwordx4 v[164:167], v14, s[12:15], s38 offen offset:1024 sc1
    v_mfma_f32_16x16x32_bf16 v[28:31], v[196:199], v[176:179], v[28:31]
    buffer_load_dwordx4 v[148:151], v10, s[8:11], s38 offen offset:1024 sc1
    v_mfma_f32_16x16x32_bf16 v[44:47], v[196:199], v[180:183], v[44:47]
    buffer_load_dwordx4 v[168:171], v15, s[12:15], s38 offen offset:1024 sc1
    v_mfma_f32_16x16x32_bf16 v[60:63], v[196:199], v[184:187], v[60:63]
    buffer_load_dwordx4 v[152:155], v11, s[8:11], s38 offen offset:1024 sc1
    v_mfma_f32_16x16x32_bf16 v[76:79], v[196:199], v[188:191], v[76:79]
    v_mfma_f32_16x16x32_bf16 v[32:35], v[200:203], v[176:179], v[32:35]
    v_mfma_f32_16x16x32_bf16 v[48:51], v[200:203], v[180:183], v[48:51]
    v_mfma_f32_16x16x32_bf16 v[64:67], v[200:203], v[184:187], v[64:67]
    v_mfma_f32_16x16x32_bf16 v[80:83], v[200:203], v[188:191], v[80:83]
    v_mfma_f32_16x16x32_bf16 v[36:39], v[204:207], v[176:179], v[36:39]
    v_mfma_f32_16x16x32_bf16 v[52:55], v[204:207], v[180:183], v[52:55]
    v_mfma_f32_16x16x32_bf16 v[68:71], v[204:207], v[184:187], v[68:71]
    v_mfma_f32_16x16x32_bf16 v[84:87], v[204:207], v[188:191], v[84:87]
    s_waitcnt vmcnt(16)
    buffer_load_dwordx4 v[192:195], v12, s[12:15], s38 offen offset:2048 sc1
    v_mfma_f32_16x16x32_bf16 v[24:27], v[228:231], v[212:215], v[24:27]
    buffer_load_dwordx4 v[176:179], v8, s[8:11], s38 offen offset:2048 sc1
    v_mfma_f32_16x16x32_bf16 v[40:43], v[228:231], v[216:219], v[40:43]
    buffer_load_dwordx4 v[196:199], v13, s[12:15], s38 offen offset:2048 sc1
    v_mfma_f32_16x16x32_bf16 v[56:59], v[228:231], v[220:223], v[56:59]
    buffer_load_dwordx4 v[180:183], v9, s[8:11], s38 offen offset:2048 sc1
    v_mfma_f32_16x16x32_bf16 v[72:75], v[228:231], v[224:227], v[72:75]
    buffer_load_dwordx4 v[200:203], v14, s[12:15], s38 offen offset:2048 sc1
    v_mfma_f32_16x16x32_bf16 v[28:31], v[232:235], v[212:215], v[28:31]
    buffer_load_dwordx4 v[184:187], v10, s[8:11], s38 offen offset:2048 sc1
    v_mfma_f32_16x16x32_bf16 v[44:47], v[232:235], v[216:219], v[44:47]
    buffer_load_dwordx4 v[204:207], v15, s[12:15], s38 offen offset:2048 sc1
    v_mfma_f32_16x16x32_bf16 v[60:63], v[232:235], v[220:223], v[60:63]
    buffer_load_dwordx4 v[188:191], v11, s[8:11], s38 offen offset:2048 sc1
    v_mfma_f32_16x16x32_bf16 v[76:79], v[232:235], v[224:227], v[76:79]
    v_mfma_f32_16x16x32_bf16 v[32:35], v[236:239], v[212:215], v[32:35]
    v_mfma_f32_16x16x32_bf16 v[48:51], v[236:239], v[216:219], v[48:51]
    v_mfma_f32_16x16x32_bf16 v[64:67], v[236:239], v[220:223], v[64:67]
    v_mfma_f32_16x16x32_bf16 v[80:83], v[236:239], v[224:227], v[80:83]
    v_mfma_f32_16x16x32_bf16 v[36:39], v[240:243], v[212:215], v[36:39]
    v_mfma_f32_16x16x32_bf16 v[52:55], v[240:243], v[216:219], v[52:55]
    v_mfma_f32_16x16x32_bf16 v[68:71], v[240:243], v[220:223], v[68:71]
    v_mfma_f32_16x16x32_bf16 v[84:87], v[240:243], v[224:227], v[84:87]
    s_waitcnt vmcnt(16)
    buffer_load_dwordx4 v[228:231], v12, s[12:15], s38 offen offset:3072 sc1
    v_mfma_f32_16x16x32_bf16 v[24:27], v[120:123], v[104:107], v[24:27]
    buffer_load_dwordx4 v[212:215], v8, s[8:11], s38 offen offset:3072 sc1
    v_mfma_f32_16x16x32_bf16 v[40:43], v[120:123], v[108:111], v[40:43]
    buffer_load_dwordx4 v[232:235], v13, s[12:15], s38 offen offset:3072 sc1
    v_mfma_f32_16x16x32_bf16 v[56:59], v[120:123], v[112:115], v[56:59]
    buffer_load_dwordx4 v[216:219], v9, s[8:11], s38 offen offset:3072 sc1
    v_mfma_f32_16x16x32_bf16 v[72:75], v[120:123], v[116:119], v[72:75]
    buffer_load_dwordx4 v[236:239], v14, s[12:15], s38 offen offset:3072 sc1
    v_mfma_f32_16x16x32_bf16 v[28:31], v[124:127], v[104:107], v[28:31]
    buffer_load_dwordx4 v[220:223], v10, s[8:11], s38 offen offset:3072 sc1
    v_mfma_f32_16x16x32_bf16 v[44:47], v[124:127], v[108:111], v[44:47]
    buffer_load_dwordx4 v[240:243], v15, s[12:15], s38 offen offset:3072 sc1
    v_mfma_f32_16x16x32_bf16 v[60:63], v[124:127], v[112:115], v[60:63]
    buffer_load_dwordx4 v[224:227], v11, s[8:11], s38 offen offset:3072 sc1
    v_mfma_f32_16x16x32_bf16 v[76:79], v[124:127], v[116:119], v[76:79]
    v_mfma_f32_16x16x32_bf16 v[32:35], v[128:131], v[104:107], v[32:35]
    v_mfma_f32_16x16x32_bf16 v[48:51], v[128:131], v[108:111], v[48:51]
    v_mfma_f32_16x16x32_bf16 v[64:67], v[128:131], v[112:115], v[64:67]
    v_mfma_f32_16x16x32_bf16 v[80:83], v[128:131], v[116:119], v[80:83]
    v_mfma_f32_16x16x32_bf16 v[36:39], v[132:135], v[104:107], v[36:39]
    v_mfma_f32_16x16x32_bf16 v[52:55], v[132:135], v[108:111], v[52:55]
    v_mfma_f32_16x16x32_bf16 v[68:71], v[132:135], v[112:115], v[68:71]
    v_mfma_f32_16x16x32_bf16 v[84:87], v[132:135], v[116:119], v[84:87]
    s_waitcnt vmcnt(16)
    s_add_u32 s38, s38, 4096
    buffer_load_dwordx4 v[120:123], v12, s[12:15], s38 offen offset:0 sc1
    v_mfma_f32_16x16x32_bf16 v[24:27], v[156:159], v[140:143], v[24:27]
    buffer_load_dwordx4 v[104:107], v8, s[8:11], s38 offen offset:0 sc1
    v_mfma_f32_16x16x32_bf16 v[40:43], v[156:159], v[144:147], v[40:43]
    buffer_load_dwordx4 v[124:127], v13, s[12:15], s38 offen offset:0 sc1
    v_mfma_f32_16x16x32_bf16 v[56:59], v[156:159], v[148:151], v[56:59]
    buffer_load_dwordx4 v[108:111], v9, s[8:11], s38 offen offset:0 sc1
    v_mfma_f32_16x16x32_bf16 v[72:75], v[156:159], v[152:155], v[72:75]
    buffer_load_dwordx4 v[128:131], v14, s[12:15], s38 offen offset:0 sc1
    v_mfma_f32_16x16x32_bf16 v[28:31], v[160:163], v[140:143], v[28:31]
    buffer_load_dwordx4 v[112:115], v10, s[8:11], s38 offen offset:0 sc1
    v_mfma_f32_16x16x32_bf16 v[44:47], v[160:163], v[144:147], v[44:47]
    buffer_load_dwordx4 v[132:135], v15, s[12:15], s38 offen offset:0 sc1
    v_mfma_f32_16x16x32_bf16 v[60:63], v[160:163], v[148:151], v[60:63]
    buffer_load_dwordx4 v[116:119], v11, s[8:11], s38 offen offset:0 sc1
    v_mfma_f32_16x16x32_bf16 v[76:79], v[160:163], v[152:155], v[76:79]
    v_mfma_f32_16x16x32_bf16 v[32:35], v[164:167], v[140:143], v[32:35]
    v_mfma_f32_16x16x32_bf16 v[48:51], v[164:167], v[144:147], v[48:51]
    v_mfma_f32_16x16x32_bf16 v[64:67], v[164:167], v[148:151], v[64:67]
    v_mfma_f32_16x16x32_bf16 v[80:83], v[164:167], v[152:155], v[80:83]
    v_mfma_f32_16x16x32_bf16 v[36:39], v[168:171], v[140:143], v[36:39]
    v_mfma_f32_16x16x32_bf16 v[52:55], v[168:171], v[144:147], v[52:55]
    v_mfma_f32_16x16x32_bf16 v[68:71], v[168:171], v[148:151], v[68:71]
    v_mfma_f32_16x16x32_bf16 v[84:87], v[168:171], v[152:155], v[84:87]
    s_waitcnt vmcnt(16)
    buffer_load_dwordx4 v[156:159], v12, s[12:15], s38 offen offset:1024 sc1
    v_mfma_f32_16x16x32_bf16 v[24:27], v[192:195], v[176:179], v[24:27]
    buffer_load_dwordx4 v[140:143], v8, s[8:11], s38 offen offset:1024 sc1
    v_mfma_f32_16x16x32_bf16 v[40:43], v[192:195], v[180:183], v[40:43]
    buffer_load_dwordx4 v[160:163], v13, s[12:15], s38 offen offset:1024 sc1
    v_mfma_f32_16x16x32_bf16 v[56:59], v[192:195], v[184:187], v[56:59]
    buffer_load_dwordx4 v[144:147], v9, s[8:11], s38 offen offset:1024 sc1
    v_mfma_f32_16x16x32_bf16 v[72:75], v[192:195], v[188:191], v[72:75]
    buffer_load_dwordx4 v[164:167], v14, s[12:15], s38 offen offset:1024 sc1
    v_mfma_f32_16x16x32_bf16 v[28:31], v[196:199], v[176:179], v[28:31]
    buffer_load_dwordx4 v[148:151], v10, s[8:11], s38 offen offset:1024 sc1
    v_mfma_f32_16x16x32_bf16 v[44:47], v[196:199], v[180:183], v[44:47]
    buffer_load_dwordx4 v[168:171], v15, s[12:15], s38 offen offset:1024 sc1
    v_mfma_f32_16x16x32_bf16 v[60:63], v[196:199], v[184:187], v[60:63]
    buffer_load_dwordx4 v[152:155], v11, s[8:11], s38 offen offset:1024 sc1
    v_mfma_f32_16x16x32_bf16 v[76:79], v[196:199], v[188:191], v[76:79]
    v_mfma_f32_16x16x32_bf16 v[32:35], v[200:203], v[176:179], v[32:35]
    v_mfma_f32_16x16x32_bf16 v[48:51], v[200:203], v[180:183], v[48:51]
    v_mfma_f32_16x16x32_bf16 v[64:67], v[200:203], v[184:187], v[64:67]
    v_mfma_f32_16x16x32_bf16 v[80:83], v[200:203], v[188:191], v[80:83]
    v_mfma_f32_16x16x32_bf16 v[36:39], v[204:207], v[176:179], v[36:39]
    v_mfma_f32_16x16x32_bf16 v[52:55], v[204:207], v[180:183], v[52:55]
    v_mfma_f32_16x16x32_bf16 v[68:71], v[204:207], v[184:187], v[68:71]
    v_mfma_f32_16x16x32_bf16 v[84:87], v[204:207], v[188:191], v[84:87]
    s_lshl_b32 s34, s36, 8
    s_add_u32 s34, s34, 1851392
    v_lshlrev_b32 v3, 8, v1
    v_mov_b32 v2, 2146435072
    v_cmp_gt_u32 vcc, 4, v1
    s_nop 1
    v_cndmask_b32 v3, v2, v3, vcc
    s_waitcnt vmcnt(16)
    v_mfma_f32_16x16x32_bf16 v[24:27], v[228:231], v[212:215], v[24:27]
    v_mfma_f32_16x16x32_bf16 v[40:43], v[228:231], v[216:219], v[40:43]
    v_mfma_f32_16x16x32_bf16 v[56:59], v[228:231], v[220:223], v[56:59]
    v_mfma_f32_16x16x32_bf16 v[72:75], v[228:231], v[224:227], v[72:75]
    v_mfma_f32_16x16x32_bf16 v[28:31], v[232:235], v[212:215], v[28:31]
    v_mfma_f32_16x16x32_bf16 v[44:47], v[232:235], v[216:219], v[44:47]
    v_mfma_f32_16x16x32_bf16 v[60:63], v[232:235], v[220:223], v[60:63]
    v_mfma_f32_16x16x32_bf16 v[76:79], v[232:235], v[224:227], v[76:79]
    v_mfma_f32_16x16x32_bf16 v[32:35], v[236:239], v[212:215], v[32:35]
    v_mfma_f32_16x16x32_bf16 v[48:51], v[236:239], v[216:219], v[48:51]
    v_mfma_f32_16x16x32_bf16 v[64:67], v[236:239], v[220:223], v[64:67]
    v_mfma_f32_16x16x32_bf16 v[80:83], v[236:239], v[224:227], v[80:83]
    v_mfma_f32_16x16x32_bf16 v[36:39], v[240:243], v[212:215], v[36:39]
    v_mfma_f32_16x16x32_bf16 v[52:55], v[240:243], v[216:219], v[52:55]
    v_mfma_f32_16x16x32_bf16 v[68:71], v[240:243], v[220:223], v[68:71]
    v_mfma_f32_16x16x32_bf16 v[84:87], v[240:243], v[224:227], v[84:87]
recurrent_scan__ssm_conv_h3__mixer_gmlp__prompt_kernel_poll88:
    buffer_load_dword v2, v3, s[48:51], s34 offen sc1
    s_waitcnt vmcnt(0)
    v_cmp_gt_u32 vcc, 16, v2
    s_and_b32 s55, vcc_lo, 15
    s_cmp_lg_u32 s55, 0
    s_cbranch_scc1 recurrent_scan__ssm_conv_h3__mixer_gmlp__prompt_kernel_poll88
    v_lshrrev_b32 v3, 2, v1
    v_lshlrev_b32 v2, 12, v3
    v_and_b32 v3, 3, v1
    v_lshl_add_u32 v2, v3, 4, v2
    s_lshl_b32 s34, s35, 12
    s_lshr_b32 s55, s28, 1
    s_lshl_b32 s55, s55, 6
    s_add_u32 s34, s34, s55
    s_lshl_b32 s55, s37, 1
    s_add_u32 s34, s34, s55
    buffer_load_dwordx4 v[176:179], v2, s[20:23], s34 offen sc1
    s_add_u32 s34, s34, 65536
    buffer_load_dwordx4 v[180:183], v2, s[20:23], s34 offen sc1
    s_add_u32 s34, s34, 65536
    buffer_load_dwordx4 v[184:187], v2, s[20:23], s34 offen sc1
    s_add_u32 s34, s34, 65536
    buffer_load_dwordx4 v[188:191], v2, s[20:23], s34 offen sc1
    s_waitcnt vmcnt(4)
    v_mfma_f32_16x16x32_bf16 v[24:27], v[120:123], v[104:107], v[24:27]
    v_mfma_f32_16x16x32_bf16 v[40:43], v[120:123], v[108:111], v[40:43]
    v_mfma_f32_16x16x32_bf16 v[56:59], v[120:123], v[112:115], v[56:59]
    v_mfma_f32_16x16x32_bf16 v[72:75], v[120:123], v[116:119], v[72:75]
    v_mfma_f32_16x16x32_bf16 v[28:31], v[124:127], v[104:107], v[28:31]
    v_mfma_f32_16x16x32_bf16 v[44:47], v[124:127], v[108:111], v[44:47]
    v_mfma_f32_16x16x32_bf16 v[60:63], v[124:127], v[112:115], v[60:63]
    v_mfma_f32_16x16x32_bf16 v[76:79], v[124:127], v[116:119], v[76:79]
    v_mfma_f32_16x16x32_bf16 v[32:35], v[128:131], v[104:107], v[32:35]
    v_mfma_f32_16x16x32_bf16 v[48:51], v[128:131], v[108:111], v[48:51]
    v_mfma_f32_16x16x32_bf16 v[64:67], v[128:131], v[112:115], v[64:67]
    v_mfma_f32_16x16x32_bf16 v[80:83], v[128:131], v[116:119], v[80:83]
    v_mfma_f32_16x16x32_bf16 v[36:39], v[132:135], v[104:107], v[36:39]
    v_mfma_f32_16x16x32_bf16 v[52:55], v[132:135], v[108:111], v[52:55]
    v_mfma_f32_16x16x32_bf16 v[68:71], v[132:135], v[112:115], v[68:71]
    v_mfma_f32_16x16x32_bf16 v[84:87], v[132:135], v[116:119], v[84:87]
    s_waitcnt vmcnt(4)
    v_mfma_f32_16x16x32_bf16 v[24:27], v[156:159], v[140:143], v[24:27]
    v_mfma_f32_16x16x32_bf16 v[40:43], v[156:159], v[144:147], v[40:43]
    v_mfma_f32_16x16x32_bf16 v[56:59], v[156:159], v[148:151], v[56:59]
    v_mfma_f32_16x16x32_bf16 v[72:75], v[156:159], v[152:155], v[72:75]
    v_mfma_f32_16x16x32_bf16 v[28:31], v[160:163], v[140:143], v[28:31]
    v_mfma_f32_16x16x32_bf16 v[44:47], v[160:163], v[144:147], v[44:47]
    v_mfma_f32_16x16x32_bf16 v[60:63], v[160:163], v[148:151], v[60:63]
    v_mfma_f32_16x16x32_bf16 v[76:79], v[160:163], v[152:155], v[76:79]
    v_mfma_f32_16x16x32_bf16 v[32:35], v[164:167], v[140:143], v[32:35]
    v_mfma_f32_16x16x32_bf16 v[48:51], v[164:167], v[144:147], v[48:51]
    v_mfma_f32_16x16x32_bf16 v[64:67], v[164:167], v[148:151], v[64:67]
    v_mfma_f32_16x16x32_bf16 v[80:83], v[164:167], v[152:155], v[80:83]
    v_mfma_f32_16x16x32_bf16 v[36:39], v[168:171], v[140:143], v[36:39]
    v_mfma_f32_16x16x32_bf16 v[52:55], v[168:171], v[144:147], v[52:55]
    v_mfma_f32_16x16x32_bf16 v[68:71], v[168:171], v[148:151], v[68:71]
    v_mfma_f32_16x16x32_bf16 v[84:87], v[168:171], v[152:155], v[84:87]
    s_mul_i32 s54, s28, 5120
    s_mul_i32 s55, s28, 2560
    v_add_u32 v3, s54, v7
    v_add_u32 v3, 95232, v3
    s_waitcnt vmcnt(3)
    ds_write_b128 v3, v[176:179] offset:0
    s_waitcnt vmcnt(2)
    ds_write_b128 v3, v[180:183] offset:1024
    s_waitcnt vmcnt(1)
    ds_write_b128 v3, v[184:187] offset:2048
    s_waitcnt vmcnt(0)
    ds_write_b128 v3, v[188:191] offset:3072
    s_mul_i32 s34, s28, 20480
    v_add_u32 v2, s34, v7
    s_waitcnt lgkmcnt(0)
    s_barrier
    ds_write_b128 v2, v[24:27] offset:0
    ds_write_b128 v2, v[28:31] offset:1024
    ds_write_b128 v2, v[32:35] offset:2048
    ds_write_b128 v2, v[36:39] offset:3072
    ds_write_b128 v2, v[40:43] offset:5120
    ds_write_b128 v2, v[44:47] offset:6144
    ds_write_b128 v2, v[48:51] offset:7168
    ds_write_b128 v2, v[52:55] offset:8192
    ds_write_b128 v2, v[56:59] offset:10240
    ds_write_b128 v2, v[60:63] offset:11264
    ds_write_b128 v2, v[64:67] offset:12288
    ds_write_b128 v2, v[68:71] offset:13312
    ds_write_b128 v2, v[72:75] offset:15360
    ds_write_b128 v2, v[76:79] offset:16384
    s_waitcnt lgkmcnt(6)
    ds_write_b128 v2, v[80:83] offset:17408
    ds_write_b128 v2, v[84:87] offset:18432
    s_waitcnt lgkmcnt(0)
    s_barrier
    s_mul_i32 s34, s28, 5120
    v_add_u32 v2, s34, v7
    v_add_u32 v9, 61440, v2
    v_lshrrev_b32 v3, 2, v5
    v_lshl_add_u32 v3, v6, 2, v3
    v_lshlrev_b32 v3, 6, v3
    v_and_b32 v116, 3, v5
    v_lshl_add_u32 v3, v116, 4, v3
    s_and_b32 s58, s28, 1
    s_lshl_b32 s58, s58, 3
    s_add_u32 s54, s54, s58
    v_add_u32 v3, s54, v3
    v_add_u32 v13, 95232, v3
    v_mul_u32_u24 v14, 160, v5
    v_lshl_add_u32 v14, v6, 3, v14
    v_add_u32 v14, s55, v14
    v_add_u32 v14, 84992, v14
    v_mov_b32 v168, 0xbfb8aa3b
    v_mov_b32 v169, 0xbfb8aa3b
    v_mov_b32 v170, 1.0
    v_mov_b32 v171, 1.0
    v_mov_b32 v172, v18
    v_mov_b32 v173, v18
    v_mov_b32 v174, v19
    v_mov_b32 v175, v19
    ds_read_b128 v[24:27], v2 offset:0
    ds_read_b128 v[28:31], v2 offset:20480
    ds_read_b128 v[32:35], v2 offset:40960
    ds_read_b128 v[36:39], v9 offset:0
    ds_read_b64_tr_b16 v[40:41], v13 offset:0
    ds_read_b64 v[42:43], v14 offset:0
    ds_read_b128 v[44:47], v2 offset:1024
    ds_read_b128 v[48:51], v2 offset:21504
    ds_read_b128 v[52:55], v2 offset:41984
    ds_read_b128 v[56:59], v9 offset:1024
    ds_read_b64_tr_b16 v[60:61], v13 offset:1024
    ds_read_b64 v[62:63], v14 offset:32
    s_waitcnt lgkmcnt(6)
    v_pk_add_f32 v[112:113], v[24:25], v[28:29]
    v_pk_add_f32 v[114:115], v[26:27], v[30:31]
    v_pk_add_f32 v[116:117], v[32:33], v[36:37]
    v_pk_add_f32 v[118:119], v[34:35], v[38:39]
    v_lshlrev_b32 v108, 16, v40
    v_and_b32 v109, 0xffff0000, v40
    v_lshlrev_b32 v110, 16, v41
    v_and_b32 v111, 0xffff0000, v41
    v_pk_add_f32 v[112:113], v[112:113], v[116:117]
    v_pk_add_f32 v[114:115], v[114:115], v[118:119]
    v_lshlrev_b32 v104, 16, v42
    v_and_b32 v105, 0xffff0000, v42
    v_lshlrev_b32 v106, 16, v43
    v_and_b32 v107, 0xffff0000, v43
    v_pk_mul_f32 v[116:117], v[112:113], v[168:169]
    v_pk_mul_f32 v[118:119], v[114:115], v[168:169]
    v_pk_add_f32 v[120:121], v[104:105], v[172:173] neg_lo:[0,1] neg_hi:[0,1]
    v_pk_add_f32 v[122:123], v[106:107], v[172:173] neg_lo:[0,1] neg_hi:[0,1]
    v_exp_f32 v116, v116
    v_exp_f32 v117, v117
    v_exp_f32 v118, v118
    v_exp_f32 v119, v119
    v_pk_mul_f32 v[108:109], v[108:109], v[174:175]
    v_pk_mul_f32 v[110:111], v[110:111], v[174:175]
    v_pk_mul_f32 v[120:121], v[120:121], v[112:113]
    v_pk_mul_f32 v[122:123], v[122:123], v[114:115]
    v_pk_add_f32 v[116:117], v[116:117], v[170:171]
    v_pk_add_f32 v[118:119], v[118:119], v[170:171]
    v_pk_mul_f32 v[120:121], v[120:121], v[108:109]
    v_pk_mul_f32 v[122:123], v[122:123], v[110:111]
    v_rcp_f32 v116, v116
    v_rcp_f32 v117, v117
    v_rcp_f32 v118, v118
    v_rcp_f32 v119, v119
    v_pk_fma_f32 v[104:105], v[120:121], v[116:117], v[104:105]
    v_pk_fma_f32 v[106:107], v[122:123], v[118:119], v[106:107]
    v_cvt_pk_bf16_f32 v124, v104, v105
    v_cvt_pk_bf16_f32 v125, v106, v107
    ds_write_b64 v14, v[124:125] offset:0
    ds_read_b128 v[24:27], v2 offset:2048
    ds_read_b128 v[28:31], v2 offset:22528
    ds_read_b128 v[32:35], v2 offset:43008
    ds_read_b128 v[36:39], v9 offset:2048
    ds_read_b64_tr_b16 v[40:41], v13 offset:2048
    ds_read_b64 v[42:43], v14 offset:64
    s_waitcnt lgkmcnt(6)
    v_pk_add_f32 v[112:113], v[44:45], v[48:49]
    v_pk_add_f32 v[114:115], v[46:47], v[50:51]
    v_pk_add_f32 v[116:117], v[52:53], v[56:57]
    v_pk_add_f32 v[118:119], v[54:55], v[58:59]
    v_lshlrev_b32 v108, 16, v60
    v_and_b32 v109, 0xffff0000, v60
    v_lshlrev_b32 v110, 16, v61
    v_and_b32 v111, 0xffff0000, v61
    v_pk_add_f32 v[112:113], v[112:113], v[116:117]
    v_pk_add_f32 v[114:115], v[114:115], v[118:119]
    v_lshlrev_b32 v104, 16, v62
    v_and_b32 v105, 0xffff0000, v62
    v_lshlrev_b32 v106, 16, v63
    v_and_b32 v107, 0xffff0000, v63
    v_pk_mul_f32 v[116:117], v[112:113], v[168:169]
    v_pk_mul_f32 v[118:119], v[114:115], v[168:169]
    v_pk_add_f32 v[120:121], v[104:105], v[172:173] neg_lo:[0,1] neg_hi:[0,1]
    v_pk_add_f32 v[122:123], v[106:107], v[172:173] neg_lo:[0,1] neg_hi:[0,1]
    v_exp_f32 v116, v116
    v_exp_f32 v117, v117
    v_exp_f32 v118, v118
    v_exp_f32 v119, v119
    v_pk_mul_f32 v[108:109], v[108:109], v[174:175]
    v_pk_mul_f32 v[110:111], v[110:111], v[174:175]
    v_pk_mul_f32 v[120:121], v[120:121], v[112:113]
    v_pk_mul_f32 v[122:123], v[122:123], v[114:115]
    v_pk_add_f32 v[116:117], v[116:117], v[170:171]
    v_pk_add_f32 v[118:119], v[118:119], v[170:171]
    v_pk_mul_f32 v[120:121], v[120:121], v[108:109]
    v_pk_mul_f32 v[122:123], v[122:123], v[110:111]
    v_rcp_f32 v116, v116
    v_rcp_f32 v117, v117
    v_rcp_f32 v118, v118
    v_rcp_f32 v119, v119
    v_pk_fma_f32 v[104:105], v[120:121], v[116:117], v[104:105]
    v_pk_fma_f32 v[106:107], v[122:123], v[118:119], v[106:107]
    v_cvt_pk_bf16_f32 v124, v104, v105
    v_cvt_pk_bf16_f32 v125, v106, v107
    ds_write_b64 v14, v[124:125] offset:32
    ds_read_b128 v[44:47], v2 offset:3072
    ds_read_b128 v[48:51], v2 offset:23552
    ds_read_b128 v[52:55], v2 offset:44032
    ds_read_b128 v[56:59], v9 offset:3072
    ds_read_b64_tr_b16 v[60:61], v13 offset:3072
    ds_read_b64 v[62:63], v14 offset:96
    s_waitcnt lgkmcnt(6)
    v_pk_add_f32 v[112:113], v[24:25], v[28:29]
    v_pk_add_f32 v[114:115], v[26:27], v[30:31]
    v_pk_add_f32 v[116:117], v[32:33], v[36:37]
    v_pk_add_f32 v[118:119], v[34:35], v[38:39]
    v_lshlrev_b32 v108, 16, v40
    v_and_b32 v109, 0xffff0000, v40
    v_lshlrev_b32 v110, 16, v41
    v_and_b32 v111, 0xffff0000, v41
    v_pk_add_f32 v[112:113], v[112:113], v[116:117]
    v_pk_add_f32 v[114:115], v[114:115], v[118:119]
    v_lshlrev_b32 v104, 16, v42
    v_and_b32 v105, 0xffff0000, v42
    v_lshlrev_b32 v106, 16, v43
    v_and_b32 v107, 0xffff0000, v43
    v_pk_mul_f32 v[116:117], v[112:113], v[168:169]
    v_pk_mul_f32 v[118:119], v[114:115], v[168:169]
    v_pk_add_f32 v[120:121], v[104:105], v[172:173] neg_lo:[0,1] neg_hi:[0,1]
    v_pk_add_f32 v[122:123], v[106:107], v[172:173] neg_lo:[0,1] neg_hi:[0,1]
    v_exp_f32 v116, v116
    v_exp_f32 v117, v117
    v_exp_f32 v118, v118
    v_exp_f32 v119, v119
    v_pk_mul_f32 v[108:109], v[108:109], v[174:175]
    v_pk_mul_f32 v[110:111], v[110:111], v[174:175]
    v_pk_mul_f32 v[120:121], v[120:121], v[112:113]
    v_pk_mul_f32 v[122:123], v[122:123], v[114:115]
    v_pk_add_f32 v[116:117], v[116:117], v[170:171]
    v_pk_add_f32 v[118:119], v[118:119], v[170:171]
    v_pk_mul_f32 v[120:121], v[120:121], v[108:109]
    v_pk_mul_f32 v[122:123], v[122:123], v[110:111]
    v_rcp_f32 v116, v116
    v_rcp_f32 v117, v117
    v_rcp_f32 v118, v118
    v_rcp_f32 v119, v119
    v_pk_fma_f32 v[104:105], v[120:121], v[116:117], v[104:105]
    v_pk_fma_f32 v[106:107], v[122:123], v[118:119], v[106:107]
    v_cvt_pk_bf16_f32 v124, v104, v105
    v_cvt_pk_bf16_f32 v125, v106, v107
    ds_write_b64 v14, v[124:125] offset:64
    s_waitcnt lgkmcnt(0)
    v_pk_add_f32 v[112:113], v[44:45], v[48:49]
    v_pk_add_f32 v[114:115], v[46:47], v[50:51]
    v_pk_add_f32 v[116:117], v[52:53], v[56:57]
    v_pk_add_f32 v[118:119], v[54:55], v[58:59]
    v_lshlrev_b32 v108, 16, v60
    v_and_b32 v109, 0xffff0000, v60
    v_lshlrev_b32 v110, 16, v61
    v_and_b32 v111, 0xffff0000, v61
    v_pk_add_f32 v[112:113], v[112:113], v[116:117]
    v_pk_add_f32 v[114:115], v[114:115], v[118:119]
    v_lshlrev_b32 v104, 16, v62
    v_and_b32 v105, 0xffff0000, v62
    v_lshlrev_b32 v106, 16, v63
    v_and_b32 v107, 0xffff0000, v63
    v_pk_mul_f32 v[116:117], v[112:113], v[168:169]
    v_pk_mul_f32 v[118:119], v[114:115], v[168:169]
    v_pk_add_f32 v[120:121], v[104:105], v[172:173] neg_lo:[0,1] neg_hi:[0,1]
    v_pk_add_f32 v[122:123], v[106:107], v[172:173] neg_lo:[0,1] neg_hi:[0,1]
    v_exp_f32 v116, v116
    v_exp_f32 v117, v117
    v_exp_f32 v118, v118
    v_exp_f32 v119, v119
    v_pk_mul_f32 v[108:109], v[108:109], v[174:175]
    v_pk_mul_f32 v[110:111], v[110:111], v[174:175]
    v_pk_mul_f32 v[120:121], v[120:121], v[112:113]
    v_pk_mul_f32 v[122:123], v[122:123], v[114:115]
    v_pk_add_f32 v[116:117], v[116:117], v[170:171]
    v_pk_add_f32 v[118:119], v[118:119], v[170:171]
    v_pk_mul_f32 v[120:121], v[120:121], v[108:109]
    v_pk_mul_f32 v[122:123], v[122:123], v[110:111]
    v_rcp_f32 v116, v116
    v_rcp_f32 v117, v117
    v_rcp_f32 v118, v118
    v_rcp_f32 v119, v119
    v_pk_fma_f32 v[104:105], v[120:121], v[116:117], v[104:105]
    v_pk_fma_f32 v[106:107], v[122:123], v[118:119], v[106:107]
    v_cvt_pk_bf16_f32 v124, v104, v105
    v_cvt_pk_bf16_f32 v125, v106, v107
    ds_write_b64 v14, v[124:125] offset:96
    s_waitcnt lgkmcnt(0)
    s_mov_b32 s54, 6554
    s_mul_i32 s34, s56, 1152
    s_lshl_b32 s38, s35, 1
    s_add_u32 s34, s34, s38
    v_add_u32 v15, s55, v7
    v_add_u32 v15, 84992, v15
    ds_read_b128 v[128:131], v15 offset:0
    ds_read_b128 v[132:135], v15 offset:1024
    ds_read_b128 v[136:139], v15 offset:2048
    v_add_u32 v2, 0, v1
    v_mul_lo_u32 v3, v2, s54
    v_lshrrev_b32 v3, 16, v3
    v_mul_u32_u24 v116, 10, v3
    v_sub_u32 v116, v2, v116
    v_and_b32 v117, 12, v3
    v_add_u32 v3, v3, v117
    v_mul_u32_u24 v3, 1152, v3
    v_lshl_add_u32 v3, v116, 4, v3
    v_cmp_gt_u32 vcc, 8, v116
    v_mov_b32 v117, 2146435072
    s_nop 0
    v_cndmask_b32 v3, v117, v3, vcc
    s_waitcnt lgkmcnt(2)
    buffer_store_dwordx4 v[128:131], v3, s[24:27], s34 offen
    v_add_u32 v2, 64, v1
    v_mul_lo_u32 v3, v2, s54
    v_lshrrev_b32 v3, 16, v3
    v_mul_u32_u24 v116, 10, v3
    v_sub_u32 v116, v2, v116
    v_and_b32 v117, 12, v3
    v_add_u32 v3, v3, v117
    v_mul_u32_u24 v3, 1152, v3
    v_lshl_add_u32 v3, v116, 4, v3
    v_cmp_gt_u32 vcc, 8, v116
    v_mov_b32 v117, 2146435072
    s_nop 0
    v_cndmask_b32 v3, v117, v3, vcc
    s_waitcnt lgkmcnt(1)
    buffer_store_dwordx4 v[132:135], v3, s[24:27], s34 offen
    v_add_u32 v2, 128, v1
    v_mul_lo_u32 v3, v2, s54
    v_lshrrev_b32 v3, 16, v3
    v_mul_u32_u24 v116, 10, v3
    v_sub_u32 v116, v2, v116
    v_and_b32 v117, 12, v3
    v_add_u32 v3, v3, v117
    v_mul_u32_u24 v3, 1152, v3
    v_lshl_add_u32 v3, v116, 4, v3
    v_cmp_gt_u32 vcc, 8, v116
    v_mov_b32 v117, 2146435072
    s_nop 0
    v_cndmask_b32 v3, v117, v3, vcc
    v_cmp_gt_u32 vcc, 32, v1
    s_nop 1
    v_cndmask_b32 v3, v117, v3, vcc
    s_waitcnt lgkmcnt(0)
    buffer_store_dwordx4 v[136:139], v3, s[24:27], s34 offen
    s_endpgm
recurrent_scan__ssm_conv_h3__mixer_gmlp__prompt_kernel_conv79:
    s_cmp_ge_u32 s54, 576
    s_cbranch_scc1 recurrent_scan__ssm_conv_h3__mixer_gmlp__prompt_kernel_noconv89
    v_lshlrev_b32 v8, 4, v1
    s_lshl_b32 s34, s54, 1
    v_mov_b32 v9, s34
    buffer_load_ushort v12, v9, s[16:19], 0 offen
    v_mov_b32 v16, 0
    v_mov_b32 v17, 0
    v_mov_b32 v18, 0
    v_mov_b32 v19, 0
    v_mov_b32 v20, 0
    v_mov_b32 v21, 0
    v_mov_b32 v22, 0
    v_mov_b32 v23, 0
    v_mov_b32 v24, 0
    v_mov_b32 v25, 0
    v_mov_b32 v26, 0
    v_mov_b32 v27, 0
    v_mov_b32 v28, 0
    v_mov_b32 v29, 0
    v_mov_b32 v30, 0
    v_mov_b32 v31, 0
    v_mov_b32 v32, 0
    v_mov_b32 v33, 0
    v_mov_b32 v34, 0
    v_mov_b32 v35, 0
    v_mov_b32 v36, 0
    v_mov_b32 v37, 0
    v_mov_b32 v38, 0
    v_mov_b32 v39, 0
    v_mov_b32 v40, 0
    v_mov_b32 v41, 0
    v_mov_b32 v42, 0
    v_mov_b32 v43, 0
    v_mov_b32 v44, 0
    v_mov_b32 v45, 0
    v_mov_b32 v46, 0
    v_mov_b32 v47, 0
    v_lshlrev_b32 v9, 3, v1
    v_add_u32 v9, s55, v9
    ds_write_b64 v9, v[16:17] offset:20736
    v_bfe_u32 v9, v1, 2, 2
    v_mul_u32_u24 v9, 4160, v9
    v_and_b32 v8, 3, v1
    v_lshl_add_u32 v9, v8, 3, v9
    v_add_u32 v9, s55, v9
    ds_write_b64 v9, v[16:17]
    v_lshl_add_u32 v9, v6, 3, v5
    v_add_u32 v9, 1, v9
    v_and_b32 v10, 3, v9
    v_mul_u32_u24 v10, 4160, v10
    v_lshrrev_b32 v9, 2, v9
    v_lshl_add_u32 v10, v9, 3, v10
    v_add_u32 v10, s55, v10
    v_lshlrev_b32 v11, 5, v5
    v_lshlrev_b32 v9, 4, v6
    v_sub_u32 v11, v9, v11
    s_add_u32 s34, s55, 17120
    v_add_u32 v11, s34, v11
    v_lshlrev_b32 v9, 4, v1
    v_add_u32 v9, s55, v9
    ds_write_b128 v9, v[100:103] offset:16640
    ds_write_b128 v9, v[104:107] offset:17664
    ds_write_b128 v9, v[108:111] offset:18688
    ds_write_b128 v9, v[112:115] offset:19712
    ds_write_b128 v9, v[116:119] offset:32
    ds_write_b128 v9, v[120:123] offset:1056
    ds_write_b128 v9, v[124:127] offset:2080
    ds_write_b128 v9, v[128:131] offset:3104
    ds_write_b128 v9, v[132:135] offset:4192
    ds_write_b128 v9, v[144:147] offset:5216
    ds_write_b128 v9, v[148:151] offset:6240
    ds_write_b128 v9, v[152:155] offset:7264
    s_waitcnt lgkmcnt(4)
    ds_write_b128 v9, v[156:159] offset:8352
    ds_write_b128 v9, v[180:183] offset:9376
    ds_write_b128 v9, v[184:187] offset:10400
    ds_write_b128 v9, v[188:191] offset:11424
    ds_write_b128 v9, v[192:195] offset:12512
    ds_write_b128 v9, v[196:199] offset:13536
    ds_write_b128 v9, v[200:203] offset:14560
    ds_write_b128 v9, v[204:207] offset:15584
    v_and_b32 v8, 3, v1
    v_lshlrev_b32 v9, 1, v8
    v_add_u32 v9, s55, v9
    v_mul_u32_u24 v8, 4160, v8
    v_add_u32 v8, s55, v8
    s_waitcnt lgkmcnt(0)
    ds_read_b64 v[14:15], v9 offset:24
    s_waitcnt lgkmcnt(0)
    ds_write_b64 v8, v[14:15] offset:24
    s_waitcnt lgkmcnt(0)
    s_waitcnt vmcnt(0)
    v_mov_b32 v2, 160772
    v_mov_b32 v3, 1
    s_mov_b64 exec, 1
    ds_add_rtn_u32 v2, v2, v3
    s_waitcnt lgkmcnt(0)
    v_readfirstlane_b32 s34, v2
    s_cmp_eq_u32 s34, 7
    s_cselect_b32 s34, 0, 2146435072
    s_mov_b64 exec, 1
    v_mov_b32 v3, 1
    v_mov_b32 v2, s60
    buffer_atomic_add v3, v2, s[48:51], s34 offen sc1
    s_mov_b64 exec, -1
    ds_read_b128 v[112:115], v11 offset:3584
    ds_read_b64 v[48:49], v10 offset:0
    ds_read_b64 v[50:51], v10 offset:8
    ds_read_b128 v[116:119], v11 offset:3072
    ds_read_b64 v[52:53], v10 offset:512
    ds_read_b64 v[54:55], v10 offset:520
    ds_read_b128 v[120:123], v11 offset:2560
    ds_read_b64 v[56:57], v10 offset:1024
    ds_read_b64 v[58:59], v10 offset:1032
    ds_read_b128 v[124:127], v11 offset:2048
    ds_read_b64 v[60:61], v10 offset:1536
    ds_read_b64 v[62:63], v10 offset:1544
    s_mov_b32 s33, 0
recurrent_scan__ssm_conv_h3__mixer_gmlp__prompt_kernel_cloop90:
    s_waitcnt lgkmcnt(9)
    v_mfma_f32_16x16x32_bf16 v[16:19], v[48:51], v[112:115], v[16:19]
    ds_read_b128 v[128:131], v11 offset:1536
    ds_read_b64 v[64:65], v10 offset:2048
    s_waitcnt lgkmcnt(8)
    v_mfma_f32_16x16x32_bf16 v[20:23], v[48:51], v[116:119], v[20:23]
    ds_read_b64 v[66:67], v10 offset:2056
    ds_read_b128 v[132:135], v11 offset:1024
    v_mfma_f32_16x16x32_bf16 v[20:23], v[52:55], v[112:115], v[20:23]
    ds_read_b64 v[68:69], v10 offset:2560
    ds_read_b64 v[70:71], v10 offset:2568
    v_mfma_f32_16x16x32_bf16 v[24:27], v[52:55], v[116:119], v[24:27]
    ds_read_b128 v[136:139], v11 offset:512
    ds_read_b64 v[72:73], v10 offset:3072
    s_waitcnt lgkmcnt(11)
    v_mfma_f32_16x16x32_bf16 v[24:27], v[48:51], v[120:123], v[24:27]
    ds_read_b64 v[74:75], v10 offset:3080
    ds_read_b128 v[140:143], v11 offset:0
    v_mfma_f32_16x16x32_bf16 v[24:27], v[56:59], v[112:115], v[24:27]
    ds_read_b64 v[76:77], v10 offset:3584
    v_mfma_f32_16x16x32_bf16 v[28:31], v[52:55], v[120:123], v[28:31]
    v_mfma_f32_16x16x32_bf16 v[28:31], v[56:59], v[116:119], v[28:31]
    v_mfma_f32_16x16x32_bf16 v[32:35], v[56:59], v[120:123], v[32:35]
    s_waitcnt lgkmcnt(11)
    v_mfma_f32_16x16x32_bf16 v[28:31], v[48:51], v[124:127], v[28:31]
    ds_read_b64 v[78:79], v10 offset:3592
    ds_read_b128 v[144:147], v11 offset:3648
    v_mfma_f32_16x16x32_bf16 v[28:31], v[60:63], v[112:115], v[28:31]
    ds_read_b64 v[80:81], v10 offset:64
    v_mfma_f32_16x16x32_bf16 v[32:35], v[52:55], v[124:127], v[32:35]
    v_mfma_f32_16x16x32_bf16 v[32:35], v[60:63], v[116:119], v[32:35]
    v_mfma_f32_16x16x32_bf16 v[36:39], v[56:59], v[124:127], v[36:39]
    v_mfma_f32_16x16x32_bf16 v[36:39], v[60:63], v[120:123], v[36:39]
    v_mfma_f32_16x16x32_bf16 v[40:43], v[60:63], v[124:127], v[40:43]
    s_waitcnt lgkmcnt(11)
    v_mfma_f32_16x16x32_bf16 v[32:35], v[48:51], v[128:131], v[32:35]
    ds_read_b64 v[82:83], v10 offset:72
    v_mfma_f32_16x16x32_bf16 v[32:35], v[64:67], v[112:115], v[32:35]
    ds_read_b128 v[148:151], v11 offset:3136
    v_mfma_f32_16x16x32_bf16 v[36:39], v[52:55], v[128:131], v[36:39]
    ds_read_b64 v[84:85], v10 offset:576
    v_mfma_f32_16x16x32_bf16 v[36:39], v[64:67], v[116:119], v[36:39]
    v_mfma_f32_16x16x32_bf16 v[40:43], v[56:59], v[128:131], v[40:43]
    v_mfma_f32_16x16x32_bf16 v[40:43], v[64:67], v[120:123], v[40:43]
    v_mfma_f32_16x16x32_bf16 v[44:47], v[60:63], v[128:131], v[44:47]
    v_mfma_f32_16x16x32_bf16 v[44:47], v[64:67], v[124:127], v[44:47]
    s_waitcnt lgkmcnt(11)
    v_mfma_f32_16x16x32_bf16 v[36:39], v[48:51], v[132:135], v[36:39]
    ds_read_b64 v[86:87], v10 offset:584
    v_mfma_f32_16x16x32_bf16 v[36:39], v[68:71], v[112:115], v[36:39]
    ds_read_b128 v[152:155], v11 offset:2624
    v_mfma_f32_16x16x32_bf16 v[40:43], v[52:55], v[132:135], v[40:43]
    ds_read_b64 v[88:89], v10 offset:1088
    v_mfma_f32_16x16x32_bf16 v[40:43], v[68:71], v[116:119], v[40:43]
    v_mfma_f32_16x16x32_bf16 v[44:47], v[56:59], v[132:135], v[44:47]
    v_mfma_f32_16x16x32_bf16 v[44:47], v[68:71], v[120:123], v[44:47]
    s_waitcnt lgkmcnt(11)
    v_mfma_f32_16x16x32_bf16 v[40:43], v[48:51], v[136:139], v[40:43]
    ds_read_b64 v[90:91], v10 offset:1096
    v_mfma_f32_16x16x32_bf16 v[40:43], v[72:75], v[112:115], v[40:43]
    ds_read_b128 v[156:159], v11 offset:2112
    v_mfma_f32_16x16x32_bf16 v[44:47], v[52:55], v[136:139], v[44:47]
    ds_read_b64 v[92:93], v10 offset:1600
    v_mfma_f32_16x16x32_bf16 v[44:47], v[72:75], v[116:119], v[44:47]
    s_waitcnt lgkmcnt(11)
    v_mfma_f32_16x16x32_bf16 v[44:47], v[48:51], v[140:143], v[44:47]
    ds_read_b64 v[94:95], v10 offset:1608
    v_mfma_f32_16x16x32_bf16 v[44:47], v[76:79], v[112:115], v[44:47]
    s_waitcnt lgkmcnt(9)
    v_mfma_f32_16x16x32_bf16 v[16:19], v[80:83], v[144:147], v[16:19]
    ds_read_b128 v[160:163], v11 offset:1600
    ds_read_b64 v[96:97], v10 offset:2112
    s_waitcnt lgkmcnt(8)
    v_mfma_f32_16x16x32_bf16 v[20:23], v[80:83], v[148:151], v[20:23]
    ds_read_b64 v[98:99], v10 offset:2120
    ds_read_b128 v[164:167], v11 offset:1088
    v_mfma_f32_16x16x32_bf16 v[20:23], v[84:87], v[144:147], v[20:23]
    ds_read_b64 v[100:101], v10 offset:2624
    ds_read_b64 v[102:103], v10 offset:2632
    v_mfma_f32_16x16x32_bf16 v[24:27], v[84:87], v[148:151], v[24:27]
    ds_read_b128 v[168:171], v11 offset:576
    ds_read_b64 v[104:105], v10 offset:3136
    s_waitcnt lgkmcnt(11)
    v_mfma_f32_16x16x32_bf16 v[24:27], v[80:83], v[152:155], v[24:27]
    ds_read_b64 v[106:107], v10 offset:3144
    ds_read_b128 v[172:175], v11 offset:64
    v_mfma_f32_16x16x32_bf16 v[24:27], v[88:91], v[144:147], v[24:27]
    ds_read_b64 v[108:109], v10 offset:3648
    v_mfma_f32_16x16x32_bf16 v[28:31], v[84:87], v[152:155], v[28:31]
    v_mfma_f32_16x16x32_bf16 v[28:31], v[88:91], v[148:151], v[28:31]
    v_mfma_f32_16x16x32_bf16 v[32:35], v[88:91], v[152:155], v[32:35]
    s_waitcnt lgkmcnt(11)
    v_mfma_f32_16x16x32_bf16 v[28:31], v[80:83], v[156:159], v[28:31]
    ds_read_b64 v[110:111], v10 offset:3656
    ds_read_b128 v[112:115], v11 offset:3712
    v_mfma_f32_16x16x32_bf16 v[28:31], v[92:95], v[144:147], v[28:31]
    ds_read_b64 v[48:49], v10 offset:128
    v_mfma_f32_16x16x32_bf16 v[32:35], v[84:87], v[156:159], v[32:35]
    v_mfma_f32_16x16x32_bf16 v[32:35], v[92:95], v[148:151], v[32:35]
    v_mfma_f32_16x16x32_bf16 v[36:39], v[88:91], v[156:159], v[36:39]
    v_mfma_f32_16x16x32_bf16 v[36:39], v[92:95], v[152:155], v[36:39]
    v_mfma_f32_16x16x32_bf16 v[40:43], v[92:95], v[156:159], v[40:43]
    s_waitcnt lgkmcnt(11)
    v_mfma_f32_16x16x32_bf16 v[32:35], v[80:83], v[160:163], v[32:35]
    ds_read_b64 v[50:51], v10 offset:136
    v_mfma_f32_16x16x32_bf16 v[32:35], v[96:99], v[144:147], v[32:35]
    ds_read_b128 v[116:119], v11 offset:3200
    v_mfma_f32_16x16x32_bf16 v[36:39], v[84:87], v[160:163], v[36:39]
    ds_read_b64 v[52:53], v10 offset:640
    v_mfma_f32_16x16x32_bf16 v[36:39], v[96:99], v[148:151], v[36:39]
    v_mfma_f32_16x16x32_bf16 v[40:43], v[88:91], v[160:163], v[40:43]
    v_mfma_f32_16x16x32_bf16 v[40:43], v[96:99], v[152:155], v[40:43]
    v_mfma_f32_16x16x32_bf16 v[44:47], v[92:95], v[160:163], v[44:47]
    v_mfma_f32_16x16x32_bf16 v[44:47], v[96:99], v[156:159], v[44:47]
    s_waitcnt lgkmcnt(11)
    v_mfma_f32_16x16x32_bf16 v[36:39], v[80:83], v[164:167], v[36:39]
    ds_read_b64 v[54:55], v10 offset:648
    v_mfma_f32_16x16x32_bf16 v[36:39], v[100:103], v[144:147], v[36:39]
    ds_read_b128 v[120:123], v11 offset:2688
    v_mfma_f32_16x16x32_bf16 v[40:43], v[84:87], v[164:167], v[40:43]
    ds_read_b64 v[56:57], v10 offset:1152
    v_mfma_f32_16x16x32_bf16 v[40:43], v[100:103], v[148:151], v[40:43]
    v_mfma_f32_16x16x32_bf16 v[44:47], v[88:91], v[164:167], v[44:47]
    v_mfma_f32_16x16x32_bf16 v[44:47], v[100:103], v[152:155], v[44:47]
    s_waitcnt lgkmcnt(11)
    v_mfma_f32_16x16x32_bf16 v[40:43], v[80:83], v[168:171], v[40:43]
    ds_read_b64 v[58:59], v10 offset:1160
    v_mfma_f32_16x16x32_bf16 v[40:43], v[104:107], v[144:147], v[40:43]
    ds_read_b128 v[124:127], v11 offset:2176
    v_mfma_f32_16x16x32_bf16 v[44:47], v[84:87], v[168:171], v[44:47]
    ds_read_b64 v[60:61], v10 offset:1664
    v_mfma_f32_16x16x32_bf16 v[44:47], v[104:107], v[148:151], v[44:47]
    s_waitcnt lgkmcnt(11)
    v_mfma_f32_16x16x32_bf16 v[44:47], v[80:83], v[172:175], v[44:47]
    ds_read_b64 v[62:63], v10 offset:1672
    v_mfma_f32_16x16x32_bf16 v[44:47], v[108:111], v[144:147], v[44:47]
    v_add_u32 v10, 128, v10
    v_add_u32 v11, 128, v11
    s_add_u32 s33, s33, 1
    s_cmp_lt_u32 s33, 4
    s_cbranch_scc1 recurrent_scan__ssm_conv_h3__mixer_gmlp__prompt_kernel_cloop90
    s_waitcnt lgkmcnt(0)
    s_setprio 3
    v_lshlrev_b32 v8, 5, v5
    v_lshl_add_u32 v8, v6, 3, v8
    s_add_u32 s34, s55, 17144
    v_sub_u32 v9, s34, v8
    ds_read_b64 v[48:49], v9 offset:3584
    ds_read_b64 v[50:51], v9 offset:3072
    ds_read_b64 v[52:53], v9 offset:2560
    ds_read_b64 v[54:55], v9 offset:2048
    ds_read_b64 v[56:57], v9 offset:1536
    ds_read_b64 v[58:59], v9 offset:1024
    ds_read_b64 v[60:61], v9 offset:512
    ds_read_b64 v[62:63], v9 offset:0
    v_lshlrev_b32 v12, 16, v12
    v_add_u32 v10, s55, v8
    s_lshl_b32 s34, s54, 12
    s_waitcnt lgkmcnt(0)
    v_and_b32 v112, 0xffff0000, v49
    v_lshlrev_b32 v113, 16, v49
    v_and_b32 v114, 0xffff0000, v48
    v_lshlrev_b32 v115, 16, v48
    v_fmac_f32 v16, v112, v12
    v_fmac_f32 v17, v113, v12
    v_fmac_f32 v18, v114, v12
    v_fmac_f32 v19, v115, v12
    v_cvt_pk_bf16_f32 v128, v16, v17
    v_cvt_pk_bf16_f32 v129, v18, v19
    ds_write_b64 v10, v[128:129] offset:0
    v_and_b32 v116, 0xffff0000, v51
    v_lshlrev_b32 v117, 16, v51
    v_and_b32 v118, 0xffff0000, v50
    v_lshlrev_b32 v119, 16, v50
    v_fmac_f32 v20, v116, v12
    v_fmac_f32 v21, v117, v12
    v_fmac_f32 v22, v118, v12
    v_fmac_f32 v23, v119, v12
    v_cvt_pk_bf16_f32 v130, v20, v21
    v_cvt_pk_bf16_f32 v131, v22, v23
    ds_write_b64 v10, v[130:131] offset:512
    v_and_b32 v112, 0xffff0000, v53
    v_lshlrev_b32 v113, 16, v53
    v_and_b32 v114, 0xffff0000, v52
    v_lshlrev_b32 v115, 16, v52
    v_fmac_f32 v24, v112, v12
    v_fmac_f32 v25, v113, v12
    v_fmac_f32 v26, v114, v12
    v_fmac_f32 v27, v115, v12
    v_cvt_pk_bf16_f32 v132, v24, v25
    v_cvt_pk_bf16_f32 v133, v26, v27
    ds_write_b64 v10, v[132:133] offset:1024
    v_and_b32 v116, 0xffff0000, v55
    v_lshlrev_b32 v117, 16, v55
    v_and_b32 v118, 0xffff0000, v54
    v_lshlrev_b32 v119, 16, v54
    v_fmac_f32 v28, v116, v12
    v_fmac_f32 v29, v117, v12
    v_fmac_f32 v30, v118, v12
    v_fmac_f32 v31, v119, v12
    v_cvt_pk_bf16_f32 v134, v28, v29
    v_cvt_pk_bf16_f32 v135, v30, v31
    ds_write_b64 v10, v[134:135] offset:1536
    v_and_b32 v112, 0xffff0000, v57
    v_lshlrev_b32 v113, 16, v57
    v_and_b32 v114, 0xffff0000, v56
    v_lshlrev_b32 v115, 16, v56
    v_fmac_f32 v32, v112, v12
    v_fmac_f32 v33, v113, v12
    v_fmac_f32 v34, v114, v12
    v_fmac_f32 v35, v115, v12
    v_cvt_pk_bf16_f32 v136, v32, v33
    v_cvt_pk_bf16_f32 v137, v34, v35
    ds_write_b64 v10, v[136:137] offset:2048
    v_and_b32 v116, 0xffff0000, v59
    v_lshlrev_b32 v117, 16, v59
    v_and_b32 v118, 0xffff0000, v58
    v_lshlrev_b32 v119, 16, v58
    v_fmac_f32 v36, v116, v12
    v_fmac_f32 v37, v117, v12
    v_fmac_f32 v38, v118, v12
    v_fmac_f32 v39, v119, v12
    v_cvt_pk_bf16_f32 v138, v36, v37
    v_cvt_pk_bf16_f32 v139, v38, v39
    ds_write_b64 v10, v[138:139] offset:2560
    v_and_b32 v112, 0xffff0000, v61
    v_lshlrev_b32 v113, 16, v61
    v_and_b32 v114, 0xffff0000, v60
    v_lshlrev_b32 v115, 16, v60
    v_fmac_f32 v40, v112, v12
    v_fmac_f32 v41, v113, v12
    v_fmac_f32 v42, v114, v12
    v_fmac_f32 v43, v115, v12
    v_cvt_pk_bf16_f32 v140, v40, v41
    v_cvt_pk_bf16_f32 v141, v42, v43
    ds_write_b64 v10, v[140:141] offset:3072
    v_and_b32 v116, 0xffff0000, v63
    v_lshlrev_b32 v117, 16, v63
    v_and_b32 v118, 0xffff0000, v62
    v_lshlrev_b32 v119, 16, v62
    v_fmac_f32 v44, v116, v12
    v_fmac_f32 v45, v117, v12
    v_fmac_f32 v46, v118, v12
    v_fmac_f32 v47, v119, v12
    v_cvt_pk_bf16_f32 v142, v44, v45
    v_cvt_pk_bf16_f32 v143, v46, v47
    ds_write_b64 v10, v[142:143] offset:3584
    v_lshlrev_b32 v8, 4, v1
    v_add_u32 v9, s55, v8
    s_waitcnt lgkmcnt(0)
    ds_read_b128 v[80:83], v9 offset:0
    ds_read_b128 v[84:87], v9 offset:1024
    ds_read_b128 v[88:91], v9 offset:2048
    ds_read_b128 v[92:95], v9 offset:3072
    s_waitcnt lgkmcnt(3)
    buffer_store_dwordx4 v[80:83], v8, s[20:23], s34 offen offset:0 sc1
    s_waitcnt lgkmcnt(2)
    buffer_store_dwordx4 v[84:87], v8, s[20:23], s34 offen offset:1024 sc1
    s_waitcnt lgkmcnt(1)
    buffer_store_dwordx4 v[88:91], v8, s[20:23], s34 offen offset:2048 sc1
    s_waitcnt lgkmcnt(0)
    buffer_store_dwordx4 v[92:95], v8, s[20:23], s34 offen offset:3072 sc1
    s_waitcnt vmcnt(0)
    s_lshr_b32 s34, s54, 4
    s_lshl_b32 s34, s34, 8
    s_add_u32 s34, s34, 1851392
    v_mov_b32 v2, s34
    v_mov_b32 v3, 1
    s_mov_b64 exec, 1
    buffer_atomic_add v3, v2, s[48:51], 0 offen sc1
    s_endpgm
recurrent_scan__ssm_conv_h3__mixer_gmlp__prompt_kernel_noconv89:
    s_waitcnt vmcnt(0)
    v_mov_b32 v2, 160772
    v_mov_b32 v3, 1
    s_mov_b64 exec, 1
    ds_add_rtn_u32 v2, v2, v3
    s_waitcnt lgkmcnt(0)
    v_readfirstlane_b32 s34, v2
    s_cmp_eq_u32 s34, 7
    s_cselect_b32 s34, 0, 2146435072
    s_mov_b64 exec, 1
    v_mov_b32 v3, 1
    v_mov_b32 v2, s60
    buffer_atomic_add v3, v2, s[48:51], s34 offen sc1
    s_mov_b64 exec, -1
recurrent_scan__ssm_conv_h3__mixer_gmlp__prompt_kernel_end1:
    s_endpgm
.section .rodata,"a"
.p2align 6
.amdhsa_kernel recurrent_scan__ssm_conv_h3__mixer_gmlp__prompt_kernel
  .amdhsa_next_free_vgpr 256
  .amdhsa_next_free_sgpr 68
  .amdhsa_accum_offset 256
  .amdhsa_group_segment_fixed_size 0
  .amdhsa_kernarg_size 112
  .amdhsa_user_sgpr_count 2
  .amdhsa_user_sgpr_kernarg_segment_ptr 1
  .amdhsa_system_sgpr_workgroup_id_x 1
.end_amdhsa_kernel
```
